```python
import torch

def _softmax(x, axis=-1):
    return torch.softmax(x, dim=axis)
def _gelu(x):
    return torch.nn.functional.gelu(x, approximate="tanh")
def _silu(x):
    return torch.nn.functional.silu(x)
def _sigmoid(x):
    return torch.sigmoid(x)
def _layernorm(x, axis=-1, eps=1e-5):
    m = x.mean(dim=axis, keepdim=True)
    v = x.var(dim=axis, keepdim=True, unbiased=False)
    return (x - m) / torch.sqrt(v + eps)
def _scatter_add(tgt, idx, src, axis=0):
    return tgt.clone().index_add_(axis, idx, src)
def _segment_sum(src, seg, n):
    out = torch.zeros((n,) + src.shape[1:], dtype=src.dtype)
    return out.index_add_(0, seg, src)
def _pad(x, pw):
    flat = tuple(v for pair in reversed(pw) for v in pair)
    return torch.nn.functional.pad(x, flat)

kernel_name = 'recurrent_scan__gqa_block_cached__dense_activation_relu__prompt'

def setup_inputs():

    _w = (lambda a: (lambda t: t.to(torch.bfloat16) if t.is_floating_point() else t)(torch.as_tensor(a)))
    def _A_setup():
        B, Sq, D = 1, 2048, 640
        Hq, Hkv, Sk, Dh = 32, 32, 2048, 192
        assert Hq % Hkv == 0, (Hq, Hkv)
        return {
            "x": _w((lambda *s: torch.randn(*s, dtype=torch.bfloat16) * 0.05)(B, Sq, D)),
            "k_cache": _w((lambda *s: torch.randn(*s, dtype=torch.bfloat16) * 1.6)(B, Hkv, Sk, Dh)),
            "v_cache": _w((lambda *s: torch.randn(*s, dtype=torch.bfloat16) * 0.2)(B, Hkv, Sk, Dh)),
            "wq": _w((lambda *s: torch.randn(*s, dtype=torch.bfloat16) * 1.6)(D, Hq * Dh) * (D ** -0.5)),
            "wo": _w((lambda *s: torch.randn(*s, dtype=torch.bfloat16) * 0.2)(Hq * Dh, D) * ((Hq * Dh) ** -0.5)),
        }
    _A_in = _A_setup()

    def _B_setup():
        B, S, D, Dff = 1, 2048, 640, 1536
        return {
            "x": _w((lambda *s: torch.randn(*s, dtype=torch.bfloat16) * 0.05)(B, S, D)),
            "w1": _w((lambda *s: torch.randn(*s, dtype=torch.bfloat16) * 0.1)(D, Dff)),
            "w2": _w((lambda *s: torch.randn(*s, dtype=torch.bfloat16) * 0.1)(Dff, D)),
        }
    _B_in = _B_setup()

    return {
        "A_x": _A_in["x"],
        "A_k_cache": _A_in["k_cache"],
        "A_v_cache": _A_in["v_cache"],
        "A_wq": _A_in["wq"],
        "A_wo": _A_in["wo"],
        "B_x": _B_in["x"],
        "B_w1": _B_in["w1"],
        "B_w2": _B_in["w2"],
    }

def reference(A_x, A_k_cache, A_v_cache, A_wq, A_wo, B_x, B_w1, B_w2):
    def _A_ref(x, k_cache, v_cache, wq, wo):
        B, Sq, D = x.shape
        Hq, Dh = 32, 192
        Hkv = k_cache.shape[1]
        rep = Hq // Hkv
        q = (lambda x, *d: x.permute(*d))((x @ wq).reshape(B, Sq, Hq, Dh), 0, 2, 1, 3)
        k = (lambda x, n, axis: torch.repeat_interleave(x, n, dim=axis))(k_cache, rep, axis=1)
        v = (lambda x, n, axis: torch.repeat_interleave(x, n, dim=axis))(v_cache, rep, axis=1)
        scores = torch.einsum("bhqd,bhkd->bhqk", q, k) * (Dh ** -0.5)
        p = _softmax(scores, axis=-1)
        o = torch.einsum("bhqk,bhkd->bhqd", p, v)
        return (lambda x, *d: x.permute(*d))(o, 0, 2, 1, 3).reshape(B, Sq, Hq * Dh) @ wo

    def _B_ref(x, w1, w2):
        h = torch.einsum("bsd,df->bsf", x, w1)
        zero = torch.zeros_like(h)
        h = torch.maximum(h, zero)
        return torch.einsum("bsf,fd->bsd", h, w2)

    x = A_x
    xn = _layernorm(x, axis=-1)
    s = _A_ref(xn, A_k_cache, A_v_cache, A_wq, A_wo)
    g = _silu(_B_ref(xn, B_w1, B_w2))
    return x + s * g
```

```asm
; @launch grid=(256,1,1) block=(256,1,1) lds=163840
.amdgcn_target "amdgcn-amd-amdhsa--gfx950"
.text
.globl recurrent_scan__gqa_block_cached__dense_activation_relu__prompt_kernel
.p2align 8
.type recurrent_scan__gqa_block_cached__dense_activation_relu__prompt_kernel,@function
recurrent_scan__gqa_block_cached__dense_activation_relu__prompt_kernel:
s_cmp_ge_u32 s2, 256
s_cbranch_scc1 F_END
s_load_dwordx8 s[4:11], s[0:1], 0
s_load_dwordx2 s[68:69], s[0:1], 32
s_load_dwordx4 s[72:75], s[0:1], 48
s_load_dwordx4 s[76:79], s[0:1], 64
s_load_dwordx2 s[70:71], s[0:1], 80
s_getpc_b64 s[66:67]
F_PC:
v_lshrrev_b32 v1, 6, v0
s_lshr_b32 s62, s2, 3
s_mul_i32 s62, s62, 1536
s_add_u32 s62, s62, 8192 - 512
v_and_b32 v2, 63, v0
v_lshlrev_b32 v4, 7, v2
v_and_b32 v2, 3, v0
v_lshl_add_u32 v2, v1, 2, v2
v_lshlrev_b32 v2, 7, v2
v_add_u32 v2, s62, v2
v_cmp_eq_u32 vcc, 0, v1
v_mov_b32 v5, s67
s_nop 0
v_cndmask_b32 v4, v2, v4, vcc
v_min_u32 v4, F_PFE-F_PC, v4
v_add_co_u32 v4, vcc, s66, v4
s_nop 1
v_addc_co_u32 v5, vcc, 0, v5, vcc
global_load_dword v213, v[4:5], off
v_lshrrev_b32 v1, 6, v0
s_nop 0
v_readfirstlane_b32 s36, v1
v_and_b32 v0, 63, v0
s_nop 3
s_mov_b32 s3, 0x10000000
s_and_b32 s66, s2, 7
s_lshl_b32 s66, s66, 2
s_lshr_b32 s67, s2, 3
s_and_b32 s67, s67, 3
s_add_u32 s37, s66, s67
s_lshr_b32 s85, s2, 5
s_lshl_b32 s66, s85, 2
s_add_u32 s38, s66, s36
s_lshl_b32 s66, s85, 5
s_add_u32 s66, s66, s37
s_lshl_b32 s66, s66, 2
s_add_u32 s66, s66, s36
s_lshl_b32 s62, s66, 1
s_mul_i32 s66, s62, 1280
v_lshrrev_b32 v1, 5, v0
v_and_b32 v2, 31, v0
v_mul_u32_u24 v3, 1280, v1
v_lshl_add_u32 v3, v2, 3, v3
v_lshlrev_b32 v253, 4, v0
s_or_b32 s39, s2, s36
s_waitcnt lgkmcnt(0)
s_add_u32 s12, s4, s66
s_addc_u32 s13, s5, 0
s_mov_b32 s14, 0xa00
s_mov_b32 s15, 0x20000
buffer_load_dwordx2 v[64:65], v3, s[12:15], 0 offen offset:0
buffer_load_dwordx2 v[66:67], v3, s[12:15], 0 offen offset:256
buffer_load_dwordx2 v[68:69], v3, s[12:15], 0 offen offset:512
buffer_load_dwordx2 v[70:71], v3, s[12:15], 0 offen offset:768
buffer_load_dwordx2 v[72:73], v3, s[12:15], 0 offen offset:1024
s_add_u32 s80, s70, 0x2f0000
s_addc_u32 s81, s71, 0
s_mov_b32 s82, 0x400
s_mov_b32 s83, 0x20000
s_cmp_eq_u32 s39, 0
s_cselect_b32 s82, 1024, 0
buffer_load_dwordx4 v[76:79], v253, s[80:83], 0 offen sc1
s_mov_b32 s82, 1024
s_lshl_b32 s66, s85, 5
s_add_u32 s66, s66, s37
s_lshl_b32 s66, s66, 2
buffer_load_dword v75, off, s[80:83], s66 sc1
s_lshr_b32 s66, s62, 6
s_mul_i32 s66, s66, 81920
s_and_b32 s67, s62, 63
s_lshl_b32 s67, s67, 6
s_add_u32 s66, s66, s67
s_sub_u32 s67, 81920, s67
s_add_u32 s16, s70, s66
s_addc_u32 s17, s71, 0
s_mov_b32 s18, s67
s_mov_b32 s19, 0x20000
v_lshrrev_b32 v13, 3, v2
v_lshlrev_b32 v13, 12, v13
v_lshl_add_u32 v13, v1, 6, v13
v_and_b32 v3, 7, v0
v_lshl_add_u32 v13, v3, 3, v13
s_mul_i32 s66, s37, 384
s_sub_u32 s67, 7864320, s66
s_add_u32 s20, s10, s66
s_addc_u32 s21, s11, 0
s_mov_b32 s22, s67
s_mov_b32 s23, 0x20000
s_mul_i32 s66, s37, 96
s_sub_u32 s67, 1969152, s66
s_sub_u32 s72, s72, 3072
s_subb_u32 s73, s73, 0
s_add_u32 s24, s72, s66
s_addc_u32 s25, s73, 0
s_mov_b32 s26, s67
s_mov_b32 s27, 0x20000
s_lshl_b32 s66, s36, 4
s_mov_b32 s67, 12288
v_lshrrev_b32 v1, 4, v0
v_and_b32 v2, 15, v0
v_lshlrev_b32 v3, 1, v1
v_xor_b32 v2, v2, v3
v_add_u32 v3, s66, v1
v_mul_lo_u32 v3, v3, s67
v_lshl_add_u32 v40, v2, 4, v3
v_add_u32 v41, 48128, v40
v_xor_b32 v2, 8, v2
v_lshl_add_u32 v3, v2, 4, v3
v_add_u32 v42, 96256, v3
v_add_u32 v43, 144384, v3
v_lshrrev_b32 v1, 3, v0
v_and_b32 v2, 7, v0
v_and_b32 v3, 2, v1
v_xor_b32 v2, v2, v3
v_add_u32 v3, s66, v1
v_mul_lo_u32 v4, v3, s67
v_add_u32 v4, 256, v4
v_lshl_add_u32 v44, v2, 4, v4
v_xor_b32 v5, 4, v2
v_lshl_add_u32 v4, v5, 4, v4
v_add_u32 v45, 97280, v4
v_mul_u32_u24 v3, 3072, v3
v_bfrev_b32 v8, 1
v_cmp_gt_u32 vcc, 6, v2
v_lshl_add_u32 v6, v2, 4, v3
v_add_u32 v6, 1024, v6
v_cndmask_b32 v46, v8, v6, vcc
v_cmp_gt_u32 vcc, 6, v5
v_lshl_add_u32 v6, v5, 4, v3
v_add_u32 v6, 24576, v6
v_cndmask_b32 v47, v8, v6, vcc
s_lshl_b32 s66, s36, 12
s_add_u32 s48, s66, 65536
s_add_u32 s49, s66, 114688
s_add_u32 s50, s66, 81920
s_add_u32 s51, s66, 131072
s_add_u32 s52, s66, 98304
s_add_u32 s53, s66, 147456
s_mov_b32 s54, 0
s_mov_b32 s55, 0
s_mov_b32 m0, s48
s_nop 0
buffer_load_dwordx4 v40, s[20:23], s54 offen offset:0 lds
buffer_load_dwordx4 v41, s[20:23], s54 offen offset:1024 lds
buffer_load_dwordx4 v42, s[20:23], s54 offen offset:2048 lds
buffer_load_dwordx4 v43, s[20:23], s54 offen offset:3072 lds
s_mov_b32 m0, s49
s_nop 0
buffer_load_dwordx4 v44, s[20:23], s54 offen offset:0 lds
buffer_load_dwordx4 v45, s[20:23], s54 offen offset:1024 lds
buffer_load_dwordx4 v46, s[24:27], s55 offen offset:2048 lds
buffer_load_dwordx4 v47, s[24:27], s55 offen offset:3072 lds
s_add_u32 s54, s54, 786432
s_add_u32 s55, s55, 196608
s_lshl_b32 s66, s85, 3
s_lshl_b32 s67, s36, 1
s_add_u32 s66, s66, s67
s_mov_b32 s67, 12288
v_mul_u32_u24 v1, 171, v0
v_lshrrev_b32 v1, 9, v1
v_mul_u32_u24 v2, 3, v1
v_sub_u32 v2, v0, v2
v_lshrrev_b32 v3, 1, v1
v_and_b32 v1, 1, v1
v_lshl_add_u32 v1, v3, 6, v1
v_add_u32 v1, s66, v1
v_mul_lo_u32 v1, v1, s67
v_lshl_add_u32 v1, v2, 7, v1
v_cmp_gt_u32 vcc, 24, v0
v_bfrev_b32 v8, 1
v_lshrrev_b32 v3, 2, v0
v_bfe_u32 v2, v0, 1, 1
v_cndmask_b32 v210, v8, v1, vcc
v_lshl_add_u32 v3, v3, 6, v2
v_add_u32 v3, s66, v3
v_cmp_gt_u32 vcc, 16, v0
v_mul_u32_u24 v3, 3072, v3
v_and_b32 v2, 1, v0
v_mul_u32_u24 v2, 92, v2
v_add_u32 v3, v3, v2
v_cndmask_b32 v211, v8, v3, vcc
s_mov_b32 s64, 786432
s_mov_b32 s65, 196608
s_waitcnt vmcnt(8)
s_mov_b32 s12, s78
s_mov_b32 s13, s79
s_mov_b32 s14, 0x4
s_mov_b32 s15, 0x20000
v_mov_b32 v27, 0
s_cmp_lg_u32 s39, 0
s_cbranch_scc1 F_T1
v_and_b32 v1, 15, v0
v_lshlrev_b32 v1, 2, v1
ds_write_b32 v1, v27
v_bfe_u32 v4, v76, 3, 9
v_lshrrev_b32 v8, 5, v4
v_lshlrev_b32 v8, 2, v8
v_and_b32 v4, 31, v4
v_lshlrev_b32_e64 v4, v4, 1
v_bfe_u32 v5, v77, 3, 9
v_lshrrev_b32 v9, 5, v5
v_lshlrev_b32 v9, 2, v9
v_and_b32 v5, 31, v5
v_lshlrev_b32_e64 v5, v5, 1
v_bfe_u32 v6, v78, 3, 9
v_lshrrev_b32 v10, 5, v6
v_lshlrev_b32 v10, 2, v10
v_and_b32 v6, 31, v6
v_lshlrev_b32_e64 v6, v6, 1
v_bfe_u32 v7, v79, 3, 9
v_lshrrev_b32 v11, 5, v7
v_lshlrev_b32 v11, 2, v11
v_and_b32 v7, 31, v7
v_lshlrev_b32_e64 v7, v7, 1
ds_or_b32 v8, v4
ds_or_b32 v9, v5
ds_or_b32 v10, v6
ds_or_b32 v11, v7
ds_read_b32 v2, v1
s_waitcnt lgkmcnt(0)
v_not_b32 v2, v2
v_ffbl_b32 v2, v2
v_cmp_ne_u32 vcc, -1, v2
s_nop 4
s_ff1_i32_b64 s66, vcc
s_nop 1
v_readlane_b32 s67, v2, s66
s_nop 4
s_lshl_b32 s66, s66, 5
s_add_u32 s66, s66, s67
s_lshl_b32 s66, s66, 3
s_or_b32 s66, s66, 0x40000000
v_mov_b32 v26, s66
s_mov_b64 exec, 1
buffer_store_dword v26, v27, s[12:15], 0 offen sc1
s_mov_b64 exec, -1
F_T1:
v_lshlrev_b32 v80, 16, v64
v_and_b32 v81, 0xffff0000, v64
v_lshlrev_b32 v82, 16, v65
v_and_b32 v83, 0xffff0000, v65
v_lshlrev_b32 v84, 16, v66
v_and_b32 v85, 0xffff0000, v66
v_lshlrev_b32 v86, 16, v67
v_and_b32 v87, 0xffff0000, v67
v_lshlrev_b32 v88, 16, v68
v_and_b32 v89, 0xffff0000, v68
v_lshlrev_b32 v90, 16, v69
v_and_b32 v91, 0xffff0000, v69
v_lshlrev_b32 v92, 16, v70
v_and_b32 v93, 0xffff0000, v70
v_lshlrev_b32 v94, 16, v71
v_and_b32 v95, 0xffff0000, v71
v_lshlrev_b32 v96, 16, v72
v_and_b32 v97, 0xffff0000, v72
v_lshlrev_b32 v98, 16, v73
v_and_b32 v99, 0xffff0000, v73
v_add_f32 v10, v80, v81
v_add_f32 v11, v82, v83
v_add_f32 v10, v10, v84
v_add_f32 v11, v11, v85
v_add_f32 v10, v10, v86
v_add_f32 v11, v11, v87
v_add_f32 v10, v10, v88
v_add_f32 v11, v11, v89
v_add_f32 v10, v10, v90
v_add_f32 v11, v11, v91
v_add_f32 v10, v10, v92
v_add_f32 v11, v11, v93
v_add_f32 v10, v10, v94
v_add_f32 v11, v11, v95
v_add_f32 v10, v10, v96
v_add_f32 v11, v11, v97
v_add_f32 v10, v10, v98
v_add_f32 v11, v11, v99
v_add_f32 v10, v10, v11
s_nop 1
v_add_f32_dpp v10, v10, v10 row_ror:8 row_mask:0xf bank_mask:0xf
s_nop 1
v_add_f32_dpp v10, v10, v10 row_ror:4 row_mask:0xf bank_mask:0xf
s_nop 1
v_add_f32_dpp v10, v10, v10 row_ror:2 row_mask:0xf bank_mask:0xf
s_nop 1
v_add_f32_dpp v10, v10, v10 row_ror:1 row_mask:0xf bank_mask:0xf
v_mov_b32 v11, v10
s_nop 1
v_permlane16_swap_b32 v10, v11
v_add_f32 v10, v10, v11
s_mov_b32 s66, 0x3acccccd
v_mul_f32 v10, s66, v10
v_mov_b32 v11, 0
v_mov_b32 v12, 0
v_sub_f32 v1, v80, v10
v_sub_f32 v2, v81, v10
v_fmac_f32 v11, v1, v1
v_fmac_f32 v12, v2, v2
v_sub_f32 v1, v82, v10
v_sub_f32 v2, v83, v10
v_fmac_f32 v11, v1, v1
v_fmac_f32 v12, v2, v2
v_sub_f32 v1, v84, v10
v_sub_f32 v2, v85, v10
v_fmac_f32 v11, v1, v1
v_fmac_f32 v12, v2, v2
v_sub_f32 v1, v86, v10
v_sub_f32 v2, v87, v10
v_fmac_f32 v11, v1, v1
v_fmac_f32 v12, v2, v2
v_sub_f32 v1, v88, v10
v_sub_f32 v2, v89, v10
v_fmac_f32 v11, v1, v1
v_fmac_f32 v12, v2, v2
v_sub_f32 v1, v90, v10
v_sub_f32 v2, v91, v10
v_fmac_f32 v11, v1, v1
v_fmac_f32 v12, v2, v2
v_sub_f32 v1, v92, v10
v_sub_f32 v2, v93, v10
v_fmac_f32 v11, v1, v1
v_fmac_f32 v12, v2, v2
v_sub_f32 v1, v94, v10
v_sub_f32 v2, v95, v10
v_fmac_f32 v11, v1, v1
v_fmac_f32 v12, v2, v2
v_sub_f32 v1, v96, v10
v_sub_f32 v2, v97, v10
v_fmac_f32 v11, v1, v1
v_fmac_f32 v12, v2, v2
v_sub_f32 v1, v98, v10
v_sub_f32 v2, v99, v10
v_fmac_f32 v11, v1, v1
v_fmac_f32 v12, v2, v2
v_add_f32 v11, v11, v12
s_nop 1
v_add_f32_dpp v11, v11, v11 row_ror:8 row_mask:0xf bank_mask:0xf
s_nop 1
v_add_f32_dpp v11, v11, v11 row_ror:4 row_mask:0xf bank_mask:0xf
s_nop 1
v_add_f32_dpp v11, v11, v11 row_ror:2 row_mask:0xf bank_mask:0xf
s_nop 1
v_add_f32_dpp v11, v11, v11 row_ror:1 row_mask:0xf bank_mask:0xf
v_mov_b32 v12, v11
s_nop 1
v_permlane16_swap_b32 v11, v12
v_add_f32 v11, v11, v12
v_mul_f32 v11, s66, v11
v_cvt_pk_bf16_f32 v10, v10, v11
v_and_b32 v11, 0xffff0000, v10
v_lshlrev_b32 v10, 16, v10
v_add_f32 v11, 0x3727c5ac, v11
v_cvt_pk_bf16_f32 v11, v11, v11
v_lshlrev_b32 v11, 16, v11
v_sqrt_f32 v11, v11
s_nop 0
v_cvt_pk_bf16_f32 v11, v11, v11
v_lshlrev_b32 v11, 16, v11
v_rcp_f32 v11, v11
s_nop 0
v_sub_f32 v80, v80, v10
v_sub_f32 v81, v81, v10
v_cvt_pk_bf16_f32 v1, v80, v81
v_lshlrev_b32 v80, 16, v1
v_and_b32 v81, 0xffff0000, v1
v_mul_f32 v80, v80, v11
v_mul_f32 v81, v81, v11
v_cvt_pk_bf16_f32 v64, v80, v81
v_sub_f32 v82, v82, v10
v_sub_f32 v83, v83, v10
v_cvt_pk_bf16_f32 v1, v82, v83
v_lshlrev_b32 v82, 16, v1
v_and_b32 v83, 0xffff0000, v1
v_mul_f32 v82, v82, v11
v_mul_f32 v83, v83, v11
v_cvt_pk_bf16_f32 v65, v82, v83
s_mov_b32 s66, 0
buffer_store_dwordx2 v[64:65], v13, s[16:19], s66 offen sc1
v_sub_f32 v84, v84, v10
v_sub_f32 v85, v85, v10
v_cvt_pk_bf16_f32 v1, v84, v85
v_lshlrev_b32 v84, 16, v1
v_and_b32 v85, 0xffff0000, v1
v_mul_f32 v84, v84, v11
v_mul_f32 v85, v85, v11
v_cvt_pk_bf16_f32 v66, v84, v85
v_sub_f32 v86, v86, v10
v_sub_f32 v87, v87, v10
v_cvt_pk_bf16_f32 v1, v86, v87
v_lshlrev_b32 v86, 16, v1
v_and_b32 v87, 0xffff0000, v1
v_mul_f32 v86, v86, v11
v_mul_f32 v87, v87, v11
v_cvt_pk_bf16_f32 v67, v86, v87
s_mov_b32 s66, 16384
buffer_store_dwordx2 v[66:67], v13, s[16:19], s66 offen sc1
v_sub_f32 v88, v88, v10
v_sub_f32 v89, v89, v10
v_cvt_pk_bf16_f32 v1, v88, v89
v_lshlrev_b32 v88, 16, v1
v_and_b32 v89, 0xffff0000, v1
v_mul_f32 v88, v88, v11
v_mul_f32 v89, v89, v11
v_cvt_pk_bf16_f32 v68, v88, v89
v_sub_f32 v90, v90, v10
v_sub_f32 v91, v91, v10
v_cvt_pk_bf16_f32 v1, v90, v91
v_lshlrev_b32 v90, 16, v1
v_and_b32 v91, 0xffff0000, v1
v_mul_f32 v90, v90, v11
v_mul_f32 v91, v91, v11
v_cvt_pk_bf16_f32 v69, v90, v91
s_mov_b32 s66, 32768
buffer_store_dwordx2 v[68:69], v13, s[16:19], s66 offen sc1
v_sub_f32 v92, v92, v10
v_sub_f32 v93, v93, v10
v_cvt_pk_bf16_f32 v1, v92, v93
v_lshlrev_b32 v92, 16, v1
v_and_b32 v93, 0xffff0000, v1
v_mul_f32 v92, v92, v11
v_mul_f32 v93, v93, v11
v_cvt_pk_bf16_f32 v70, v92, v93
v_sub_f32 v94, v94, v10
v_sub_f32 v95, v95, v10
v_cvt_pk_bf16_f32 v1, v94, v95
v_lshlrev_b32 v94, 16, v1
v_and_b32 v95, 0xffff0000, v1
v_mul_f32 v94, v94, v11
v_mul_f32 v95, v95, v11
v_cvt_pk_bf16_f32 v71, v94, v95
s_mov_b32 s66, 49152
buffer_store_dwordx2 v[70:71], v13, s[16:19], s66 offen sc1
v_sub_f32 v96, v96, v10
v_sub_f32 v97, v97, v10
v_cvt_pk_bf16_f32 v1, v96, v97
v_lshlrev_b32 v96, 16, v1
v_and_b32 v97, 0xffff0000, v1
v_mul_f32 v96, v96, v11
v_mul_f32 v97, v97, v11
v_cvt_pk_bf16_f32 v72, v96, v97
v_sub_f32 v98, v98, v10
v_sub_f32 v99, v99, v10
v_cvt_pk_bf16_f32 v1, v98, v99
v_lshlrev_b32 v98, 16, v1
v_and_b32 v99, 0xffff0000, v1
v_mul_f32 v98, v98, v11
v_mul_f32 v99, v99, v11
v_cvt_pk_bf16_f32 v73, v98, v99
s_mov_b32 s66, 65536
buffer_store_dwordx2 v[72:73], v13, s[16:19], s66 offen sc1
v_lshrrev_b32 v1, 4, v0
v_lshrrev_b32 v2, 2, v0
v_and_b32 v2, 3, v2
v_and_b32 v3, 3, v0
v_and_b32 v5, 1, v1
v_lshlrev_b32 v4, 1, v2
v_lshl_or_b32 v4, v5, 3, v4
v_lshl_add_u32 v6, v1, 3, v2
v_lshlrev_b32 v6, 8, v6
v_add_u32 v6, 65536, v6
v_lshrrev_b32 v7, 1, v3
v_or_b32 v8, 0, v3
v_xor_b32 v8, v8, v4
v_lshl_add_u32 v8, v8, 4, v6
v_xor_b32 v9, 0, v7
v_lshl_add_u32 v192, v9, 3, v8
v_or_b32 v8, 0, v3
v_xor_b32 v8, v8, v4
v_lshl_add_u32 v8, v8, 4, v6
v_xor_b32 v9, 1, v7
v_lshl_add_u32 v193, v9, 3, v8
v_or_b32 v8, 4, v3
v_xor_b32 v8, v8, v4
v_lshl_add_u32 v8, v8, 4, v6
v_xor_b32 v9, 0, v7
v_lshl_add_u32 v194, v9, 3, v8
v_or_b32 v8, 4, v3
v_xor_b32 v8, v8, v4
v_lshl_add_u32 v8, v8, 4, v6
v_xor_b32 v9, 1, v7
v_lshl_add_u32 v195, v9, 3, v8
v_or_b32 v8, 8, v3
v_xor_b32 v8, v8, v4
v_lshl_add_u32 v8, v8, 4, v6
v_xor_b32 v9, 0, v7
v_lshl_add_u32 v196, v9, 3, v8
v_or_b32 v8, 8, v3
v_xor_b32 v8, v8, v4
v_lshl_add_u32 v8, v8, 4, v6
v_xor_b32 v9, 1, v7
v_lshl_add_u32 v197, v9, 3, v8
v_or_b32 v8, 12, v3
v_xor_b32 v8, v8, v4
v_lshl_add_u32 v8, v8, 4, v6
v_xor_b32 v9, 0, v7
v_lshl_add_u32 v198, v9, 3, v8
v_or_b32 v8, 12, v3
v_xor_b32 v8, v8, v4
v_lshl_add_u32 v8, v8, 4, v6
v_xor_b32 v9, 1, v7
v_lshl_add_u32 v199, v9, 3, v8
v_and_b32 v4, 2, v2
v_lshl_or_b32 v4, v5, 2, v4
v_lshl_add_u32 v6, v5, 3, v2
v_lshlrev_b32 v6, 7, v6
v_lshrrev_b32 v8, 1, v1
v_lshl_add_u32 v6, v8, 12, v6
v_add_u32 v6, 114688, v6
v_or_b32 v8, 0, v3
v_xor_b32 v8, v8, v4
v_lshl_add_u32 v8, v8, 4, v6
v_xor_b32 v9, 0, v7
v_lshl_add_u32 v200, v9, 3, v8
v_or_b32 v8, 0, v3
v_xor_b32 v8, v8, v4
v_lshl_add_u32 v8, v8, 4, v6
v_xor_b32 v9, 1, v7
v_lshl_add_u32 v201, v9, 3, v8
v_or_b32 v8, 4, v3
v_xor_b32 v8, v8, v4
v_lshl_add_u32 v8, v8, 4, v6
v_xor_b32 v9, 0, v7
v_lshl_add_u32 v202, v9, 3, v8
v_or_b32 v8, 4, v3
v_xor_b32 v8, v8, v4
v_lshl_add_u32 v8, v8, 4, v6
v_xor_b32 v9, 1, v7
v_lshl_add_u32 v203, v9, 3, v8
v_add_u32 v6, 2048, v6
v_lshl_add_u32 v6, v3, 3, v6
v_xor_b32 v8, 0, v4
v_lshl_add_u32 v204, v8, 4, v6
v_xor_b32 v8, 2, v4
v_lshl_add_u32 v205, v8, 4, v6
v_xor_b32 v8, 4, v4
v_lshl_add_u32 v206, v8, 4, v6
s_cmp_lg_u32 s36, 0
s_cbranch_scc1 F_W4
v_readfirstlane_b32 s62, v75
s_mov_b32 s67, 0
F_P2:
buffer_load_dword v26, v27, s[12:15], 0 offen sc1
s_waitcnt vmcnt(0)
v_readfirstlane_b32 s84, v26
s_add_u32 s67, s67, 1
s_cmp_gt_u32 s67, 262144
s_cbranch_scc1 F_D3
s_cmp_eq_u32 s84, 0
s_cbranch_scc1 F_P2
s_xor_b32 s66, s84, s62
s_bfe_u32 s66, s66, 0x90003
s_cmp_eq_u32 s66, 0
s_cbranch_scc1 F_P2
F_D3:
F_W4:
s_waitcnt vmcnt(0)
s_barrier
s_cmp_lg_u32 s36, 0
s_cbranch_scc1 F_W5
s_add_u32 s66, s84, 1
s_lshl_b32 s67, s85, 5
s_add_u32 s67, s67, s37
s_lshl_b32 s67, s67, 2
v_mov_b32 v4, s66
v_mov_b32 v5, 0
s_mov_b64 exec, 1
buffer_store_dword v4, v5, s[80:83], s67 offen sc1
s_mov_b64 exec, -1
F_W5:
s_mov_b32 m0, s50
s_nop 0
buffer_load_dwordx4 v40, s[20:23], s54 offen offset:0 lds
buffer_load_dwordx4 v41, s[20:23], s54 offen offset:1024 lds
buffer_load_dwordx4 v42, s[20:23], s54 offen offset:2048 lds
buffer_load_dwordx4 v43, s[20:23], s54 offen offset:3072 lds
s_mov_b32 m0, s51
s_nop 0
buffer_load_dwordx4 v44, s[20:23], s54 offen offset:0 lds
buffer_load_dwordx4 v45, s[20:23], s54 offen offset:1024 lds
buffer_load_dwordx4 v46, s[24:27], s55 offen offset:2048 lds
buffer_load_dwordx4 v47, s[24:27], s55 offen offset:3072 lds
s_add_u32 s54, s54, 786432
s_add_u32 s55, s55, 196608
s_mov_b32 m0, s52
s_nop 0
buffer_load_dwordx4 v40, s[20:23], s54 offen offset:0 lds
buffer_load_dwordx4 v41, s[20:23], s54 offen offset:1024 lds
buffer_load_dwordx4 v42, s[20:23], s54 offen offset:2048 lds
buffer_load_dwordx4 v43, s[20:23], s54 offen offset:3072 lds
v_lshrrev_b32 v1, 3, v0
v_and_b32 v2, 7, v0
s_mul_i32 s62, s36, 3072
s_lshl_b32 s66, s36, 2
v_add_u32 v3, 0, v1
v_mul_u32_u24 v4, 171, v3
v_lshrrev_b32 v4, 9, v4
v_lshrrev_b32 v5, 1, v4
v_add_u32 v6, s66, v5
v_and_b32 v6, 7, v6
v_xor_b32 v6, v2, v6
v_lshlrev_b32 v7, 7, v1
v_add_u32 v7, s62, v7
v_lshl_add_u32 v246, v6, 4, v7
v_and_b32 v5, 3, v5
v_lshlrev_b32 v5, 1, v5
v_xor_b32 v5, v2, v5
v_lshl_add_u32 v249, v5, 4, v7
v_add_u32 v3, 8, v1
v_mul_u32_u24 v4, 171, v3
v_lshrrev_b32 v4, 9, v4
v_lshrrev_b32 v5, 1, v4
v_add_u32 v6, s66, v5
v_and_b32 v6, 7, v6
v_xor_b32 v6, v2, v6
v_lshlrev_b32 v7, 7, v1
v_add_u32 v7, s62, v7
v_lshl_add_u32 v247, v6, 4, v7
v_and_b32 v5, 3, v5
v_lshlrev_b32 v5, 1, v5
v_xor_b32 v5, v2, v5
v_lshl_add_u32 v250, v5, 4, v7
v_add_u32 v3, 16, v1
v_mul_u32_u24 v4, 171, v3
v_lshrrev_b32 v4, 9, v4
v_lshrrev_b32 v5, 1, v4
v_add_u32 v6, s66, v5
v_and_b32 v6, 7, v6
v_xor_b32 v6, v2, v6
v_lshlrev_b32 v7, 7, v1
v_add_u32 v7, s62, v7
v_lshl_add_u32 v248, v6, 4, v7
v_and_b32 v5, 3, v5
v_lshlrev_b32 v5, 1, v5
v_xor_b32 v5, v2, v5
v_lshl_add_u32 v251, v5, 4, v7
s_add_u32 s40, s62, 0
s_add_u32 s44, s62, 49152
s_add_u32 s41, s62, 12288
s_add_u32 s45, s62, 61440
s_add_u32 s42, s62, 24576
s_add_u32 s46, s62, 73728
s_add_u32 s43, s62, 36864
s_add_u32 s47, s62, 86016
v_and_b32 v3, 6, v1
v_xor_b32 v3, v2, v3
v_mul_u32_u24 v4, 1280, v1
v_lshl_add_u32 v4, v3, 4, v4
s_mul_i32 s66, s36, 10240
v_add_u32 v254, s66, v4
s_mul_i32 s66, s38, 81920
s_add_u32 s28, s70, s66
s_addc_u32 s29, s71, 0
s_mov_b32 s30, 0x14000
s_mov_b32 s31, 0x20000
v_and_b32 v1, 15, v0
v_lshrrev_b32 v2, 4, v0
v_lshlrev_b32 v1, 6, v1
v_lshl_add_u32 v207, v2, 4, v1
v_add_u32 v209, 4096, v207
v_lshrrev_b32 v3, 1, v2
v_and_b32 v2, 1, v2
v_lshrrev_b32 v1, 2, v1
v_lshl_add_u32 v1, v3, 8, v1
v_lshl_add_u32 v208, v2, 3, v1
s_mov_b32 s56, 0
s_mul_i32 s66, s37, 786432
s_add_u32 s12, s6, s66
s_addc_u32 s13, s7, 0
s_mov_b32 s14, 0xc0000
s_mov_b32 s15, 0x20000
s_add_u32 s16, s8, s66
s_addc_u32 s17, s9, 0
s_mov_b32 s18, 0xc0000
s_mov_b32 s19, 0x20000
s_cmp_lt_u32 s2, 192
s_cselect_b32 s8, s68, s74
s_cselect_b32 s9, s69, s75
s_cselect_b32 s66, 0, 192
s_sub_u32 s66, s2, s66
s_mul_i32 s66, s66, 40960
s_add_u32 s8, s8, s66
s_addc_u32 s9, s9, 0
s_cmp_lt_u32 s2, 240
s_cselect_b32 s10, 40960, 0
s_mov_b32 s11, 0x20000
s_mul_i32 s66, s38, 983040
s_add_u32 s66, s66, 0x1000000
s_add_u32 s32, s70, s66
s_addc_u32 s33, s71, 0
s_mov_b32 s34, 0xf0000
s_mov_b32 s35, 0x20000
s_mov_b32 s58, 0x3dd53b95
s_mov_b32 s59, 0x3dd53b95
s_mov_b32 s60, 0x4e800000
s_mul_i32 s61, s37, 24576
s_mul_i32 s66, s37, 3
s_add_u32 s66, s66, 0
s_and_b32 s67, s66, 1
s_lshl_b32 s67, s67, 9
s_lshr_b32 s66, s66, 1
s_add_u32 s66, s66, 192
s_lshl_b32 s66, s66, 12
s_add_u32 s6, s66, s67
s_mul_i32 s66, s37, 3
s_add_u32 s66, s66, 1
s_and_b32 s67, s66, 1
s_lshl_b32 s67, s67, 9
s_lshr_b32 s66, s66, 1
s_add_u32 s66, s66, 192
s_lshl_b32 s66, s66, 12
s_add_u32 s7, s66, s67
s_mul_i32 s66, s37, 3
s_add_u32 s66, s66, 2
s_and_b32 s67, s66, 1
s_lshl_b32 s67, s67, 9
s_lshr_b32 s66, s66, 1
s_add_u32 s66, s66, 192
s_lshl_b32 s66, s66, 12
s_add_u32 s62, s66, s67
v_lshrrev_b32 v1, 4, v0
v_and_b32 v3, 3, v0
v_lshrrev_b32 v5, 2, v0
v_mul_u32_u24 v6, 384, v5
v_add_u32 v6, 49152, v6
v_lshl_add_u32 v6, v3, 3, v6
v_lshrrev_b32 v5, 1, v5
v_and_b32 v5, 3, v5
v_lshlrev_b32 v5, 1, v5
v_xor_b32 v8, 0, v5
v_lshl_add_u32 v242, v8, 4, v6
v_xor_b32 v8, 2, v5
v_lshl_add_u32 v243, v8, 4, v6
v_xor_b32 v8, 4, v5
v_lshl_add_u32 v244, v8, 4, v6
v_xor_b32 v8, 6, v5
v_lshl_add_u32 v245, v8, 4, v6
v_and_b32 v2, 15, v0
v_mul_u32_u24 v6, 384, v2
v_lshrrev_b32 v2, 1, v2
v_xor_b32 v2, v2, v1
v_lshl_add_u32 v240, v2, 4, v6
v_xor_b32 v2, 4, v2
v_lshl_add_u32 v241, v2, 4, v6
s_mov_b32 s67, 121856
v_lshrrev_b32 v1, 2, v0
v_and_b32 v1, 7, v1
v_lshlrev_b32 v2, 7, v1
v_lshrrev_b32 v3, 5, v0
v_mul_u32_u24 v3, 10240, v3
v_add_u32 v2, v2, v3
v_and_b32 v3, 3, v0
v_lshl_add_u32 v2, v3, 3, v2
v_add_u32 v2, 121856, v2
v_lshrrev_b32 v1, 1, v1
v_lshlrev_b32 v1, 5, v1
s_lshl_b32 s66, s36, 5
v_xor_b32 v1, s66, v1
v_add_u32 v4, v1, v2
v_lshrrev_b32 v1, 4, v0
v_mul_u32_u24 v1, 10240, v1
v_bfe_u32 v2, v0, 2, 2
v_lshl_add_u32 v1, v2, 7, v1
v_lshl_add_u32 v1, v3, 3, v1
v_lshrrev_b32 v2, 1, v2
v_lshlrev_b32 v2, 5, v2
v_xor_b32 v2, s66, v2
v_add3_u32 v1, v1, v2, s67
s_cmp_lt_u32 s2, 192
s_cselect_b64 vcc, -1, 0
v_cndmask_b32 v255, v1, v4, vcc
s_lshl_b32 s66, s85, 2
s_add_u32 s66, s66, s36
s_mul_i32 s66, s66, 1536
v_lshlrev_b32 v3, 7, v0
v_add_u32 v3, s66, v3
v_cmp_gt_u32 vcc, 12, v0
v_bfrev_b32 v2, 1
s_nop 0
v_cndmask_b32 v252, v2, v3, vcc
s_lshl_b32 s66, s85, 3
s_lshl_b32 s67, s36, 1
s_add_u32 s66, s66, s67
s_mov_b32 s67, 12288
v_mul_u32_u24 v1, 171, v0
v_lshrrev_b32 v1, 9, v1
v_mul_u32_u24 v2, 3, v1
v_sub_u32 v2, v0, v2
v_lshrrev_b32 v3, 1, v1
v_and_b32 v1, 1, v1
v_lshl_add_u32 v1, v3, 6, v1
v_add_u32 v1, s66, v1
v_mul_lo_u32 v1, v1, s67
v_lshl_add_u32 v1, v2, 7, v1
v_cmp_gt_u32 vcc, 6, v0
v_bfrev_b32 v8, 1
v_lshrrev_b32 v3, 2, v0
v_bfe_u32 v2, v0, 1, 1
v_cndmask_b32 v210, v8, v1, vcc
v_lshl_add_u32 v3, v3, 6, v2
v_add_u32 v3, s66, v3
v_cmp_gt_u32 vcc, 4, v0
v_mul_u32_u24 v3, 3072, v3
v_and_b32 v2, 1, v0
v_mul_u32_u24 v2, 92, v2
v_add_u32 v3, v3, v2
v_cndmask_b32 v211, v8, v3, vcc
s_mov_b32 s64, 2359296
s_mov_b32 s65, 589824
v_accvgpr_write_b32 a0, 0
v_accvgpr_write_b32 a1, 0
v_accvgpr_write_b32 a2, 0
v_accvgpr_write_b32 a3, 0
v_accvgpr_write_b32 a4, 0
v_accvgpr_write_b32 a5, 0
v_accvgpr_write_b32 a6, 0
v_accvgpr_write_b32 a7, 0
v_accvgpr_write_b32 a8, 0
v_accvgpr_write_b32 a9, 0
v_accvgpr_write_b32 a10, 0
v_accvgpr_write_b32 a11, 0
v_accvgpr_write_b32 a12, 0
v_accvgpr_write_b32 a13, 0
v_accvgpr_write_b32 a14, 0
v_accvgpr_write_b32 a15, 0
v_accvgpr_write_b32 a16, 0
v_accvgpr_write_b32 a17, 0
v_accvgpr_write_b32 a18, 0
v_accvgpr_write_b32 a19, 0
v_accvgpr_write_b32 a20, 0
v_accvgpr_write_b32 a21, 0
v_accvgpr_write_b32 a22, 0
v_accvgpr_write_b32 a23, 0
v_accvgpr_write_b32 a24, 0
v_accvgpr_write_b32 a25, 0
v_accvgpr_write_b32 a26, 0
v_accvgpr_write_b32 a27, 0
v_accvgpr_write_b32 a28, 0
v_accvgpr_write_b32 a29, 0
v_accvgpr_write_b32 a30, 0
v_accvgpr_write_b32 a31, 0
v_accvgpr_write_b32 a32, 0
v_accvgpr_write_b32 a33, 0
v_accvgpr_write_b32 a34, 0
v_accvgpr_write_b32 a35, 0
v_accvgpr_write_b32 a36, 0
v_accvgpr_write_b32 a37, 0
v_accvgpr_write_b32 a38, 0
v_accvgpr_write_b32 a39, 0
v_accvgpr_write_b32 a40, 0
v_accvgpr_write_b32 a41, 0
v_accvgpr_write_b32 a42, 0
v_accvgpr_write_b32 a43, 0
v_accvgpr_write_b32 a44, 0
v_accvgpr_write_b32 a45, 0
v_accvgpr_write_b32 a46, 0
v_accvgpr_write_b32 a47, 0
v_accvgpr_write_b32 a48, 0
v_accvgpr_write_b32 a49, 0
v_accvgpr_write_b32 a50, 0
v_accvgpr_write_b32 a51, 0
v_accvgpr_write_b32 a52, 0
v_accvgpr_write_b32 a53, 0
v_accvgpr_write_b32 a54, 0
v_accvgpr_write_b32 a55, 0
v_accvgpr_write_b32 a56, 0
v_accvgpr_write_b32 a57, 0
v_accvgpr_write_b32 a58, 0
v_accvgpr_write_b32 a59, 0
v_accvgpr_write_b32 a60, 0
v_accvgpr_write_b32 a61, 0
v_accvgpr_write_b32 a62, 0
v_accvgpr_write_b32 a63, 0
v_accvgpr_write_b32 a64, 0
v_accvgpr_write_b32 a65, 0
v_accvgpr_write_b32 a66, 0
v_accvgpr_write_b32 a67, 0
v_accvgpr_write_b32 a68, 0
v_accvgpr_write_b32 a69, 0
v_accvgpr_write_b32 a70, 0
v_accvgpr_write_b32 a71, 0
v_accvgpr_write_b32 a72, 0
v_accvgpr_write_b32 a73, 0
v_accvgpr_write_b32 a74, 0
v_accvgpr_write_b32 a75, 0
v_accvgpr_write_b32 a76, 0
v_accvgpr_write_b32 a77, 0
v_accvgpr_write_b32 a78, 0
v_accvgpr_write_b32 a79, 0
v_accvgpr_write_b32 a80, 0
v_accvgpr_write_b32 a81, 0
v_accvgpr_write_b32 a82, 0
v_accvgpr_write_b32 a83, 0
v_accvgpr_write_b32 a84, 0
v_accvgpr_write_b32 a85, 0
v_accvgpr_write_b32 a86, 0
v_accvgpr_write_b32 a87, 0
v_accvgpr_write_b32 a88, 0
v_accvgpr_write_b32 a89, 0
v_accvgpr_write_b32 a90, 0
v_accvgpr_write_b32 a91, 0
v_accvgpr_write_b32 a92, 0
v_accvgpr_write_b32 a93, 0
v_accvgpr_write_b32 a94, 0
v_accvgpr_write_b32 a95, 0
v_mov_b32 v48, 0
v_mov_b32 v49, 0
v_mov_b32 v50, 0
v_mov_b32 v51, 0
v_mov_b32 v52, 0
v_mov_b32 v53, 0
v_mov_b32 v54, 0
v_mov_b32 v55, 0
v_mov_b32 v56, 0
v_mov_b32 v57, 0
v_mov_b32 v58, 0
v_mov_b32 v59, 0
v_mov_b32 v60, 0
v_mov_b32 v61, 0
v_mov_b32 v62, 0
v_mov_b32 v63, 0
v_mov_b32 v64, 0
v_mov_b32 v65, 0
v_mov_b32 v66, 0
v_mov_b32 v67, 0
v_mov_b32 v68, 0
v_mov_b32 v69, 0
v_mov_b32 v70, 0
v_mov_b32 v71, 0
v_mov_b32 v72, 0
v_mov_b32 v73, 0
v_mov_b32 v74, 0
v_mov_b32 v75, 0
v_mov_b32 v76, 0
v_mov_b32 v77, 0
v_mov_b32 v78, 0
v_mov_b32 v79, 0
v_mov_b32 v80, 0
v_mov_b32 v81, 0
v_mov_b32 v82, 0
v_mov_b32 v83, 0
v_mov_b32 v84, 0
v_mov_b32 v85, 0
v_mov_b32 v86, 0
v_mov_b32 v87, 0
v_mov_b32 v88, 0
v_mov_b32 v89, 0
v_mov_b32 v90, 0
v_mov_b32 v91, 0
v_mov_b32 v92, 0
v_mov_b32 v93, 0
v_mov_b32 v94, 0
v_mov_b32 v95, 0
v_mov_b32 v96, 0
v_mov_b32 v97, 0
v_mov_b32 v98, 0
v_mov_b32 v99, 0
v_mov_b32 v100, 0
v_mov_b32 v101, 0
v_mov_b32 v102, 0
v_mov_b32 v103, 0
v_mov_b32 v104, 0
v_mov_b32 v105, 0
v_mov_b32 v106, 0
v_mov_b32 v107, 0
v_mov_b32 v108, 0
v_mov_b32 v109, 0
v_mov_b32 v110, 0
v_mov_b32 v111, 0
v_mov_b32 v112, 0
v_mov_b32 v113, 0
v_mov_b32 v114, 0
v_mov_b32 v115, 0
v_mov_b32 v116, 0
v_mov_b32 v117, 0
v_mov_b32 v118, 0
v_mov_b32 v119, 0
v_mov_b32 v120, 0
v_mov_b32 v121, 0
v_mov_b32 v122, 0
v_mov_b32 v123, 0
v_mov_b32 v124, 0
v_mov_b32 v125, 0
v_mov_b32 v126, 0
v_mov_b32 v127, 0
v_mov_b32 v128, 0
v_mov_b32 v129, 0
v_mov_b32 v130, 0
v_mov_b32 v131, 0
v_mov_b32 v132, 0
v_mov_b32 v133, 0
v_mov_b32 v134, 0
v_mov_b32 v135, 0
v_mov_b32 v136, 0
v_mov_b32 v137, 0
v_mov_b32 v138, 0
v_mov_b32 v139, 0
v_mov_b32 v140, 0
v_mov_b32 v141, 0
v_mov_b32 v142, 0
v_mov_b32 v143, 0
v_mov_b32 v144, 0
v_mov_b32 v145, 0
v_mov_b32 v146, 0
v_mov_b32 v147, 0
v_mov_b32 v148, 0
v_mov_b32 v149, 0
v_mov_b32 v150, 0
v_mov_b32 v151, 0
v_mov_b32 v152, 0
v_mov_b32 v153, 0
v_mov_b32 v154, 0
v_mov_b32 v155, 0
v_mov_b32 v156, 0
v_mov_b32 v157, 0
v_mov_b32 v158, 0
v_mov_b32 v159, 0
v_mov_b32 v160, 0
v_mov_b32 v161, 0
v_mov_b32 v162, 0
v_mov_b32 v163, 0
v_mov_b32 v164, 0
v_mov_b32 v165, 0
v_mov_b32 v166, 0
v_mov_b32 v167, 0
v_mov_b32 v168, 0
v_mov_b32 v169, 0
v_mov_b32 v170, 0
v_mov_b32 v171, 0
v_mov_b32 v172, 0
v_mov_b32 v173, 0
v_mov_b32 v174, 0
v_mov_b32 v175, 0
v_mov_b32 v176, 0
v_mov_b32 v177, 0
v_mov_b32 v178, 0
v_mov_b32 v179, 0
v_mov_b32 v180, 0
v_mov_b32 v181, 0
v_mov_b32 v182, 0
v_mov_b32 v183, 0
v_mov_b32 v184, 0
v_mov_b32 v185, 0
v_mov_b32 v186, 0
v_mov_b32 v187, 0
v_mov_b32 v188, 0
v_mov_b32 v189, 0
v_mov_b32 v190, 0
v_mov_b32 v191, 0
s_waitcnt vmcnt(0)
s_cmp_lg_u32 s36, 0
s_cbranch_scc1 F_W8
v_lshlrev_b32 v2, 2, v0
s_lshl_b32 s57, s85, 7
s_mov_b32 exec_lo, -1
s_mov_b32 exec_hi, 0
s_add_u32 s66, s84, 1
s_mov_b32 s67, 0
F_P6:
buffer_load_dword v4, v2, s[80:83], s57 offen sc1
s_waitcnt vmcnt(0)
v_subrev_u32 v4, s66, v4
v_cmp_lt_u32 vcc, 3, v4
s_add_u32 s67, s67, 1
s_cmp_gt_u32 s67, 262144
s_cbranch_scc1 F_D7
s_cbranch_vccnz F_P6
F_D7:
s_mov_b64 exec, -1
F_W8:
s_barrier
buffer_load_dwordx4 a[96:99], v207, s[28:31], s56 offen offset:0 sc1
buffer_load_dwordx4 a[100:103], v207, s[28:31], s56 offen offset:1024 sc1
buffer_load_dwordx4 a[104:107], v207, s[28:31], s56 offen offset:2048 sc1
buffer_load_dwordx4 a[108:111], v207, s[28:31], s56 offen offset:3072 sc1
buffer_load_dwordx4 a[112:115], v209, s[28:31], s56 offen offset:0 sc1
buffer_load_dwordx4 a[116:119], v209, s[28:31], s56 offen offset:1024 sc1
buffer_load_dwordx4 a[120:123], v209, s[28:31], s56 offen offset:2048 sc1
buffer_load_dwordx4 a[124:127], v209, s[28:31], s56 offen offset:3072 sc1
s_add_u32 s56, s56, 8192
buffer_load_dwordx4 a[128:131], v207, s[28:31], s56 offen offset:0 sc1
buffer_load_dwordx4 a[132:135], v207, s[28:31], s56 offen offset:1024 sc1
buffer_load_dwordx4 a[136:139], v207, s[28:31], s56 offen offset:2048 sc1
buffer_load_dwordx4 a[140:143], v207, s[28:31], s56 offen offset:3072 sc1
buffer_load_dwordx4 a[144:147], v209, s[28:31], s56 offen offset:0 sc1
buffer_load_dwordx4 a[148:151], v209, s[28:31], s56 offen offset:1024 sc1
buffer_load_dwordx4 a[152:155], v209, s[28:31], s56 offen offset:2048 sc1
buffer_load_dwordx4 a[156:159], v209, s[28:31], s56 offen offset:3072 sc1
s_add_u32 s56, s56, 8192
ds_read_b64_tr_b16 v[16:17], v192 offset:0
ds_read_b64_tr_b16 v[18:19], v192 offset:1024
ds_read_b64_tr_b16 v[20:21], v192 offset:8192
ds_read_b64_tr_b16 v[22:23], v192 offset:9216
ds_read_b64_tr_b16 v[24:25], v193 offset:0
ds_read_b64_tr_b16 v[26:27], v193 offset:1024
ds_read_b64_tr_b16 v[28:29], v193 offset:8192
ds_read_b64_tr_b16 v[30:31], v193 offset:9216
s_mov_b32 s57, 0
s_waitcnt vmcnt(8) lgkmcnt(4)
.p2align 6
F_QL:
v_mfma_f32_16x16x32_bf16 a[0:3], v[16:19], a[96:99], a[0:3]
ds_read_b64_tr_b16 v[32:33], v194 offset:0
v_mfma_f32_16x16x32_bf16 a[0:3], v[20:23], a[112:115], a[0:3]
ds_read_b64_tr_b16 v[34:35], v194 offset:1024
v_mfma_f32_16x16x32_bf16 a[4:7], v[16:19], a[100:103], a[4:7]
ds_read_b64_tr_b16 v[36:37], v194 offset:8192
v_mfma_f32_16x16x32_bf16 a[4:7], v[20:23], a[116:119], a[4:7]
ds_read_b64_tr_b16 v[38:39], v194 offset:9216
s_waitcnt lgkmcnt(4)
v_mfma_f32_16x16x32_bf16 a[8:11], v[16:19], a[104:107], a[8:11]
buffer_load_dwordx4 a[160:163], v207, s[28:31], s56 offen offset:0 sc1
v_mfma_f32_16x16x32_bf16 a[8:11], v[20:23], a[120:123], a[8:11]
v_mfma_f32_16x16x32_bf16 a[12:15], v[16:19], a[108:111], a[12:15]
buffer_load_dwordx4 a[164:167], v207, s[28:31], s56 offen offset:1024 sc1
v_mfma_f32_16x16x32_bf16 a[12:15], v[20:23], a[124:127], a[12:15]
v_mfma_f32_16x16x32_bf16 a[28:31], v[24:27], a[108:111], a[28:31]
ds_read_b64_tr_b16 v[16:17], v195 offset:0
v_mfma_f32_16x16x32_bf16 a[28:31], v[28:31], a[124:127], a[28:31]
ds_read_b64_tr_b16 v[18:19], v195 offset:1024
v_mfma_f32_16x16x32_bf16 a[24:27], v[24:27], a[104:107], a[24:27]
ds_read_b64_tr_b16 v[20:21], v195 offset:8192
v_mfma_f32_16x16x32_bf16 a[24:27], v[28:31], a[120:123], a[24:27]
ds_read_b64_tr_b16 v[22:23], v195 offset:9216
s_waitcnt lgkmcnt(4)
v_mfma_f32_16x16x32_bf16 a[20:23], v[24:27], a[100:103], a[20:23]
buffer_load_dwordx4 a[168:171], v207, s[28:31], s56 offen offset:2048 sc1
v_mfma_f32_16x16x32_bf16 a[20:23], v[28:31], a[116:119], a[20:23]
v_mfma_f32_16x16x32_bf16 a[16:19], v[24:27], a[96:99], a[16:19]
buffer_load_dwordx4 a[172:175], v207, s[28:31], s56 offen offset:3072 sc1
v_mfma_f32_16x16x32_bf16 a[16:19], v[28:31], a[112:115], a[16:19]
v_mfma_f32_16x16x32_bf16 a[32:35], v[32:35], a[96:99], a[32:35]
ds_read_b64_tr_b16 v[24:25], v196 offset:0
v_mfma_f32_16x16x32_bf16 a[32:35], v[36:39], a[112:115], a[32:35]
ds_read_b64_tr_b16 v[26:27], v196 offset:1024
v_mfma_f32_16x16x32_bf16 a[36:39], v[32:35], a[100:103], a[36:39]
ds_read_b64_tr_b16 v[28:29], v196 offset:8192
v_mfma_f32_16x16x32_bf16 a[36:39], v[36:39], a[116:119], a[36:39]
ds_read_b64_tr_b16 v[30:31], v196 offset:9216
s_waitcnt lgkmcnt(4)
v_mfma_f32_16x16x32_bf16 a[40:43], v[32:35], a[104:107], a[40:43]
buffer_load_dwordx4 a[176:179], v209, s[28:31], s56 offen offset:0 sc1
v_mfma_f32_16x16x32_bf16 a[40:43], v[36:39], a[120:123], a[40:43]
v_mfma_f32_16x16x32_bf16 a[44:47], v[32:35], a[108:111], a[44:47]
buffer_load_dwordx4 a[180:183], v209, s[28:31], s56 offen offset:1024 sc1
v_mfma_f32_16x16x32_bf16 a[44:47], v[36:39], a[124:127], a[44:47]
v_mfma_f32_16x16x32_bf16 a[60:63], v[16:19], a[108:111], a[60:63]
ds_read_b64_tr_b16 v[32:33], v197 offset:0
v_mfma_f32_16x16x32_bf16 a[60:63], v[20:23], a[124:127], a[60:63]
ds_read_b64_tr_b16 v[34:35], v197 offset:1024
v_mfma_f32_16x16x32_bf16 a[56:59], v[16:19], a[104:107], a[56:59]
ds_read_b64_tr_b16 v[36:37], v197 offset:8192
v_mfma_f32_16x16x32_bf16 a[56:59], v[20:23], a[120:123], a[56:59]
ds_read_b64_tr_b16 v[38:39], v197 offset:9216
s_waitcnt lgkmcnt(4)
v_mfma_f32_16x16x32_bf16 a[52:55], v[16:19], a[100:103], a[52:55]
buffer_load_dwordx4 a[184:187], v209, s[28:31], s56 offen offset:2048 sc1
v_mfma_f32_16x16x32_bf16 a[52:55], v[20:23], a[116:119], a[52:55]
v_mfma_f32_16x16x32_bf16 a[48:51], v[16:19], a[96:99], a[48:51]
buffer_load_dwordx4 a[188:191], v209, s[28:31], s56 offen offset:3072 sc1
v_mfma_f32_16x16x32_bf16 a[48:51], v[20:23], a[112:115], a[48:51]
v_mfma_f32_16x16x32_bf16 a[64:67], v[24:27], a[96:99], a[64:67]
ds_read_b64_tr_b16 v[16:17], v198 offset:0
v_mfma_f32_16x16x32_bf16 a[64:67], v[28:31], a[112:115], a[64:67]
ds_read_b64_tr_b16 v[18:19], v198 offset:1024
v_mfma_f32_16x16x32_bf16 a[68:71], v[24:27], a[100:103], a[68:71]
ds_read_b64_tr_b16 v[20:21], v198 offset:8192
v_mfma_f32_16x16x32_bf16 a[68:71], v[28:31], a[116:119], a[68:71]
ds_read_b64_tr_b16 v[22:23], v198 offset:9216
s_waitcnt lgkmcnt(4)
v_mfma_f32_16x16x32_bf16 a[72:75], v[24:27], a[104:107], a[72:75]
s_add_u32 s56, s56, 8192
v_mfma_f32_16x16x32_bf16 a[72:75], v[28:31], a[120:123], a[72:75]
v_mfma_f32_16x16x32_bf16 a[76:79], v[24:27], a[108:111], a[76:79]
buffer_load_dword v212, v210, s[20:23], s64 offen
v_mfma_f32_16x16x32_bf16 a[76:79], v[28:31], a[124:127], a[76:79]
v_mfma_f32_16x16x32_bf16 a[92:95], v[32:35], a[108:111], a[92:95]
ds_read_b64_tr_b16 v[24:25], v199 offset:0
v_mfma_f32_16x16x32_bf16 a[92:95], v[36:39], a[124:127], a[92:95]
ds_read_b64_tr_b16 v[26:27], v199 offset:1024
v_mfma_f32_16x16x32_bf16 a[88:91], v[32:35], a[104:107], a[88:91]
ds_read_b64_tr_b16 v[28:29], v199 offset:8192
v_mfma_f32_16x16x32_bf16 a[88:91], v[36:39], a[120:123], a[88:91]
ds_read_b64_tr_b16 v[30:31], v199 offset:9216
s_waitcnt lgkmcnt(4)
v_mfma_f32_16x16x32_bf16 a[84:87], v[32:35], a[100:103], a[84:87]
buffer_load_dword v212, v211, s[24:27], s65 offen offset:3072
v_mfma_f32_16x16x32_bf16 a[84:87], v[36:39], a[116:119], a[84:87]
s_add_u32 s64, s64, 786432
s_add_u32 s65, s65, 196608
v_mfma_f32_16x16x32_bf16 a[80:83], v[32:35], a[96:99], a[80:83]
s_mov_b32 m0, s53
v_mfma_f32_16x16x32_bf16 a[80:83], v[36:39], a[112:115], a[80:83]
s_waitcnt vmcnt(32)
s_barrier
v_mfma_f32_16x16x32_bf16 v[48:51], v[16:19], a[96:99], v[48:51]
ds_read_b64_tr_b16 v[32:33], v200 offset:0
v_mfma_f32_16x16x32_bf16 v[48:51], v[20:23], a[112:115], v[48:51]
ds_read_b64_tr_b16 v[34:35], v200 offset:512
v_mfma_f32_16x16x32_bf16 v[52:55], v[16:19], a[100:103], v[52:55]
ds_read_b64_tr_b16 v[36:37], v200 offset:8192
v_mfma_f32_16x16x32_bf16 v[52:55], v[20:23], a[116:119], v[52:55]
ds_read_b64_tr_b16 v[38:39], v200 offset:8704
s_waitcnt lgkmcnt(4)
v_mfma_f32_16x16x32_bf16 v[56:59], v[16:19], a[104:107], v[56:59]
buffer_load_dwordx4 v44, s[20:23], s54 offen offset:0 lds
v_mfma_f32_16x16x32_bf16 v[56:59], v[20:23], a[120:123], v[56:59]
v_mfma_f32_16x16x32_bf16 v[60:63], v[16:19], a[108:111], v[60:63]
buffer_load_dwordx4 v45, s[20:23], s54 offen offset:1024 lds
v_mfma_f32_16x16x32_bf16 v[60:63], v[20:23], a[124:127], v[60:63]
v_mfma_f32_16x16x32_bf16 v[76:79], v[24:27], a[108:111], v[76:79]
ds_read_b64_tr_b16 v[16:17], v201 offset:0
v_mfma_f32_16x16x32_bf16 v[76:79], v[28:31], a[124:127], v[76:79]
ds_read_b64_tr_b16 v[18:19], v201 offset:512
v_mfma_f32_16x16x32_bf16 v[72:75], v[24:27], a[104:107], v[72:75]
ds_read_b64_tr_b16 v[20:21], v201 offset:8192
v_mfma_f32_16x16x32_bf16 v[72:75], v[28:31], a[120:123], v[72:75]
ds_read_b64_tr_b16 v[22:23], v201 offset:8704
s_waitcnt lgkmcnt(4)
v_mfma_f32_16x16x32_bf16 v[68:71], v[24:27], a[100:103], v[68:71]
buffer_load_dwordx4 v46, s[24:27], s55 offen offset:2048 lds
v_mfma_f32_16x16x32_bf16 v[68:71], v[28:31], a[116:119], v[68:71]
v_mfma_f32_16x16x32_bf16 v[64:67], v[24:27], a[96:99], v[64:67]
buffer_load_dwordx4 v47, s[24:27], s55 offen offset:3072 lds
v_mfma_f32_16x16x32_bf16 v[64:67], v[28:31], a[112:115], v[64:67]
s_add_u32 s54, s54, 786432
s_add_u32 s55, s55, 196608
v_mfma_f32_16x16x32_bf16 v[80:83], v[32:35], a[96:99], v[80:83]
ds_read_b64_tr_b16 v[24:25], v202 offset:0
v_mfma_f32_16x16x32_bf16 v[80:83], v[36:39], a[112:115], v[80:83]
ds_read_b64_tr_b16 v[26:27], v202 offset:512
v_mfma_f32_16x16x32_bf16 v[84:87], v[32:35], a[100:103], v[84:87]
ds_read_b64_tr_b16 v[28:29], v202 offset:8192
v_mfma_f32_16x16x32_bf16 v[84:87], v[36:39], a[116:119], v[84:87]
ds_read_b64_tr_b16 v[30:31], v202 offset:8704
s_waitcnt lgkmcnt(4)
v_mfma_f32_16x16x32_bf16 v[88:91], v[32:35], a[104:107], v[88:91]
v_mfma_f32_16x16x32_bf16 v[88:91], v[36:39], a[120:123], v[88:91]
v_mfma_f32_16x16x32_bf16 v[92:95], v[32:35], a[108:111], v[92:95]
v_mfma_f32_16x16x32_bf16 v[92:95], v[36:39], a[124:127], v[92:95]
v_mfma_f32_16x16x32_bf16 v[108:111], v[16:19], a[108:111], v[108:111]
ds_read_b64_tr_b16 v[32:33], v203 offset:0
v_mfma_f32_16x16x32_bf16 v[108:111], v[20:23], a[124:127], v[108:111]
ds_read_b64_tr_b16 v[34:35], v203 offset:512
v_mfma_f32_16x16x32_bf16 v[104:107], v[16:19], a[104:107], v[104:107]
ds_read_b64_tr_b16 v[36:37], v203 offset:8192
v_mfma_f32_16x16x32_bf16 v[104:107], v[20:23], a[120:123], v[104:107]
ds_read_b64_tr_b16 v[38:39], v203 offset:8704
s_waitcnt lgkmcnt(4)
v_mfma_f32_16x16x32_bf16 v[100:103], v[16:19], a[100:103], v[100:103]
v_mfma_f32_16x16x32_bf16 v[100:103], v[20:23], a[116:119], v[100:103]
v_mfma_f32_16x16x32_bf16 v[96:99], v[16:19], a[96:99], v[96:99]
v_mfma_f32_16x16x32_bf16 v[96:99], v[20:23], a[112:115], v[96:99]
v_mfma_f32_16x16x32_bf16 v[112:115], v[24:27], a[96:99], v[112:115]
ds_read_b64_tr_b16 v[16:17], v204 offset:0
v_mfma_f32_16x16x32_bf16 v[112:115], v[28:31], a[112:115], v[112:115]
ds_read_b64_tr_b16 v[18:19], v204 offset:512
v_mfma_f32_16x16x32_bf16 v[116:119], v[24:27], a[100:103], v[116:119]
ds_read_b64_tr_b16 v[20:21], v204 offset:8192
v_mfma_f32_16x16x32_bf16 v[116:119], v[28:31], a[116:119], v[116:119]
ds_read_b64_tr_b16 v[22:23], v204 offset:8704
s_waitcnt lgkmcnt(4)
v_mfma_f32_16x16x32_bf16 v[120:123], v[24:27], a[104:107], v[120:123]
v_mfma_f32_16x16x32_bf16 v[120:123], v[28:31], a[120:123], v[120:123]
v_mfma_f32_16x16x32_bf16 v[124:127], v[24:27], a[108:111], v[124:127]
v_mfma_f32_16x16x32_bf16 v[124:127], v[28:31], a[124:127], v[124:127]
v_mfma_f32_16x16x32_bf16 v[140:143], v[32:35], a[108:111], v[140:143]
ds_read_b64_tr_b16 v[24:25], v205 offset:0
v_mfma_f32_16x16x32_bf16 v[140:143], v[36:39], a[124:127], v[140:143]
ds_read_b64_tr_b16 v[26:27], v205 offset:512
v_mfma_f32_16x16x32_bf16 v[136:139], v[32:35], a[104:107], v[136:139]
ds_read_b64_tr_b16 v[28:29], v205 offset:8192
v_mfma_f32_16x16x32_bf16 v[136:139], v[36:39], a[120:123], v[136:139]
ds_read_b64_tr_b16 v[30:31], v205 offset:8704
s_waitcnt lgkmcnt(4)
v_mfma_f32_16x16x32_bf16 v[132:135], v[32:35], a[100:103], v[132:135]
v_mfma_f32_16x16x32_bf16 v[132:135], v[36:39], a[116:119], v[132:135]
v_mfma_f32_16x16x32_bf16 v[128:131], v[32:35], a[96:99], v[128:131]
v_mfma_f32_16x16x32_bf16 v[128:131], v[36:39], a[112:115], v[128:131]
v_mfma_f32_16x16x32_bf16 v[144:147], v[16:19], a[96:99], v[144:147]
ds_read_b64_tr_b16 v[32:33], v206 offset:0
v_mfma_f32_16x16x32_bf16 v[144:147], v[20:23], a[112:115], v[144:147]
ds_read_b64_tr_b16 v[34:35], v206 offset:512
v_mfma_f32_16x16x32_bf16 v[148:151], v[16:19], a[100:103], v[148:151]
ds_read_b64_tr_b16 v[36:37], v206 offset:8192
v_mfma_f32_16x16x32_bf16 v[148:151], v[20:23], a[116:119], v[148:151]
ds_read_b64_tr_b16 v[38:39], v206 offset:8704
s_waitcnt lgkmcnt(4)
v_mfma_f32_16x16x32_bf16 v[152:155], v[16:19], a[104:107], v[152:155]
v_mfma_f32_16x16x32_bf16 v[152:155], v[20:23], a[120:123], v[152:155]
v_mfma_f32_16x16x32_bf16 v[156:159], v[16:19], a[108:111], v[156:159]
s_cmp_eq_u32 s57, 0
s_mov_b32 m0, s48
v_mfma_f32_16x16x32_bf16 v[156:159], v[20:23], a[124:127], v[156:159]
s_cbranch_scc1 F_QS1
s_waitcnt vmcnt(24)
F_QB1:
s_barrier
v_mfma_f32_16x16x32_bf16 v[172:175], v[24:27], a[108:111], v[172:175]
ds_read_b64_tr_b16 v[16:17], v192 offset:16384
v_mfma_f32_16x16x32_bf16 v[172:175], v[28:31], a[124:127], v[172:175]
ds_read_b64_tr_b16 v[18:19], v192 offset:17408
v_mfma_f32_16x16x32_bf16 v[168:171], v[24:27], a[104:107], v[168:171]
ds_read_b64_tr_b16 v[20:21], v192 offset:24576
v_mfma_f32_16x16x32_bf16 v[168:171], v[28:31], a[120:123], v[168:171]
ds_read_b64_tr_b16 v[22:23], v192 offset:25600
s_waitcnt lgkmcnt(4)
v_mfma_f32_16x16x32_bf16 v[164:167], v[24:27], a[100:103], v[164:167]
buffer_load_dwordx4 v40, s[20:23], s54 offen offset:0 lds
v_mfma_f32_16x16x32_bf16 v[164:167], v[28:31], a[116:119], v[164:167]
v_mfma_f32_16x16x32_bf16 v[160:163], v[24:27], a[96:99], v[160:163]
buffer_load_dwordx4 v41, s[20:23], s54 offen offset:1024 lds
v_mfma_f32_16x16x32_bf16 v[160:163], v[28:31], a[112:115], v[160:163]
v_mfma_f32_16x16x32_bf16 v[176:179], v[32:35], a[96:99], v[176:179]
ds_read_b64_tr_b16 v[24:25], v193 offset:16384
v_mfma_f32_16x16x32_bf16 v[176:179], v[36:39], a[112:115], v[176:179]
ds_read_b64_tr_b16 v[26:27], v193 offset:17408
v_mfma_f32_16x16x32_bf16 v[180:183], v[32:35], a[100:103], v[180:183]
ds_read_b64_tr_b16 v[28:29], v193 offset:24576
v_mfma_f32_16x16x32_bf16 v[180:183], v[36:39], a[116:119], v[180:183]
ds_read_b64_tr_b16 v[30:31], v193 offset:25600
s_waitcnt lgkmcnt(4)
v_mfma_f32_16x16x32_bf16 v[184:187], v[32:35], a[104:107], v[184:187]
buffer_load_dwordx4 v42, s[20:23], s54 offen offset:2048 lds
v_mfma_f32_16x16x32_bf16 v[184:187], v[36:39], a[120:123], v[184:187]
v_mfma_f32_16x16x32_bf16 v[188:191], v[32:35], a[108:111], v[188:191]
buffer_load_dwordx4 v43, s[20:23], s54 offen offset:3072 lds
v_mfma_f32_16x16x32_bf16 v[188:191], v[36:39], a[124:127], v[188:191]
v_mfma_f32_16x16x32_bf16 a[0:3], v[16:19], a[128:131], a[0:3]
ds_read_b64_tr_b16 v[32:33], v194 offset:16384
v_mfma_f32_16x16x32_bf16 a[0:3], v[20:23], a[144:147], a[0:3]
ds_read_b64_tr_b16 v[34:35], v194 offset:17408
v_mfma_f32_16x16x32_bf16 a[4:7], v[16:19], a[132:135], a[4:7]
ds_read_b64_tr_b16 v[36:37], v194 offset:24576
v_mfma_f32_16x16x32_bf16 a[4:7], v[20:23], a[148:151], a[4:7]
ds_read_b64_tr_b16 v[38:39], v194 offset:25600
s_waitcnt lgkmcnt(4)
v_mfma_f32_16x16x32_bf16 a[8:11], v[16:19], a[136:139], a[8:11]
buffer_load_dwordx4 a[96:99], v207, s[28:31], s56 offen offset:0 sc1
v_mfma_f32_16x16x32_bf16 a[8:11], v[20:23], a[152:155], a[8:11]
v_mfma_f32_16x16x32_bf16 a[12:15], v[16:19], a[140:143], a[12:15]
buffer_load_dwordx4 a[100:103], v207, s[28:31], s56 offen offset:1024 sc1
v_mfma_f32_16x16x32_bf16 a[12:15], v[20:23], a[156:159], a[12:15]
v_mfma_f32_16x16x32_bf16 a[28:31], v[24:27], a[140:143], a[28:31]
ds_read_b64_tr_b16 v[16:17], v195 offset:16384
v_mfma_f32_16x16x32_bf16 a[28:31], v[28:31], a[156:159], a[28:31]
ds_read_b64_tr_b16 v[18:19], v195 offset:17408
v_mfma_f32_16x16x32_bf16 a[24:27], v[24:27], a[136:139], a[24:27]
ds_read_b64_tr_b16 v[20:21], v195 offset:24576
v_mfma_f32_16x16x32_bf16 a[24:27], v[28:31], a[152:155], a[24:27]
ds_read_b64_tr_b16 v[22:23], v195 offset:25600
s_waitcnt lgkmcnt(4)
v_mfma_f32_16x16x32_bf16 a[20:23], v[24:27], a[132:135], a[20:23]
buffer_load_dwordx4 a[104:107], v207, s[28:31], s56 offen offset:2048 sc1
v_mfma_f32_16x16x32_bf16 a[20:23], v[28:31], a[148:151], a[20:23]
v_mfma_f32_16x16x32_bf16 a[16:19], v[24:27], a[128:131], a[16:19]
buffer_load_dwordx4 a[108:111], v207, s[28:31], s56 offen offset:3072 sc1
v_mfma_f32_16x16x32_bf16 a[16:19], v[28:31], a[144:147], a[16:19]
v_mfma_f32_16x16x32_bf16 a[32:35], v[32:35], a[128:131], a[32:35]
ds_read_b64_tr_b16 v[24:25], v196 offset:16384
v_mfma_f32_16x16x32_bf16 a[32:35], v[36:39], a[144:147], a[32:35]
ds_read_b64_tr_b16 v[26:27], v196 offset:17408
v_mfma_f32_16x16x32_bf16 a[36:39], v[32:35], a[132:135], a[36:39]
ds_read_b64_tr_b16 v[28:29], v196 offset:24576
v_mfma_f32_16x16x32_bf16 a[36:39], v[36:39], a[148:151], a[36:39]
ds_read_b64_tr_b16 v[30:31], v196 offset:25600
s_waitcnt lgkmcnt(4)
v_mfma_f32_16x16x32_bf16 a[40:43], v[32:35], a[136:139], a[40:43]
buffer_load_dwordx4 a[112:115], v209, s[28:31], s56 offen offset:0 sc1
v_mfma_f32_16x16x32_bf16 a[40:43], v[36:39], a[152:155], a[40:43]
v_mfma_f32_16x16x32_bf16 a[44:47], v[32:35], a[140:143], a[44:47]
buffer_load_dwordx4 a[116:119], v209, s[28:31], s56 offen offset:1024 sc1
v_mfma_f32_16x16x32_bf16 a[44:47], v[36:39], a[156:159], a[44:47]
v_mfma_f32_16x16x32_bf16 a[60:63], v[16:19], a[140:143], a[60:63]
ds_read_b64_tr_b16 v[32:33], v197 offset:16384
v_mfma_f32_16x16x32_bf16 a[60:63], v[20:23], a[156:159], a[60:63]
ds_read_b64_tr_b16 v[34:35], v197 offset:17408
v_mfma_f32_16x16x32_bf16 a[56:59], v[16:19], a[136:139], a[56:59]
ds_read_b64_tr_b16 v[36:37], v197 offset:24576
v_mfma_f32_16x16x32_bf16 a[56:59], v[20:23], a[152:155], a[56:59]
ds_read_b64_tr_b16 v[38:39], v197 offset:25600
s_waitcnt lgkmcnt(4)
v_mfma_f32_16x16x32_bf16 a[52:55], v[16:19], a[132:135], a[52:55]
buffer_load_dwordx4 a[120:123], v209, s[28:31], s56 offen offset:2048 sc1
v_mfma_f32_16x16x32_bf16 a[52:55], v[20:23], a[148:151], a[52:55]
v_mfma_f32_16x16x32_bf16 a[48:51], v[16:19], a[128:131], a[48:51]
buffer_load_dwordx4 a[124:127], v209, s[28:31], s56 offen offset:3072 sc1
v_mfma_f32_16x16x32_bf16 a[48:51], v[20:23], a[144:147], a[48:51]
v_mfma_f32_16x16x32_bf16 a[64:67], v[24:27], a[128:131], a[64:67]
ds_read_b64_tr_b16 v[16:17], v198 offset:16384
v_mfma_f32_16x16x32_bf16 a[64:67], v[28:31], a[144:147], a[64:67]
ds_read_b64_tr_b16 v[18:19], v198 offset:17408
v_mfma_f32_16x16x32_bf16 a[68:71], v[24:27], a[132:135], a[68:71]
ds_read_b64_tr_b16 v[20:21], v198 offset:24576
v_mfma_f32_16x16x32_bf16 a[68:71], v[28:31], a[148:151], a[68:71]
ds_read_b64_tr_b16 v[22:23], v198 offset:25600
s_waitcnt lgkmcnt(4)
v_mfma_f32_16x16x32_bf16 a[72:75], v[24:27], a[136:139], a[72:75]
s_add_u32 s56, s56, 8192
v_mfma_f32_16x16x32_bf16 a[72:75], v[28:31], a[152:155], a[72:75]
v_mfma_f32_16x16x32_bf16 a[76:79], v[24:27], a[140:143], a[76:79]
buffer_load_dword v212, v210, s[20:23], s64 offen
v_mfma_f32_16x16x32_bf16 a[76:79], v[28:31], a[156:159], a[76:79]
v_mfma_f32_16x16x32_bf16 a[92:95], v[32:35], a[140:143], a[92:95]
ds_read_b64_tr_b16 v[24:25], v199 offset:16384
v_mfma_f32_16x16x32_bf16 a[92:95], v[36:39], a[156:159], a[92:95]
ds_read_b64_tr_b16 v[26:27], v199 offset:17408
v_mfma_f32_16x16x32_bf16 a[88:91], v[32:35], a[136:139], a[88:91]
ds_read_b64_tr_b16 v[28:29], v199 offset:24576
v_mfma_f32_16x16x32_bf16 a[88:91], v[36:39], a[152:155], a[88:91]
ds_read_b64_tr_b16 v[30:31], v199 offset:25600
s_waitcnt lgkmcnt(4)
v_mfma_f32_16x16x32_bf16 a[84:87], v[32:35], a[132:135], a[84:87]
buffer_load_dword v212, v211, s[24:27], s65 offen offset:3072
v_mfma_f32_16x16x32_bf16 a[84:87], v[36:39], a[148:151], a[84:87]
s_add_u32 s64, s64, 786432
s_add_u32 s65, s65, 196608
v_mfma_f32_16x16x32_bf16 a[80:83], v[32:35], a[128:131], a[80:83]
s_mov_b32 m0, s49
v_mfma_f32_16x16x32_bf16 a[80:83], v[36:39], a[144:147], a[80:83]
s_waitcnt vmcnt(32)
s_barrier
v_mfma_f32_16x16x32_bf16 v[48:51], v[16:19], a[128:131], v[48:51]
ds_read_b64_tr_b16 v[32:33], v200 offset:16384
v_mfma_f32_16x16x32_bf16 v[48:51], v[20:23], a[144:147], v[48:51]
ds_read_b64_tr_b16 v[34:35], v200 offset:16896
v_mfma_f32_16x16x32_bf16 v[52:55], v[16:19], a[132:135], v[52:55]
ds_read_b64_tr_b16 v[36:37], v200 offset:24576
v_mfma_f32_16x16x32_bf16 v[52:55], v[20:23], a[148:151], v[52:55]
ds_read_b64_tr_b16 v[38:39], v200 offset:25088
s_waitcnt lgkmcnt(4)
v_mfma_f32_16x16x32_bf16 v[56:59], v[16:19], a[136:139], v[56:59]
buffer_load_dwordx4 v44, s[20:23], s54 offen offset:0 lds
v_mfma_f32_16x16x32_bf16 v[56:59], v[20:23], a[152:155], v[56:59]
v_mfma_f32_16x16x32_bf16 v[60:63], v[16:19], a[140:143], v[60:63]
buffer_load_dwordx4 v45, s[20:23], s54 offen offset:1024 lds
v_mfma_f32_16x16x32_bf16 v[60:63], v[20:23], a[156:159], v[60:63]
v_mfma_f32_16x16x32_bf16 v[76:79], v[24:27], a[140:143], v[76:79]
ds_read_b64_tr_b16 v[16:17], v201 offset:16384
v_mfma_f32_16x16x32_bf16 v[76:79], v[28:31], a[156:159], v[76:79]
ds_read_b64_tr_b16 v[18:19], v201 offset:16896
v_mfma_f32_16x16x32_bf16 v[72:75], v[24:27], a[136:139], v[72:75]
ds_read_b64_tr_b16 v[20:21], v201 offset:24576
v_mfma_f32_16x16x32_bf16 v[72:75], v[28:31], a[152:155], v[72:75]
ds_read_b64_tr_b16 v[22:23], v201 offset:25088
s_waitcnt lgkmcnt(4)
v_mfma_f32_16x16x32_bf16 v[68:71], v[24:27], a[132:135], v[68:71]
buffer_load_dwordx4 v46, s[24:27], s55 offen offset:2048 lds
v_mfma_f32_16x16x32_bf16 v[68:71], v[28:31], a[148:151], v[68:71]
v_mfma_f32_16x16x32_bf16 v[64:67], v[24:27], a[128:131], v[64:67]
buffer_load_dwordx4 v47, s[24:27], s55 offen offset:3072 lds
v_mfma_f32_16x16x32_bf16 v[64:67], v[28:31], a[144:147], v[64:67]
s_add_u32 s54, s54, 786432
s_add_u32 s55, s55, 196608
v_mfma_f32_16x16x32_bf16 v[80:83], v[32:35], a[128:131], v[80:83]
ds_read_b64_tr_b16 v[24:25], v202 offset:16384
v_mfma_f32_16x16x32_bf16 v[80:83], v[36:39], a[144:147], v[80:83]
ds_read_b64_tr_b16 v[26:27], v202 offset:16896
v_mfma_f32_16x16x32_bf16 v[84:87], v[32:35], a[132:135], v[84:87]
ds_read_b64_tr_b16 v[28:29], v202 offset:24576
v_mfma_f32_16x16x32_bf16 v[84:87], v[36:39], a[148:151], v[84:87]
ds_read_b64_tr_b16 v[30:31], v202 offset:25088
s_waitcnt lgkmcnt(4)
v_mfma_f32_16x16x32_bf16 v[88:91], v[32:35], a[136:139], v[88:91]
v_mfma_f32_16x16x32_bf16 v[88:91], v[36:39], a[152:155], v[88:91]
v_mfma_f32_16x16x32_bf16 v[92:95], v[32:35], a[140:143], v[92:95]
v_mfma_f32_16x16x32_bf16 v[92:95], v[36:39], a[156:159], v[92:95]
v_mfma_f32_16x16x32_bf16 v[108:111], v[16:19], a[140:143], v[108:111]
ds_read_b64_tr_b16 v[32:33], v203 offset:16384
v_mfma_f32_16x16x32_bf16 v[108:111], v[20:23], a[156:159], v[108:111]
ds_read_b64_tr_b16 v[34:35], v203 offset:16896
v_mfma_f32_16x16x32_bf16 v[104:107], v[16:19], a[136:139], v[104:107]
ds_read_b64_tr_b16 v[36:37], v203 offset:24576
v_mfma_f32_16x16x32_bf16 v[104:107], v[20:23], a[152:155], v[104:107]
ds_read_b64_tr_b16 v[38:39], v203 offset:25088
s_waitcnt lgkmcnt(4)
v_mfma_f32_16x16x32_bf16 v[100:103], v[16:19], a[132:135], v[100:103]
v_mfma_f32_16x16x32_bf16 v[100:103], v[20:23], a[148:151], v[100:103]
v_mfma_f32_16x16x32_bf16 v[96:99], v[16:19], a[128:131], v[96:99]
v_mfma_f32_16x16x32_bf16 v[96:99], v[20:23], a[144:147], v[96:99]
v_mfma_f32_16x16x32_bf16 v[112:115], v[24:27], a[128:131], v[112:115]
ds_read_b64_tr_b16 v[16:17], v204 offset:16384
v_mfma_f32_16x16x32_bf16 v[112:115], v[28:31], a[144:147], v[112:115]
ds_read_b64_tr_b16 v[18:19], v204 offset:16896
v_mfma_f32_16x16x32_bf16 v[116:119], v[24:27], a[132:135], v[116:119]
ds_read_b64_tr_b16 v[20:21], v204 offset:24576
v_mfma_f32_16x16x32_bf16 v[116:119], v[28:31], a[148:151], v[116:119]
ds_read_b64_tr_b16 v[22:23], v204 offset:25088
s_waitcnt lgkmcnt(4)
v_mfma_f32_16x16x32_bf16 v[120:123], v[24:27], a[136:139], v[120:123]
v_mfma_f32_16x16x32_bf16 v[120:123], v[28:31], a[152:155], v[120:123]
v_mfma_f32_16x16x32_bf16 v[124:127], v[24:27], a[140:143], v[124:127]
v_mfma_f32_16x16x32_bf16 v[124:127], v[28:31], a[156:159], v[124:127]
v_mfma_f32_16x16x32_bf16 v[140:143], v[32:35], a[140:143], v[140:143]
ds_read_b64_tr_b16 v[24:25], v205 offset:16384
v_mfma_f32_16x16x32_bf16 v[140:143], v[36:39], a[156:159], v[140:143]
ds_read_b64_tr_b16 v[26:27], v205 offset:16896
v_mfma_f32_16x16x32_bf16 v[136:139], v[32:35], a[136:139], v[136:139]
ds_read_b64_tr_b16 v[28:29], v205 offset:24576
v_mfma_f32_16x16x32_bf16 v[136:139], v[36:39], a[152:155], v[136:139]
ds_read_b64_tr_b16 v[30:31], v205 offset:25088
s_waitcnt lgkmcnt(4)
v_mfma_f32_16x16x32_bf16 v[132:135], v[32:35], a[132:135], v[132:135]
v_mfma_f32_16x16x32_bf16 v[132:135], v[36:39], a[148:151], v[132:135]
v_mfma_f32_16x16x32_bf16 v[128:131], v[32:35], a[128:131], v[128:131]
v_mfma_f32_16x16x32_bf16 v[128:131], v[36:39], a[144:147], v[128:131]
v_mfma_f32_16x16x32_bf16 v[144:147], v[16:19], a[128:131], v[144:147]
ds_read_b64_tr_b16 v[32:33], v206 offset:16384
v_mfma_f32_16x16x32_bf16 v[144:147], v[20:23], a[144:147], v[144:147]
ds_read_b64_tr_b16 v[34:35], v206 offset:16896
v_mfma_f32_16x16x32_bf16 v[148:151], v[16:19], a[132:135], v[148:151]
ds_read_b64_tr_b16 v[36:37], v206 offset:24576
v_mfma_f32_16x16x32_bf16 v[148:151], v[20:23], a[148:151], v[148:151]
ds_read_b64_tr_b16 v[38:39], v206 offset:25088
s_waitcnt lgkmcnt(4)
v_mfma_f32_16x16x32_bf16 v[152:155], v[16:19], a[136:139], v[152:155]
v_mfma_f32_16x16x32_bf16 v[152:155], v[20:23], a[152:155], v[152:155]
v_mfma_f32_16x16x32_bf16 v[156:159], v[16:19], a[140:143], v[156:159]
s_mov_b32 m0, s50
v_mfma_f32_16x16x32_bf16 v[156:159], v[20:23], a[156:159], v[156:159]
s_waitcnt vmcnt(24)
s_barrier
v_mfma_f32_16x16x32_bf16 v[172:175], v[24:27], a[140:143], v[172:175]
ds_read_b64_tr_b16 v[16:17], v192 offset:32768
v_mfma_f32_16x16x32_bf16 v[172:175], v[28:31], a[156:159], v[172:175]
ds_read_b64_tr_b16 v[18:19], v192 offset:33792
v_mfma_f32_16x16x32_bf16 v[168:171], v[24:27], a[136:139], v[168:171]
ds_read_b64_tr_b16 v[20:21], v192 offset:40960
v_mfma_f32_16x16x32_bf16 v[168:171], v[28:31], a[152:155], v[168:171]
ds_read_b64_tr_b16 v[22:23], v192 offset:41984
s_waitcnt lgkmcnt(4)
v_mfma_f32_16x16x32_bf16 v[164:167], v[24:27], a[132:135], v[164:167]
buffer_load_dwordx4 v40, s[20:23], s54 offen offset:0 lds
v_mfma_f32_16x16x32_bf16 v[164:167], v[28:31], a[148:151], v[164:167]
v_mfma_f32_16x16x32_bf16 v[160:163], v[24:27], a[128:131], v[160:163]
buffer_load_dwordx4 v41, s[20:23], s54 offen offset:1024 lds
v_mfma_f32_16x16x32_bf16 v[160:163], v[28:31], a[144:147], v[160:163]
v_mfma_f32_16x16x32_bf16 v[176:179], v[32:35], a[128:131], v[176:179]
ds_read_b64_tr_b16 v[24:25], v193 offset:32768
v_mfma_f32_16x16x32_bf16 v[176:179], v[36:39], a[144:147], v[176:179]
ds_read_b64_tr_b16 v[26:27], v193 offset:33792
v_mfma_f32_16x16x32_bf16 v[180:183], v[32:35], a[132:135], v[180:183]
ds_read_b64_tr_b16 v[28:29], v193 offset:40960
v_mfma_f32_16x16x32_bf16 v[180:183], v[36:39], a[148:151], v[180:183]
ds_read_b64_tr_b16 v[30:31], v193 offset:41984
s_waitcnt lgkmcnt(4)
v_mfma_f32_16x16x32_bf16 v[184:187], v[32:35], a[136:139], v[184:187]
buffer_load_dwordx4 v42, s[20:23], s54 offen offset:2048 lds
v_mfma_f32_16x16x32_bf16 v[184:187], v[36:39], a[152:155], v[184:187]
v_mfma_f32_16x16x32_bf16 v[188:191], v[32:35], a[140:143], v[188:191]
buffer_load_dwordx4 v43, s[20:23], s54 offen offset:3072 lds
v_mfma_f32_16x16x32_bf16 v[188:191], v[36:39], a[156:159], v[188:191]
v_mfma_f32_16x16x32_bf16 a[0:3], v[16:19], a[160:163], a[0:3]
ds_read_b64_tr_b16 v[32:33], v194 offset:32768
v_mfma_f32_16x16x32_bf16 a[0:3], v[20:23], a[176:179], a[0:3]
ds_read_b64_tr_b16 v[34:35], v194 offset:33792
v_mfma_f32_16x16x32_bf16 a[4:7], v[16:19], a[164:167], a[4:7]
ds_read_b64_tr_b16 v[36:37], v194 offset:40960
v_mfma_f32_16x16x32_bf16 a[4:7], v[20:23], a[180:183], a[4:7]
ds_read_b64_tr_b16 v[38:39], v194 offset:41984
s_waitcnt lgkmcnt(4)
v_mfma_f32_16x16x32_bf16 a[8:11], v[16:19], a[168:171], a[8:11]
buffer_load_dwordx4 a[128:131], v207, s[28:31], s56 offen offset:0 sc1
v_mfma_f32_16x16x32_bf16 a[8:11], v[20:23], a[184:187], a[8:11]
v_mfma_f32_16x16x32_bf16 a[12:15], v[16:19], a[172:175], a[12:15]
buffer_load_dwordx4 a[132:135], v207, s[28:31], s56 offen offset:1024 sc1
v_mfma_f32_16x16x32_bf16 a[12:15], v[20:23], a[188:191], a[12:15]
v_mfma_f32_16x16x32_bf16 a[28:31], v[24:27], a[172:175], a[28:31]
ds_read_b64_tr_b16 v[16:17], v195 offset:32768
v_mfma_f32_16x16x32_bf16 a[28:31], v[28:31], a[188:191], a[28:31]
ds_read_b64_tr_b16 v[18:19], v195 offset:33792
v_mfma_f32_16x16x32_bf16 a[24:27], v[24:27], a[168:171], a[24:27]
ds_read_b64_tr_b16 v[20:21], v195 offset:40960
v_mfma_f32_16x16x32_bf16 a[24:27], v[28:31], a[184:187], a[24:27]
ds_read_b64_tr_b16 v[22:23], v195 offset:41984
s_waitcnt lgkmcnt(4)
v_mfma_f32_16x16x32_bf16 a[20:23], v[24:27], a[164:167], a[20:23]
buffer_load_dwordx4 a[136:139], v207, s[28:31], s56 offen offset:2048 sc1
v_mfma_f32_16x16x32_bf16 a[20:23], v[28:31], a[180:183], a[20:23]
v_mfma_f32_16x16x32_bf16 a[16:19], v[24:27], a[160:163], a[16:19]
buffer_load_dwordx4 a[140:143], v207, s[28:31], s56 offen offset:3072 sc1
v_mfma_f32_16x16x32_bf16 a[16:19], v[28:31], a[176:179], a[16:19]
v_mfma_f32_16x16x32_bf16 a[32:35], v[32:35], a[160:163], a[32:35]
ds_read_b64_tr_b16 v[24:25], v196 offset:32768
v_mfma_f32_16x16x32_bf16 a[32:35], v[36:39], a[176:179], a[32:35]
ds_read_b64_tr_b16 v[26:27], v196 offset:33792
v_mfma_f32_16x16x32_bf16 a[36:39], v[32:35], a[164:167], a[36:39]
ds_read_b64_tr_b16 v[28:29], v196 offset:40960
v_mfma_f32_16x16x32_bf16 a[36:39], v[36:39], a[180:183], a[36:39]
ds_read_b64_tr_b16 v[30:31], v196 offset:41984
s_waitcnt lgkmcnt(4)
v_mfma_f32_16x16x32_bf16 a[40:43], v[32:35], a[168:171], a[40:43]
buffer_load_dwordx4 a[144:147], v209, s[28:31], s56 offen offset:0 sc1
v_mfma_f32_16x16x32_bf16 a[40:43], v[36:39], a[184:187], a[40:43]
v_mfma_f32_16x16x32_bf16 a[44:47], v[32:35], a[172:175], a[44:47]
buffer_load_dwordx4 a[148:151], v209, s[28:31], s56 offen offset:1024 sc1
v_mfma_f32_16x16x32_bf16 a[44:47], v[36:39], a[188:191], a[44:47]
v_mfma_f32_16x16x32_bf16 a[60:63], v[16:19], a[172:175], a[60:63]
ds_read_b64_tr_b16 v[32:33], v197 offset:32768
v_mfma_f32_16x16x32_bf16 a[60:63], v[20:23], a[188:191], a[60:63]
ds_read_b64_tr_b16 v[34:35], v197 offset:33792
v_mfma_f32_16x16x32_bf16 a[56:59], v[16:19], a[168:171], a[56:59]
ds_read_b64_tr_b16 v[36:37], v197 offset:40960
v_mfma_f32_16x16x32_bf16 a[56:59], v[20:23], a[184:187], a[56:59]
ds_read_b64_tr_b16 v[38:39], v197 offset:41984
s_waitcnt lgkmcnt(4)
v_mfma_f32_16x16x32_bf16 a[52:55], v[16:19], a[164:167], a[52:55]
buffer_load_dwordx4 a[152:155], v209, s[28:31], s56 offen offset:2048 sc1
v_mfma_f32_16x16x32_bf16 a[52:55], v[20:23], a[180:183], a[52:55]
v_mfma_f32_16x16x32_bf16 a[48:51], v[16:19], a[160:163], a[48:51]
buffer_load_dwordx4 a[156:159], v209, s[28:31], s56 offen offset:3072 sc1
v_mfma_f32_16x16x32_bf16 a[48:51], v[20:23], a[176:179], a[48:51]
v_mfma_f32_16x16x32_bf16 a[64:67], v[24:27], a[160:163], a[64:67]
ds_read_b64_tr_b16 v[16:17], v198 offset:32768
v_mfma_f32_16x16x32_bf16 a[64:67], v[28:31], a[176:179], a[64:67]
ds_read_b64_tr_b16 v[18:19], v198 offset:33792
v_mfma_f32_16x16x32_bf16 a[68:71], v[24:27], a[164:167], a[68:71]
ds_read_b64_tr_b16 v[20:21], v198 offset:40960
v_mfma_f32_16x16x32_bf16 a[68:71], v[28:31], a[180:183], a[68:71]
ds_read_b64_tr_b16 v[22:23], v198 offset:41984
s_waitcnt lgkmcnt(4)
v_mfma_f32_16x16x32_bf16 a[72:75], v[24:27], a[168:171], a[72:75]
s_add_u32 s56, s56, 8192
v_mfma_f32_16x16x32_bf16 a[72:75], v[28:31], a[184:187], a[72:75]
v_mfma_f32_16x16x32_bf16 a[76:79], v[24:27], a[172:175], a[76:79]
buffer_load_dword v212, v210, s[20:23], s64 offen
v_mfma_f32_16x16x32_bf16 a[76:79], v[28:31], a[188:191], a[76:79]
v_mfma_f32_16x16x32_bf16 a[92:95], v[32:35], a[172:175], a[92:95]
ds_read_b64_tr_b16 v[24:25], v199 offset:32768
v_mfma_f32_16x16x32_bf16 a[92:95], v[36:39], a[188:191], a[92:95]
ds_read_b64_tr_b16 v[26:27], v199 offset:33792
v_mfma_f32_16x16x32_bf16 a[88:91], v[32:35], a[168:171], a[88:91]
ds_read_b64_tr_b16 v[28:29], v199 offset:40960
v_mfma_f32_16x16x32_bf16 a[88:91], v[36:39], a[184:187], a[88:91]
ds_read_b64_tr_b16 v[30:31], v199 offset:41984
s_waitcnt lgkmcnt(4)
v_mfma_f32_16x16x32_bf16 a[84:87], v[32:35], a[164:167], a[84:87]
buffer_load_dword v212, v211, s[24:27], s65 offen offset:3072
v_mfma_f32_16x16x32_bf16 a[84:87], v[36:39], a[180:183], a[84:87]
s_add_u32 s64, s64, 786432
s_add_u32 s65, s65, 196608
v_mfma_f32_16x16x32_bf16 a[80:83], v[32:35], a[160:163], a[80:83]
s_mov_b32 m0, s51
v_mfma_f32_16x16x32_bf16 a[80:83], v[36:39], a[176:179], a[80:83]
s_waitcnt vmcnt(32)
s_barrier
v_mfma_f32_16x16x32_bf16 v[48:51], v[16:19], a[160:163], v[48:51]
ds_read_b64_tr_b16 v[32:33], v200 offset:32768
v_mfma_f32_16x16x32_bf16 v[48:51], v[20:23], a[176:179], v[48:51]
ds_read_b64_tr_b16 v[34:35], v200 offset:33280
v_mfma_f32_16x16x32_bf16 v[52:55], v[16:19], a[164:167], v[52:55]
ds_read_b64_tr_b16 v[36:37], v200 offset:40960
v_mfma_f32_16x16x32_bf16 v[52:55], v[20:23], a[180:183], v[52:55]
ds_read_b64_tr_b16 v[38:39], v200 offset:41472
s_waitcnt lgkmcnt(4)
v_mfma_f32_16x16x32_bf16 v[56:59], v[16:19], a[168:171], v[56:59]
buffer_load_dwordx4 v44, s[20:23], s54 offen offset:0 lds
v_mfma_f32_16x16x32_bf16 v[56:59], v[20:23], a[184:187], v[56:59]
v_mfma_f32_16x16x32_bf16 v[60:63], v[16:19], a[172:175], v[60:63]
buffer_load_dwordx4 v45, s[20:23], s54 offen offset:1024 lds
v_mfma_f32_16x16x32_bf16 v[60:63], v[20:23], a[188:191], v[60:63]
v_mfma_f32_16x16x32_bf16 v[76:79], v[24:27], a[172:175], v[76:79]
ds_read_b64_tr_b16 v[16:17], v201 offset:32768
v_mfma_f32_16x16x32_bf16 v[76:79], v[28:31], a[188:191], v[76:79]
ds_read_b64_tr_b16 v[18:19], v201 offset:33280
v_mfma_f32_16x16x32_bf16 v[72:75], v[24:27], a[168:171], v[72:75]
ds_read_b64_tr_b16 v[20:21], v201 offset:40960
v_mfma_f32_16x16x32_bf16 v[72:75], v[28:31], a[184:187], v[72:75]
ds_read_b64_tr_b16 v[22:23], v201 offset:41472
s_waitcnt lgkmcnt(4)
v_mfma_f32_16x16x32_bf16 v[68:71], v[24:27], a[164:167], v[68:71]
buffer_load_dwordx4 v46, s[24:27], s55 offen offset:2048 lds
v_mfma_f32_16x16x32_bf16 v[68:71], v[28:31], a[180:183], v[68:71]
v_mfma_f32_16x16x32_bf16 v[64:67], v[24:27], a[160:163], v[64:67]
buffer_load_dwordx4 v47, s[24:27], s55 offen offset:3072 lds
v_mfma_f32_16x16x32_bf16 v[64:67], v[28:31], a[176:179], v[64:67]
s_add_u32 s54, s54, 786432
s_add_u32 s55, s55, 196608
v_mfma_f32_16x16x32_bf16 v[80:83], v[32:35], a[160:163], v[80:83]
ds_read_b64_tr_b16 v[24:25], v202 offset:32768
v_mfma_f32_16x16x32_bf16 v[80:83], v[36:39], a[176:179], v[80:83]
ds_read_b64_tr_b16 v[26:27], v202 offset:33280
v_mfma_f32_16x16x32_bf16 v[84:87], v[32:35], a[164:167], v[84:87]
ds_read_b64_tr_b16 v[28:29], v202 offset:40960
v_mfma_f32_16x16x32_bf16 v[84:87], v[36:39], a[180:183], v[84:87]
ds_read_b64_tr_b16 v[30:31], v202 offset:41472
s_waitcnt lgkmcnt(4)
v_mfma_f32_16x16x32_bf16 v[88:91], v[32:35], a[168:171], v[88:91]
v_mfma_f32_16x16x32_bf16 v[88:91], v[36:39], a[184:187], v[88:91]
v_mfma_f32_16x16x32_bf16 v[92:95], v[32:35], a[172:175], v[92:95]
v_mfma_f32_16x16x32_bf16 v[92:95], v[36:39], a[188:191], v[92:95]
v_mfma_f32_16x16x32_bf16 v[108:111], v[16:19], a[172:175], v[108:111]
ds_read_b64_tr_b16 v[32:33], v203 offset:32768
v_mfma_f32_16x16x32_bf16 v[108:111], v[20:23], a[188:191], v[108:111]
ds_read_b64_tr_b16 v[34:35], v203 offset:33280
v_mfma_f32_16x16x32_bf16 v[104:107], v[16:19], a[168:171], v[104:107]
ds_read_b64_tr_b16 v[36:37], v203 offset:40960
v_mfma_f32_16x16x32_bf16 v[104:107], v[20:23], a[184:187], v[104:107]
ds_read_b64_tr_b16 v[38:39], v203 offset:41472
s_waitcnt lgkmcnt(4)
v_mfma_f32_16x16x32_bf16 v[100:103], v[16:19], a[164:167], v[100:103]
v_mfma_f32_16x16x32_bf16 v[100:103], v[20:23], a[180:183], v[100:103]
v_mfma_f32_16x16x32_bf16 v[96:99], v[16:19], a[160:163], v[96:99]
v_mfma_f32_16x16x32_bf16 v[96:99], v[20:23], a[176:179], v[96:99]
v_mfma_f32_16x16x32_bf16 v[112:115], v[24:27], a[160:163], v[112:115]
ds_read_b64_tr_b16 v[16:17], v204 offset:32768
v_mfma_f32_16x16x32_bf16 v[112:115], v[28:31], a[176:179], v[112:115]
ds_read_b64_tr_b16 v[18:19], v204 offset:33280
v_mfma_f32_16x16x32_bf16 v[116:119], v[24:27], a[164:167], v[116:119]
ds_read_b64_tr_b16 v[20:21], v204 offset:40960
v_mfma_f32_16x16x32_bf16 v[116:119], v[28:31], a[180:183], v[116:119]
ds_read_b64_tr_b16 v[22:23], v204 offset:41472
s_waitcnt lgkmcnt(4)
v_mfma_f32_16x16x32_bf16 v[120:123], v[24:27], a[168:171], v[120:123]
v_mfma_f32_16x16x32_bf16 v[120:123], v[28:31], a[184:187], v[120:123]
v_mfma_f32_16x16x32_bf16 v[124:127], v[24:27], a[172:175], v[124:127]
v_mfma_f32_16x16x32_bf16 v[124:127], v[28:31], a[188:191], v[124:127]
v_mfma_f32_16x16x32_bf16 v[140:143], v[32:35], a[172:175], v[140:143]
ds_read_b64_tr_b16 v[24:25], v205 offset:32768
v_mfma_f32_16x16x32_bf16 v[140:143], v[36:39], a[188:191], v[140:143]
ds_read_b64_tr_b16 v[26:27], v205 offset:33280
v_mfma_f32_16x16x32_bf16 v[136:139], v[32:35], a[168:171], v[136:139]
ds_read_b64_tr_b16 v[28:29], v205 offset:40960
v_mfma_f32_16x16x32_bf16 v[136:139], v[36:39], a[184:187], v[136:139]
ds_read_b64_tr_b16 v[30:31], v205 offset:41472
s_waitcnt lgkmcnt(4)
v_mfma_f32_16x16x32_bf16 v[132:135], v[32:35], a[164:167], v[132:135]
v_mfma_f32_16x16x32_bf16 v[132:135], v[36:39], a[180:183], v[132:135]
v_mfma_f32_16x16x32_bf16 v[128:131], v[32:35], a[160:163], v[128:131]
v_mfma_f32_16x16x32_bf16 v[128:131], v[36:39], a[176:179], v[128:131]
v_mfma_f32_16x16x32_bf16 v[144:147], v[16:19], a[160:163], v[144:147]
ds_read_b64_tr_b16 v[32:33], v206 offset:32768
v_mfma_f32_16x16x32_bf16 v[144:147], v[20:23], a[176:179], v[144:147]
ds_read_b64_tr_b16 v[34:35], v206 offset:33280
v_mfma_f32_16x16x32_bf16 v[148:151], v[16:19], a[164:167], v[148:151]
ds_read_b64_tr_b16 v[36:37], v206 offset:40960
v_mfma_f32_16x16x32_bf16 v[148:151], v[20:23], a[180:183], v[148:151]
ds_read_b64_tr_b16 v[38:39], v206 offset:41472
s_waitcnt lgkmcnt(4)
v_mfma_f32_16x16x32_bf16 v[152:155], v[16:19], a[168:171], v[152:155]
v_mfma_f32_16x16x32_bf16 v[152:155], v[20:23], a[184:187], v[152:155]
v_mfma_f32_16x16x32_bf16 v[156:159], v[16:19], a[172:175], v[156:159]
s_mov_b32 m0, s52
v_mfma_f32_16x16x32_bf16 v[156:159], v[20:23], a[188:191], v[156:159]
s_waitcnt vmcnt(24)
s_barrier
v_mfma_f32_16x16x32_bf16 v[172:175], v[24:27], a[172:175], v[172:175]
ds_read_b64_tr_b16 v[16:17], v192 offset:0
v_mfma_f32_16x16x32_bf16 v[172:175], v[28:31], a[188:191], v[172:175]
ds_read_b64_tr_b16 v[18:19], v192 offset:1024
v_mfma_f32_16x16x32_bf16 v[168:171], v[24:27], a[168:171], v[168:171]
ds_read_b64_tr_b16 v[20:21], v192 offset:8192
v_mfma_f32_16x16x32_bf16 v[168:171], v[28:31], a[184:187], v[168:171]
ds_read_b64_tr_b16 v[22:23], v192 offset:9216
s_waitcnt lgkmcnt(4)
v_mfma_f32_16x16x32_bf16 v[164:167], v[24:27], a[164:167], v[164:167]
buffer_load_dwordx4 v40, s[20:23], s54 offen offset:0 lds
v_mfma_f32_16x16x32_bf16 v[164:167], v[28:31], a[180:183], v[164:167]
v_mfma_f32_16x16x32_bf16 v[160:163], v[24:27], a[160:163], v[160:163]
buffer_load_dwordx4 v41, s[20:23], s54 offen offset:1024 lds
v_mfma_f32_16x16x32_bf16 v[160:163], v[28:31], a[176:179], v[160:163]
v_mfma_f32_16x16x32_bf16 v[176:179], v[32:35], a[160:163], v[176:179]
ds_read_b64_tr_b16 v[24:25], v193 offset:0
v_mfma_f32_16x16x32_bf16 v[176:179], v[36:39], a[176:179], v[176:179]
ds_read_b64_tr_b16 v[26:27], v193 offset:1024
v_mfma_f32_16x16x32_bf16 v[180:183], v[32:35], a[164:167], v[180:183]
ds_read_b64_tr_b16 v[28:29], v193 offset:8192
v_mfma_f32_16x16x32_bf16 v[180:183], v[36:39], a[180:183], v[180:183]
ds_read_b64_tr_b16 v[30:31], v193 offset:9216
s_waitcnt lgkmcnt(4)
v_mfma_f32_16x16x32_bf16 v[184:187], v[32:35], a[168:171], v[184:187]
buffer_load_dwordx4 v42, s[20:23], s54 offen offset:2048 lds
v_mfma_f32_16x16x32_bf16 v[184:187], v[36:39], a[184:187], v[184:187]
v_mfma_f32_16x16x32_bf16 v[188:191], v[32:35], a[172:175], v[188:191]
buffer_load_dwordx4 v43, s[20:23], s54 offen offset:3072 lds
v_mfma_f32_16x16x32_bf16 v[188:191], v[36:39], a[188:191], v[188:191]
s_add_u32 s57, s57, 1
s_cmp_lt_u32 s57, 3
s_cbranch_scc1 F_QL
v_mfma_f32_16x16x32_bf16 a[0:3], v[16:19], a[96:99], a[0:3]
ds_read_b64_tr_b16 v[32:33], v194 offset:0
s_mul_i32 s66, s2, 10240
v_mfma_f32_16x16x32_bf16 a[0:3], v[20:23], a[112:115], a[0:3]
ds_read_b64_tr_b16 v[34:35], v194 offset:1024
s_add_u32 s67, s66, 0x300000
v_mfma_f32_16x16x32_bf16 a[4:7], v[16:19], a[100:103], a[4:7]
ds_read_b64_tr_b16 v[36:37], v194 offset:8192
s_sub_u32 s22, 9830400, s66
v_mfma_f32_16x16x32_bf16 a[4:7], v[20:23], a[116:119], a[4:7]
ds_read_b64_tr_b16 v[38:39], v194 offset:9216
s_waitcnt lgkmcnt(4)
v_mfma_f32_16x16x32_bf16 a[8:11], v[16:19], a[104:107], a[8:11]
s_mov_b32 m0, s40
s_mov_b32 s39, 0
v_mfma_f32_16x16x32_bf16 a[8:11], v[20:23], a[120:123], a[8:11]
buffer_load_dwordx4 v246, s[12:15], s39 offen offset:0 lds
v_mfma_f32_16x16x32_bf16 a[12:15], v[16:19], a[108:111], a[12:15]
buffer_load_dwordx4 v247, s[12:15], s39 offen offset:1024 lds
v_mfma_f32_16x16x32_bf16 a[12:15], v[20:23], a[124:127], a[12:15]
buffer_load_dwordx4 v248, s[12:15], s39 offen offset:2048 lds
v_mfma_f32_16x16x32_bf16 a[28:31], v[24:27], a[108:111], a[28:31]
ds_read_b64_tr_b16 v[16:17], v195 offset:0
s_cmp_lt_u32 s2, 240
v_mfma_f32_16x16x32_bf16 a[28:31], v[28:31], a[124:127], a[28:31]
ds_read_b64_tr_b16 v[18:19], v195 offset:1024
s_cselect_b32 s22, s22, 0
v_mfma_f32_16x16x32_bf16 a[24:27], v[24:27], a[104:107], a[24:27]
ds_read_b64_tr_b16 v[20:21], v195 offset:8192
s_cselect_b32 s67, s67, 0x300000
v_mfma_f32_16x16x32_bf16 a[24:27], v[28:31], a[120:123], a[24:27]
ds_read_b64_tr_b16 v[22:23], v195 offset:9216
s_waitcnt lgkmcnt(4)
v_mfma_f32_16x16x32_bf16 a[20:23], v[24:27], a[100:103], a[20:23]
v_mfma_f32_16x16x32_bf16 a[20:23], v[28:31], a[116:119], a[20:23]
v_mfma_f32_16x16x32_bf16 a[16:19], v[24:27], a[96:99], a[16:19]
v_mfma_f32_16x16x32_bf16 a[16:19], v[28:31], a[112:115], a[16:19]
v_mfma_f32_16x16x32_bf16 a[32:35], v[32:35], a[96:99], a[32:35]
ds_read_b64_tr_b16 v[24:25], v196 offset:0
s_add_u32 s20, s70, s67
v_mfma_f32_16x16x32_bf16 a[32:35], v[36:39], a[112:115], a[32:35]
ds_read_b64_tr_b16 v[26:27], v196 offset:1024
s_addc_u32 s21, s71, 0
v_mfma_f32_16x16x32_bf16 a[36:39], v[32:35], a[100:103], a[36:39]
ds_read_b64_tr_b16 v[28:29], v196 offset:8192
s_mov_b32 s23, 0x20000
v_mfma_f32_16x16x32_bf16 a[36:39], v[36:39], a[116:119], a[36:39]
ds_read_b64_tr_b16 v[30:31], v196 offset:9216
s_waitcnt lgkmcnt(4)
v_mfma_f32_16x16x32_bf16 a[40:43], v[32:35], a[104:107], a[40:43]
s_mov_b32 m0, s41
s_mov_b32 s39, 12288
v_mfma_f32_16x16x32_bf16 a[40:43], v[36:39], a[120:123], a[40:43]
buffer_load_dwordx4 v246, s[12:15], s39 offen offset:0 lds
v_mfma_f32_16x16x32_bf16 a[44:47], v[32:35], a[108:111], a[44:47]
buffer_load_dwordx4 v247, s[12:15], s39 offen offset:1024 lds
v_mfma_f32_16x16x32_bf16 a[44:47], v[36:39], a[124:127], a[44:47]
buffer_load_dwordx4 v248, s[12:15], s39 offen offset:2048 lds
v_mfma_f32_16x16x32_bf16 a[60:63], v[16:19], a[108:111], a[60:63]
ds_read_b64_tr_b16 v[32:33], v197 offset:0
s_mul_i32 s24, s36, 10240
v_mfma_f32_16x16x32_bf16 a[60:63], v[20:23], a[124:127], a[60:63]
ds_read_b64_tr_b16 v[34:35], v197 offset:1024
s_add_u32 s24, s24, 122880
v_mfma_f32_16x16x32_bf16 a[56:59], v[16:19], a[104:107], a[56:59]
ds_read_b64_tr_b16 v[36:37], v197 offset:8192
s_mov_b32 s25, 0
v_mfma_f32_16x16x32_bf16 a[56:59], v[20:23], a[120:123], a[56:59]
ds_read_b64_tr_b16 v[38:39], v197 offset:9216
s_waitcnt lgkmcnt(4)
v_mfma_f32_16x16x32_bf16 a[52:55], v[16:19], a[100:103], a[52:55]
v_mfma_f32_16x16x32_bf16 a[52:55], v[20:23], a[116:119], a[52:55]
v_mfma_f32_16x16x32_bf16 a[48:51], v[16:19], a[96:99], a[48:51]
v_mfma_f32_16x16x32_bf16 a[48:51], v[20:23], a[112:115], a[48:51]
v_mfma_f32_16x16x32_bf16 a[64:67], v[24:27], a[96:99], a[64:67]
ds_read_b64_tr_b16 v[16:17], v198 offset:0
s_lshl_b32 s26, s36, 10
v_mfma_f32_16x16x32_bf16 a[64:67], v[28:31], a[112:115], a[64:67]
ds_read_b64_tr_b16 v[18:19], v198 offset:1024
s_mov_b32 s27, s36
v_mfma_f32_16x16x32_bf16 a[68:71], v[24:27], a[100:103], a[68:71]
ds_read_b64_tr_b16 v[20:21], v198 offset:8192
s_cmp_lt_u32 s2, 192
v_mfma_f32_16x16x32_bf16 a[68:71], v[28:31], a[116:119], a[68:71]
ds_read_b64_tr_b16 v[22:23], v198 offset:9216
s_waitcnt lgkmcnt(4)
v_mfma_f32_16x16x32_bf16 a[72:75], v[24:27], a[104:107], a[72:75]
s_mov_b32 m0, s44
s_mov_b32 s63, 0
v_mfma_f32_16x16x32_bf16 a[72:75], v[28:31], a[120:123], a[72:75]
buffer_load_dwordx4 v249, s[16:19], s63 offen offset:0 lds
v_mfma_f32_16x16x32_bf16 a[76:79], v[24:27], a[108:111], a[76:79]
buffer_load_dwordx4 v250, s[16:19], s63 offen offset:1024 lds
v_mfma_f32_16x16x32_bf16 a[76:79], v[28:31], a[124:127], a[76:79]
buffer_load_dwordx4 v251, s[16:19], s63 offen offset:2048 lds
v_mfma_f32_16x16x32_bf16 a[92:95], v[32:35], a[108:111], a[92:95]
ds_read_b64_tr_b16 v[24:25], v199 offset:0
s_cselect_b32 s48, 0, 64
v_mfma_f32_16x16x32_bf16 a[92:95], v[36:39], a[124:127], a[92:95]
ds_read_b64_tr_b16 v[26:27], v199 offset:1024
s_mov_b32 s49, 512
v_mfma_f32_16x16x32_bf16 a[88:91], v[32:35], a[104:107], a[88:91]
ds_read_b64_tr_b16 v[28:29], v199 offset:8192
s_cselect_b32 s49, 20480, s49
v_mfma_f32_16x16x32_bf16 a[88:91], v[36:39], a[120:123], a[88:91]
ds_read_b64_tr_b16 v[30:31], v199 offset:9216
s_waitcnt lgkmcnt(4)
v_mfma_f32_16x16x32_bf16 a[84:87], v[32:35], a[100:103], a[84:87]
v_mfma_f32_16x16x32_bf16 a[84:87], v[36:39], a[116:119], a[84:87]
v_mfma_f32_16x16x32_bf16 a[80:83], v[32:35], a[96:99], a[80:83]
v_mfma_f32_16x16x32_bf16 a[80:83], v[36:39], a[112:115], a[80:83]
s_waitcnt vmcnt(31)
s_barrier
v_mfma_f32_16x16x32_bf16 v[48:51], v[16:19], a[96:99], v[48:51]
ds_read_b64_tr_b16 v[32:33], v204 offset:0
v_mfma_f32_16x16x32_bf16 v[48:51], v[20:23], a[112:115], v[48:51]
ds_read_b64_tr_b16 v[34:35], v204 offset:512
v_mfma_f32_16x16x32_bf16 v[52:55], v[16:19], a[100:103], v[52:55]
ds_read_b64_tr_b16 v[36:37], v204 offset:8192
v_mfma_f32_16x16x32_bf16 v[52:55], v[20:23], a[116:119], v[52:55]
ds_read_b64_tr_b16 v[38:39], v204 offset:8704
s_waitcnt lgkmcnt(4)
v_mfma_f32_16x16x32_bf16 v[56:59], v[16:19], a[104:107], v[56:59]
v_mfma_f32_16x16x32_bf16 v[56:59], v[20:23], a[120:123], v[56:59]
v_mfma_f32_16x16x32_bf16 v[60:63], v[16:19], a[108:111], v[60:63]
v_mfma_f32_16x16x32_bf16 v[60:63], v[20:23], a[124:127], v[60:63]
v_mfma_f32_16x16x32_bf16 v[76:79], v[24:27], a[108:111], v[76:79]
ds_read_b64_tr_b16 v[16:17], v205 offset:0
v_mfma_f32_16x16x32_bf16 v[76:79], v[28:31], a[124:127], v[76:79]
ds_read_b64_tr_b16 v[18:19], v205 offset:512
v_mfma_f32_16x16x32_bf16 v[72:75], v[24:27], a[104:107], v[72:75]
ds_read_b64_tr_b16 v[20:21], v205 offset:8192
v_mfma_f32_16x16x32_bf16 v[72:75], v[28:31], a[120:123], v[72:75]
ds_read_b64_tr_b16 v[22:23], v205 offset:8704
s_waitcnt lgkmcnt(4)
v_mfma_f32_16x16x32_bf16 v[68:71], v[24:27], a[100:103], v[68:71]
v_mfma_f32_16x16x32_bf16 v[68:71], v[28:31], a[116:119], v[68:71]
v_mfma_f32_16x16x32_bf16 v[64:67], v[24:27], a[96:99], v[64:67]
v_mfma_f32_16x16x32_bf16 v[64:67], v[28:31], a[112:115], v[64:67]
v_mfma_f32_16x16x32_bf16 v[144:147], v[32:35], a[96:99], v[144:147]
ds_read_b64_tr_b16 v[24:25], v206 offset:0
v_mfma_f32_16x16x32_bf16 v[144:147], v[36:39], a[112:115], v[144:147]
ds_read_b64_tr_b16 v[26:27], v206 offset:512
v_mfma_f32_16x16x32_bf16 v[148:151], v[32:35], a[100:103], v[148:151]
ds_read_b64_tr_b16 v[28:29], v206 offset:8192
v_mfma_f32_16x16x32_bf16 v[148:151], v[36:39], a[116:119], v[148:151]
ds_read_b64_tr_b16 v[30:31], v206 offset:8704
s_waitcnt lgkmcnt(4)
v_mfma_f32_16x16x32_bf16 v[152:155], v[32:35], a[104:107], v[152:155]
s_mov_b32 m0, s42
s_mov_b32 s39, 24576
v_mfma_f32_16x16x32_bf16 v[152:155], v[36:39], a[120:123], v[152:155]
buffer_load_dwordx4 v246, s[12:15], s39 offen offset:0 lds
v_mfma_f32_16x16x32_bf16 v[156:159], v[32:35], a[108:111], v[156:159]
buffer_load_dwordx4 v247, s[12:15], s39 offen offset:1024 lds
v_mfma_f32_16x16x32_bf16 v[156:159], v[36:39], a[124:127], v[156:159]
buffer_load_dwordx4 v248, s[12:15], s39 offen offset:2048 lds
v_mfma_f32_16x16x32_bf16 v[172:175], v[16:19], a[108:111], v[172:175]
ds_read_b64_tr_b16 v[32:33], v200 offset:0
v_cvt_pk_bf16_f32 v2, v144, v145
v_mfma_f32_16x16x32_bf16 v[172:175], v[20:23], a[124:127], v[172:175]
ds_read_b64_tr_b16 v[34:35], v200 offset:512
v_cvt_pk_bf16_f32 v3, v146, v147
v_mfma_f32_16x16x32_bf16 v[168:171], v[16:19], a[104:107], v[168:171]
ds_read_b64_tr_b16 v[36:37], v200 offset:8192
v_pk_max_i16 v2, v2, 0
v_mfma_f32_16x16x32_bf16 v[168:171], v[20:23], a[120:123], v[168:171]
ds_read_b64_tr_b16 v[38:39], v200 offset:8704
s_waitcnt lgkmcnt(4)
v_mfma_f32_16x16x32_bf16 v[164:167], v[16:19], a[100:103], v[164:167]
v_pk_max_i16 v3, v3, 0
v_mfma_f32_16x16x32_bf16 v[164:167], v[20:23], a[116:119], v[164:167]
buffer_store_dwordx2 v[2:3], v208, s[32:35], s6 offen offset:0 sc1
v_mfma_f32_16x16x32_bf16 v[160:163], v[16:19], a[96:99], v[160:163]
v_cvt_pk_bf16_f32 v4, v148, v149
v_cvt_pk_bf16_f32 v5, v150, v151
v_mfma_f32_16x16x32_bf16 v[160:163], v[20:23], a[112:115], v[160:163]
v_pk_max_i16 v4, v4, 0
v_pk_max_i16 v5, v5, 0
v_mfma_f32_16x16x32_bf16 v[176:179], v[24:27], a[96:99], v[176:179]
ds_read_b64_tr_b16 v[16:17], v201 offset:0
v_mfma_f32_16x16x32_bf16 v[176:179], v[28:31], a[112:115], v[176:179]
ds_read_b64_tr_b16 v[18:19], v201 offset:512
v_mfma_f32_16x16x32_bf16 v[180:183], v[24:27], a[100:103], v[180:183]
ds_read_b64_tr_b16 v[20:21], v201 offset:8192
v_mfma_f32_16x16x32_bf16 v[180:183], v[28:31], a[116:119], v[180:183]
ds_read_b64_tr_b16 v[22:23], v201 offset:8704
s_waitcnt lgkmcnt(4)
v_mfma_f32_16x16x32_bf16 v[184:187], v[24:27], a[104:107], v[184:187]
buffer_store_dwordx2 v[4:5], v208, s[32:35], s6 offen offset:1024 sc1
v_mfma_f32_16x16x32_bf16 v[184:187], v[28:31], a[120:123], v[184:187]
v_cvt_pk_bf16_f32 v6, v152, v153
v_cvt_pk_bf16_f32 v7, v154, v155
v_mfma_f32_16x16x32_bf16 v[188:191], v[24:27], a[108:111], v[188:191]
v_pk_max_i16 v6, v6, 0
v_pk_max_i16 v7, v7, 0
v_mfma_f32_16x16x32_bf16 v[188:191], v[28:31], a[124:127], v[188:191]
buffer_store_dwordx2 v[6:7], v208, s[32:35], s6 offen offset:2048 sc1
v_mfma_f32_16x16x32_bf16 v[92:95], v[32:35], a[108:111], v[92:95]
ds_read_b64_tr_b16 v[24:25], v202 offset:0
v_cvt_pk_bf16_f32 v8, v156, v157
v_mfma_f32_16x16x32_bf16 v[92:95], v[36:39], a[124:127], v[92:95]
ds_read_b64_tr_b16 v[26:27], v202 offset:512
v_cvt_pk_bf16_f32 v9, v158, v159
v_mfma_f32_16x16x32_bf16 v[88:91], v[32:35], a[104:107], v[88:91]
ds_read_b64_tr_b16 v[28:29], v202 offset:8192
v_pk_max_i16 v8, v8, 0
v_mfma_f32_16x16x32_bf16 v[88:91], v[36:39], a[120:123], v[88:91]
ds_read_b64_tr_b16 v[30:31], v202 offset:8704
s_waitcnt lgkmcnt(4)
v_mfma_f32_16x16x32_bf16 v[84:87], v[32:35], a[100:103], v[84:87]
v_pk_max_i16 v9, v9, 0
v_mfma_f32_16x16x32_bf16 v[84:87], v[36:39], a[116:119], v[84:87]
buffer_store_dwordx2 v[8:9], v208, s[32:35], s6 offen offset:3072 sc1
v_mfma_f32_16x16x32_bf16 v[80:83], v[32:35], a[96:99], v[80:83]
v_cvt_pk_bf16_f32 v10, v172, v173
v_cvt_pk_bf16_f32 v11, v174, v175
v_mfma_f32_16x16x32_bf16 v[80:83], v[36:39], a[112:115], v[80:83]
v_pk_max_i16 v10, v10, 0
v_pk_max_i16 v11, v11, 0
v_mfma_f32_16x16x32_bf16 v[96:99], v[16:19], a[96:99], v[96:99]
ds_read_b64_tr_b16 v[32:33], v203 offset:0
v_mfma_f32_16x16x32_bf16 v[96:99], v[20:23], a[112:115], v[96:99]
ds_read_b64_tr_b16 v[34:35], v203 offset:512
v_mfma_f32_16x16x32_bf16 v[100:103], v[16:19], a[100:103], v[100:103]
ds_read_b64_tr_b16 v[36:37], v203 offset:8192
v_mfma_f32_16x16x32_bf16 v[100:103], v[20:23], a[116:119], v[100:103]
ds_read_b64_tr_b16 v[38:39], v203 offset:8704
s_waitcnt lgkmcnt(4)
v_mfma_f32_16x16x32_bf16 v[104:107], v[16:19], a[104:107], v[104:107]
buffer_store_dwordx2 v[10:11], v208, s[32:35], s7 offen offset:3072 sc1
v_mfma_f32_16x16x32_bf16 v[104:107], v[20:23], a[120:123], v[104:107]
v_cvt_pk_bf16_f32 v12, v168, v169
v_cvt_pk_bf16_f32 v13, v170, v171
v_mfma_f32_16x16x32_bf16 v[108:111], v[16:19], a[108:111], v[108:111]
v_pk_max_i16 v12, v12, 0
v_pk_max_i16 v13, v13, 0
v_mfma_f32_16x16x32_bf16 v[108:111], v[20:23], a[124:127], v[108:111]
buffer_store_dwordx2 v[12:13], v208, s[32:35], s7 offen offset:2048 sc1
v_mfma_f32_16x16x32_bf16 v[124:127], v[24:27], a[108:111], v[124:127]
v_cvt_pk_bf16_f32 v2, v164, v165
v_cvt_pk_bf16_f32 v3, v166, v167
v_mfma_f32_16x16x32_bf16 v[124:127], v[28:31], a[124:127], v[124:127]
v_pk_max_i16 v2, v2, 0
v_pk_max_i16 v3, v3, 0
v_mfma_f32_16x16x32_bf16 v[120:123], v[24:27], a[104:107], v[120:123]
buffer_store_dwordx2 v[2:3], v208, s[32:35], s7 offen offset:1024 sc1
v_mfma_f32_16x16x32_bf16 v[120:123], v[28:31], a[120:123], v[120:123]
s_waitcnt lgkmcnt(0)
v_cvt_pk_bf16_f32 v4, v160, v161
v_cvt_pk_bf16_f32 v5, v162, v163
v_mfma_f32_16x16x32_bf16 v[116:119], v[24:27], a[100:103], v[116:119]
v_pk_max_i16 v4, v4, 0
v_pk_max_i16 v5, v5, 0
v_mfma_f32_16x16x32_bf16 v[116:119], v[28:31], a[116:119], v[116:119]
buffer_store_dwordx2 v[4:5], v208, s[32:35], s7 offen offset:0 sc1
v_mfma_f32_16x16x32_bf16 v[112:115], v[24:27], a[96:99], v[112:115]
v_cvt_pk_bf16_f32 v6, v176, v177
v_cvt_pk_bf16_f32 v7, v178, v179
v_mfma_f32_16x16x32_bf16 v[112:115], v[28:31], a[112:115], v[112:115]
v_pk_max_i16 v6, v6, 0
v_pk_max_i16 v7, v7, 0
v_mfma_f32_16x16x32_bf16 v[128:131], v[32:35], a[96:99], v[128:131]
buffer_store_dwordx2 v[6:7], v208, s[32:35], s62 offen offset:0 sc1
v_mfma_f32_16x16x32_bf16 v[128:131], v[36:39], a[112:115], v[128:131]
v_cvt_pk_bf16_f32 v8, v180, v181
v_cvt_pk_bf16_f32 v9, v182, v183
v_mfma_f32_16x16x32_bf16 v[132:135], v[32:35], a[100:103], v[132:135]
v_pk_max_i16 v8, v8, 0
v_pk_max_i16 v9, v9, 0
v_mfma_f32_16x16x32_bf16 v[132:135], v[36:39], a[116:119], v[132:135]
buffer_store_dwordx2 v[8:9], v208, s[32:35], s62 offen offset:1024 sc1
v_mfma_f32_16x16x32_bf16 v[136:139], v[32:35], a[104:107], v[136:139]
v_cvt_pk_bf16_f32 v10, v184, v185
v_cvt_pk_bf16_f32 v11, v186, v187
v_mfma_f32_16x16x32_bf16 v[136:139], v[36:39], a[120:123], v[136:139]
v_pk_max_i16 v10, v10, 0
v_pk_max_i16 v11, v11, 0
v_mfma_f32_16x16x32_bf16 v[140:143], v[32:35], a[108:111], v[140:143]
buffer_store_dwordx2 v[10:11], v208, s[32:35], s62 offen offset:2048 sc1
v_mfma_f32_16x16x32_bf16 v[140:143], v[36:39], a[124:127], v[140:143]
v_cvt_pk_bf16_f32 v12, v188, v189
v_cvt_pk_bf16_f32 v13, v190, v191
v_pk_max_i16 v12, v12, 0
v_pk_max_i16 v13, v13, 0
buffer_store_dwordx2 v[12:13], v208, s[32:35], s62 offen offset:3072 sc1
s_nop 7
v_pk_mul_f32 v[48:49], v[48:49], s[58:59]
v_pk_mul_f32 v[50:51], v[50:51], s[58:59]
v_pk_mul_f32 v[64:65], v[64:65], s[58:59]
v_pk_mul_f32 v[66:67], v[66:67], s[58:59]
v_cvt_pk_bf16_f32 v176, v48, v49
v_cvt_pk_bf16_f32 v177, v50, v51
v_cvt_pk_bf16_f32 v178, v64, v65
v_cvt_pk_bf16_f32 v179, v66, v67
v_pk_mul_f32 v[52:53], v[52:53], s[58:59]
v_pk_mul_f32 v[54:55], v[54:55], s[58:59]
v_pk_mul_f32 v[68:69], v[68:69], s[58:59]
v_pk_mul_f32 v[70:71], v[70:71], s[58:59]
v_cvt_pk_bf16_f32 v180, v52, v53
v_cvt_pk_bf16_f32 v181, v54, v55
v_cvt_pk_bf16_f32 v182, v68, v69
v_cvt_pk_bf16_f32 v183, v70, v71
v_pk_mul_f32 v[56:57], v[56:57], s[58:59]
v_pk_mul_f32 v[58:59], v[58:59], s[58:59]
v_pk_mul_f32 v[72:73], v[72:73], s[58:59]
v_pk_mul_f32 v[74:75], v[74:75], s[58:59]
v_cvt_pk_bf16_f32 v184, v56, v57
v_cvt_pk_bf16_f32 v185, v58, v59
v_cvt_pk_bf16_f32 v186, v72, v73
v_cvt_pk_bf16_f32 v187, v74, v75
v_pk_mul_f32 v[60:61], v[60:61], s[58:59]
v_pk_mul_f32 v[62:63], v[62:63], s[58:59]
v_pk_mul_f32 v[76:77], v[76:77], s[58:59]
v_pk_mul_f32 v[78:79], v[78:79], s[58:59]
v_cvt_pk_bf16_f32 v188, v60, v61
v_cvt_pk_bf16_f32 v189, v62, v63
v_cvt_pk_bf16_f32 v190, v76, v77
v_cvt_pk_bf16_f32 v191, v78, v79
s_mov_b32 exec_lo, 0
v_swap_b32 v176, v178
v_swap_b32 v177, v179
v_swap_b32 v180, v182
v_swap_b32 v181, v183
v_swap_b32 v184, v186
v_swap_b32 v185, v187
v_swap_b32 v188, v190
v_swap_b32 v189, v191
s_mov_b32 exec_lo, -1
v_accvgpr_write_b32 a240, v176
v_accvgpr_write_b32 a241, v177
v_accvgpr_write_b32 a242, v178
v_accvgpr_write_b32 a243, v179
v_accvgpr_write_b32 a244, v180
v_accvgpr_write_b32 a245, v181
v_accvgpr_write_b32 a246, v182
v_accvgpr_write_b32 a247, v183
v_accvgpr_write_b32 a248, v184
v_accvgpr_write_b32 a249, v185
v_accvgpr_write_b32 a250, v186
v_accvgpr_write_b32 a251, v187
v_accvgpr_write_b32 a252, v188
v_accvgpr_write_b32 a253, v189
v_accvgpr_write_b32 a254, v190
v_accvgpr_write_b32 a255, v191
v_pk_mul_f32 v[80:81], v[80:81], s[58:59]
v_pk_mul_f32 v[82:83], v[82:83], s[58:59]
v_pk_mul_f32 v[96:97], v[96:97], s[58:59]
v_pk_mul_f32 v[98:99], v[98:99], s[58:59]
v_cvt_pk_bf16_f32 v16, v80, v81
v_cvt_pk_bf16_f32 v17, v82, v83
v_cvt_pk_bf16_f32 v18, v96, v97
v_cvt_pk_bf16_f32 v19, v98, v99
v_pk_mul_f32 v[84:85], v[84:85], s[58:59]
v_pk_mul_f32 v[86:87], v[86:87], s[58:59]
v_pk_mul_f32 v[100:101], v[100:101], s[58:59]
v_pk_mul_f32 v[102:103], v[102:103], s[58:59]
v_cvt_pk_bf16_f32 v20, v84, v85
v_cvt_pk_bf16_f32 v21, v86, v87
v_cvt_pk_bf16_f32 v22, v100, v101
v_cvt_pk_bf16_f32 v23, v102, v103
v_pk_mul_f32 v[88:89], v[88:89], s[58:59]
v_pk_mul_f32 v[90:91], v[90:91], s[58:59]
v_pk_mul_f32 v[104:105], v[104:105], s[58:59]
v_pk_mul_f32 v[106:107], v[106:107], s[58:59]
v_cvt_pk_bf16_f32 v24, v88, v89
v_cvt_pk_bf16_f32 v25, v90, v91
v_cvt_pk_bf16_f32 v26, v104, v105
v_cvt_pk_bf16_f32 v27, v106, v107
v_pk_mul_f32 v[92:93], v[92:93], s[58:59]
v_pk_mul_f32 v[94:95], v[94:95], s[58:59]
v_pk_mul_f32 v[108:109], v[108:109], s[58:59]
v_pk_mul_f32 v[110:111], v[110:111], s[58:59]
v_cvt_pk_bf16_f32 v28, v92, v93
v_cvt_pk_bf16_f32 v29, v94, v95
v_cvt_pk_bf16_f32 v30, v108, v109
v_cvt_pk_bf16_f32 v31, v110, v111
s_mov_b32 exec_lo, 0
v_swap_b32 v16, v18
v_swap_b32 v17, v19
v_swap_b32 v20, v22
v_swap_b32 v21, v23
v_swap_b32 v24, v26
v_swap_b32 v25, v27
v_swap_b32 v28, v30
v_swap_b32 v29, v31
s_mov_b32 exec_lo, -1
v_pk_mul_f32 v[112:113], v[112:113], s[58:59]
v_pk_mul_f32 v[114:115], v[114:115], s[58:59]
v_pk_mul_f32 v[128:129], v[128:129], s[58:59]
v_pk_mul_f32 v[130:131], v[130:131], s[58:59]
v_cvt_pk_bf16_f32 v32, v112, v113
v_cvt_pk_bf16_f32 v33, v114, v115
v_cvt_pk_bf16_f32 v34, v128, v129
v_cvt_pk_bf16_f32 v35, v130, v131
v_pk_mul_f32 v[116:117], v[116:117], s[58:59]
v_pk_mul_f32 v[118:119], v[118:119], s[58:59]
v_pk_mul_f32 v[132:133], v[132:133], s[58:59]
v_pk_mul_f32 v[134:135], v[134:135], s[58:59]
v_cvt_pk_bf16_f32 v36, v116, v117
v_cvt_pk_bf16_f32 v37, v118, v119
v_cvt_pk_bf16_f32 v38, v132, v133
v_cvt_pk_bf16_f32 v39, v134, v135
v_pk_mul_f32 v[120:121], v[120:121], s[58:59]
v_pk_mul_f32 v[122:123], v[122:123], s[58:59]
v_pk_mul_f32 v[136:137], v[136:137], s[58:59]
v_pk_mul_f32 v[138:139], v[138:139], s[58:59]
v_cvt_pk_bf16_f32 v40, v120, v121
v_cvt_pk_bf16_f32 v41, v122, v123
v_cvt_pk_bf16_f32 v42, v136, v137
v_cvt_pk_bf16_f32 v43, v138, v139
v_pk_mul_f32 v[124:125], v[124:125], s[58:59]
v_pk_mul_f32 v[126:127], v[126:127], s[58:59]
v_pk_mul_f32 v[140:141], v[140:141], s[58:59]
v_pk_mul_f32 v[142:143], v[142:143], s[58:59]
v_cvt_pk_bf16_f32 v44, v124, v125
v_cvt_pk_bf16_f32 v45, v126, v127
v_cvt_pk_bf16_f32 v46, v140, v141
v_cvt_pk_bf16_f32 v47, v142, v143
s_mov_b32 exec_lo, 0
v_swap_b32 v32, v34
v_swap_b32 v33, v35
v_swap_b32 v36, v38
v_swap_b32 v37, v39
v_swap_b32 v40, v42
v_swap_b32 v41, v43
v_swap_b32 v44, v46
v_swap_b32 v45, v47
s_mov_b32 exec_lo, -1
v_accvgpr_read_b32 v144, a0
v_accvgpr_read_b32 v145, a1
v_accvgpr_read_b32 v146, a2
v_accvgpr_read_b32 v147, a3
v_accvgpr_read_b32 v148, a16
v_accvgpr_read_b32 v149, a17
v_accvgpr_read_b32 v150, a18
v_accvgpr_read_b32 v151, a19
v_pk_mul_f32 v[144:145], v[144:145], s[58:59]
v_pk_mul_f32 v[146:147], v[146:147], s[58:59]
v_pk_mul_f32 v[148:149], v[148:149], s[58:59]
v_pk_mul_f32 v[150:151], v[150:151], s[58:59]
v_cvt_pk_bf16_f32 v176, v144, v145
v_cvt_pk_bf16_f32 v177, v146, v147
v_cvt_pk_bf16_f32 v178, v148, v149
v_cvt_pk_bf16_f32 v179, v150, v151
v_accvgpr_read_b32 v152, a4
v_accvgpr_read_b32 v153, a5
v_accvgpr_read_b32 v154, a6
v_accvgpr_read_b32 v155, a7
v_accvgpr_read_b32 v156, a20
v_accvgpr_read_b32 v157, a21
v_accvgpr_read_b32 v158, a22
v_accvgpr_read_b32 v159, a23
v_pk_mul_f32 v[152:153], v[152:153], s[58:59]
v_pk_mul_f32 v[154:155], v[154:155], s[58:59]
v_pk_mul_f32 v[156:157], v[156:157], s[58:59]
v_pk_mul_f32 v[158:159], v[158:159], s[58:59]
v_cvt_pk_bf16_f32 v180, v152, v153
v_cvt_pk_bf16_f32 v181, v154, v155
v_cvt_pk_bf16_f32 v182, v156, v157
v_cvt_pk_bf16_f32 v183, v158, v159
v_accvgpr_read_b32 v160, a8
v_accvgpr_read_b32 v161, a9
v_accvgpr_read_b32 v162, a10
v_accvgpr_read_b32 v163, a11
v_accvgpr_read_b32 v164, a24
v_accvgpr_read_b32 v165, a25
v_accvgpr_read_b32 v166, a26
v_accvgpr_read_b32 v167, a27
v_pk_mul_f32 v[160:161], v[160:161], s[58:59]
v_pk_mul_f32 v[162:163], v[162:163], s[58:59]
v_pk_mul_f32 v[164:165], v[164:165], s[58:59]
v_pk_mul_f32 v[166:167], v[166:167], s[58:59]
v_cvt_pk_bf16_f32 v184, v160, v161
v_cvt_pk_bf16_f32 v185, v162, v163
v_cvt_pk_bf16_f32 v186, v164, v165
v_cvt_pk_bf16_f32 v187, v166, v167
v_accvgpr_read_b32 v168, a12
v_accvgpr_read_b32 v169, a13
v_accvgpr_read_b32 v170, a14
v_accvgpr_read_b32 v171, a15
v_accvgpr_read_b32 v172, a28
v_accvgpr_read_b32 v173, a29
v_accvgpr_read_b32 v174, a30
v_accvgpr_read_b32 v175, a31
v_pk_mul_f32 v[168:169], v[168:169], s[58:59]
v_pk_mul_f32 v[170:171], v[170:171], s[58:59]
v_pk_mul_f32 v[172:173], v[172:173], s[58:59]
v_pk_mul_f32 v[174:175], v[174:175], s[58:59]
v_cvt_pk_bf16_f32 v188, v168, v169
v_cvt_pk_bf16_f32 v189, v170, v171
v_cvt_pk_bf16_f32 v190, v172, v173
v_cvt_pk_bf16_f32 v191, v174, v175
s_mov_b32 exec_lo, 0
v_swap_b32 v176, v178
v_swap_b32 v177, v179
v_swap_b32 v180, v182
v_swap_b32 v181, v183
v_swap_b32 v184, v186
v_swap_b32 v185, v187
v_swap_b32 v188, v190
v_swap_b32 v189, v191
s_mov_b32 exec_lo, -1
v_accvgpr_write_b32 a192, v176
v_accvgpr_write_b32 a193, v177
v_accvgpr_write_b32 a194, v178
v_accvgpr_write_b32 a195, v179
v_accvgpr_write_b32 a196, v180
v_accvgpr_write_b32 a197, v181
v_accvgpr_write_b32 a198, v182
v_accvgpr_write_b32 a199, v183
v_accvgpr_write_b32 a200, v184
v_accvgpr_write_b32 a201, v185
v_accvgpr_write_b32 a202, v186
v_accvgpr_write_b32 a203, v187
v_accvgpr_write_b32 a204, v188
v_accvgpr_write_b32 a205, v189
v_accvgpr_write_b32 a206, v190
v_accvgpr_write_b32 a207, v191
v_accvgpr_read_b32 v144, a32
v_accvgpr_read_b32 v145, a33
v_accvgpr_read_b32 v146, a34
v_accvgpr_read_b32 v147, a35
v_accvgpr_read_b32 v148, a48
v_accvgpr_read_b32 v149, a49
v_accvgpr_read_b32 v150, a50
v_accvgpr_read_b32 v151, a51
v_pk_mul_f32 v[144:145], v[144:145], s[58:59]
v_pk_mul_f32 v[146:147], v[146:147], s[58:59]
v_pk_mul_f32 v[148:149], v[148:149], s[58:59]
v_pk_mul_f32 v[150:151], v[150:151], s[58:59]
v_cvt_pk_bf16_f32 v176, v144, v145
v_cvt_pk_bf16_f32 v177, v146, v147
v_cvt_pk_bf16_f32 v178, v148, v149
v_cvt_pk_bf16_f32 v179, v150, v151
v_accvgpr_read_b32 v152, a36
v_accvgpr_read_b32 v153, a37
v_accvgpr_read_b32 v154, a38
v_accvgpr_read_b32 v155, a39
v_accvgpr_read_b32 v156, a52
v_accvgpr_read_b32 v157, a53
v_accvgpr_read_b32 v158, a54
v_accvgpr_read_b32 v159, a55
v_pk_mul_f32 v[152:153], v[152:153], s[58:59]
v_pk_mul_f32 v[154:155], v[154:155], s[58:59]
v_pk_mul_f32 v[156:157], v[156:157], s[58:59]
v_pk_mul_f32 v[158:159], v[158:159], s[58:59]
v_cvt_pk_bf16_f32 v180, v152, v153
v_cvt_pk_bf16_f32 v181, v154, v155
v_cvt_pk_bf16_f32 v182, v156, v157
v_cvt_pk_bf16_f32 v183, v158, v159
v_accvgpr_read_b32 v160, a40
v_accvgpr_read_b32 v161, a41
v_accvgpr_read_b32 v162, a42
v_accvgpr_read_b32 v163, a43
v_accvgpr_read_b32 v164, a56
v_accvgpr_read_b32 v165, a57
v_accvgpr_read_b32 v166, a58
v_accvgpr_read_b32 v167, a59
v_pk_mul_f32 v[160:161], v[160:161], s[58:59]
v_pk_mul_f32 v[162:163], v[162:163], s[58:59]
v_pk_mul_f32 v[164:165], v[164:165], s[58:59]
v_pk_mul_f32 v[166:167], v[166:167], s[58:59]
v_cvt_pk_bf16_f32 v184, v160, v161
v_cvt_pk_bf16_f32 v185, v162, v163
v_cvt_pk_bf16_f32 v186, v164, v165
v_cvt_pk_bf16_f32 v187, v166, v167
v_accvgpr_read_b32 v168, a44
v_accvgpr_read_b32 v169, a45
v_accvgpr_read_b32 v170, a46
v_accvgpr_read_b32 v171, a47
v_accvgpr_read_b32 v172, a60
v_accvgpr_read_b32 v173, a61
v_accvgpr_read_b32 v174, a62
v_accvgpr_read_b32 v175, a63
v_pk_mul_f32 v[168:169], v[168:169], s[58:59]
v_pk_mul_f32 v[170:171], v[170:171], s[58:59]
v_pk_mul_f32 v[172:173], v[172:173], s[58:59]
v_pk_mul_f32 v[174:175], v[174:175], s[58:59]
v_cvt_pk_bf16_f32 v188, v168, v169
v_cvt_pk_bf16_f32 v189, v170, v171
v_cvt_pk_bf16_f32 v190, v172, v173
v_cvt_pk_bf16_f32 v191, v174, v175
s_mov_b32 exec_lo, 0
v_swap_b32 v176, v178
v_swap_b32 v177, v179
v_swap_b32 v180, v182
v_swap_b32 v181, v183
v_swap_b32 v184, v186
v_swap_b32 v185, v187
v_swap_b32 v188, v190
v_swap_b32 v189, v191
s_mov_b32 exec_lo, -1
v_accvgpr_write_b32 a208, v176
v_accvgpr_write_b32 a209, v177
v_accvgpr_write_b32 a210, v178
v_accvgpr_write_b32 a211, v179
v_accvgpr_write_b32 a212, v180
v_accvgpr_write_b32 a213, v181
v_accvgpr_write_b32 a214, v182
v_accvgpr_write_b32 a215, v183
v_accvgpr_write_b32 a216, v184
v_accvgpr_write_b32 a217, v185
v_accvgpr_write_b32 a218, v186
v_accvgpr_write_b32 a219, v187
v_accvgpr_write_b32 a220, v188
v_accvgpr_write_b32 a221, v189
v_accvgpr_write_b32 a222, v190
v_accvgpr_write_b32 a223, v191
v_accvgpr_read_b32 v144, a64
v_accvgpr_read_b32 v145, a65
v_accvgpr_read_b32 v146, a66
v_accvgpr_read_b32 v147, a67
v_accvgpr_read_b32 v148, a80
v_accvgpr_read_b32 v149, a81
v_accvgpr_read_b32 v150, a82
v_accvgpr_read_b32 v151, a83
v_pk_mul_f32 v[144:145], v[144:145], s[58:59]
v_pk_mul_f32 v[146:147], v[146:147], s[58:59]
v_pk_mul_f32 v[148:149], v[148:149], s[58:59]
v_pk_mul_f32 v[150:151], v[150:151], s[58:59]
v_cvt_pk_bf16_f32 v176, v144, v145
v_cvt_pk_bf16_f32 v177, v146, v147
v_cvt_pk_bf16_f32 v178, v148, v149
v_cvt_pk_bf16_f32 v179, v150, v151
v_accvgpr_read_b32 v152, a68
v_accvgpr_read_b32 v153, a69
v_accvgpr_read_b32 v154, a70
v_accvgpr_read_b32 v155, a71
v_accvgpr_read_b32 v156, a84
v_accvgpr_read_b32 v157, a85
v_accvgpr_read_b32 v158, a86
v_accvgpr_read_b32 v159, a87
v_pk_mul_f32 v[152:153], v[152:153], s[58:59]
v_pk_mul_f32 v[154:155], v[154:155], s[58:59]
v_pk_mul_f32 v[156:157], v[156:157], s[58:59]
v_pk_mul_f32 v[158:159], v[158:159], s[58:59]
v_cvt_pk_bf16_f32 v180, v152, v153
v_cvt_pk_bf16_f32 v181, v154, v155
v_cvt_pk_bf16_f32 v182, v156, v157
v_cvt_pk_bf16_f32 v183, v158, v159
v_accvgpr_read_b32 v160, a72
v_accvgpr_read_b32 v161, a73
v_accvgpr_read_b32 v162, a74
v_accvgpr_read_b32 v163, a75
v_accvgpr_read_b32 v164, a88
v_accvgpr_read_b32 v165, a89
v_accvgpr_read_b32 v166, a90
v_accvgpr_read_b32 v167, a91
v_pk_mul_f32 v[160:161], v[160:161], s[58:59]
v_pk_mul_f32 v[162:163], v[162:163], s[58:59]
v_pk_mul_f32 v[164:165], v[164:165], s[58:59]
v_pk_mul_f32 v[166:167], v[166:167], s[58:59]
v_cvt_pk_bf16_f32 v184, v160, v161
v_cvt_pk_bf16_f32 v185, v162, v163
v_cvt_pk_bf16_f32 v186, v164, v165
v_cvt_pk_bf16_f32 v187, v166, v167
v_accvgpr_read_b32 v168, a76
v_accvgpr_read_b32 v169, a77
v_accvgpr_read_b32 v170, a78
v_accvgpr_read_b32 v171, a79
v_accvgpr_read_b32 v172, a92
v_accvgpr_read_b32 v173, a93
v_accvgpr_read_b32 v174, a94
v_accvgpr_read_b32 v175, a95
v_pk_mul_f32 v[168:169], v[168:169], s[58:59]
v_pk_mul_f32 v[170:171], v[170:171], s[58:59]
v_pk_mul_f32 v[172:173], v[172:173], s[58:59]
v_pk_mul_f32 v[174:175], v[174:175], s[58:59]
v_cvt_pk_bf16_f32 v188, v168, v169
v_cvt_pk_bf16_f32 v189, v170, v171
v_cvt_pk_bf16_f32 v190, v172, v173
v_cvt_pk_bf16_f32 v191, v174, v175
s_mov_b32 exec_lo, 0
v_swap_b32 v176, v178
v_swap_b32 v177, v179
v_swap_b32 v180, v182
v_swap_b32 v181, v183
v_swap_b32 v184, v186
v_swap_b32 v185, v187
v_swap_b32 v188, v190
v_swap_b32 v189, v191
s_mov_b32 exec_lo, -1
v_accvgpr_write_b32 a224, v176
v_accvgpr_write_b32 a225, v177
v_accvgpr_write_b32 a226, v178
v_accvgpr_write_b32 a227, v179
v_accvgpr_write_b32 a228, v180
v_accvgpr_write_b32 a229, v181
v_accvgpr_write_b32 a230, v182
v_accvgpr_write_b32 a231, v183
v_accvgpr_write_b32 a232, v184
v_accvgpr_write_b32 a233, v185
v_accvgpr_write_b32 a234, v186
v_accvgpr_write_b32 a235, v187
v_accvgpr_write_b32 a236, v188
v_accvgpr_write_b32 a237, v189
v_accvgpr_write_b32 a238, v190
v_accvgpr_write_b32 a239, v191
s_waitcnt vmcnt(21)
s_barrier
ds_read_b128 v[176:179], v240 offset:0
ds_read_b128 v[180:183], v241 offset:0
ds_read_b128 v[184:187], v240 offset:128
ds_read_b128 v[188:191], v241 offset:128
ds_read_b128 v[192:195], v240 offset:256
ds_read_b128 v[196:199], v241 offset:256
ds_read_b128 v[200:203], v240 offset:6144
ds_read_b128 v[204:207], v241 offset:6144
ds_read_b128 v[208:211], v240 offset:6272
ds_read_b128 v[212:215], v241 offset:6272
ds_read_b128 v[216:219], v240 offset:6400
ds_read_b128 v[220:223], v241 offset:6400
s_mov_b32 m0, s45
s_mov_b32 s63, 12288
buffer_load_dwordx4 v249, s[16:19], s63 offen offset:0 lds
buffer_load_dwordx4 v250, s[16:19], s63 offen offset:1024 lds
buffer_load_dwordx4 v251, s[16:19], s63 offen offset:2048 lds
s_mov_b32 m0, s43
s_mov_b32 s39, 36864
buffer_load_dwordx4 v246, s[12:15], s39 offen offset:0 lds
buffer_load_dwordx4 v247, s[12:15], s39 offen offset:1024 lds
s_mov_b32 s58, 49152
buffer_load_dword v1, v252, s[12:15], s58 offen
buffer_load_dword v1, v252, s[16:19], s58 offen
s_add_u32 s58, s58, 49152
buffer_load_dword v1, v252, s[12:15], s58 offen
buffer_load_dword v1, v252, s[16:19], s58 offen
s_add_u32 s58, s58, 49152
s_mov_b32 s63, 24576
v_mov_b32 v236, 0
v_mov_b32 v237, 0
v_mov_b32 v238, 0
v_mov_b32 v239, 0
s_waitcnt lgkmcnt(6)
v_mfma_f32_16x16x32_bf16 v[64:67], v[176:179], a[192:195], 0
v_mfma_f32_16x16x32_bf16 v[64:67], v[180:183], a[208:211], v[64:67]
v_mfma_f32_16x16x32_bf16 v[64:67], v[184:187], a[224:227], v[64:67]
v_mfma_f32_16x16x32_bf16 v[64:67], v[188:191], a[240:243], v[64:67]
v_mfma_f32_16x16x32_bf16 v[64:67], v[192:195], v[16:19], v[64:67]
v_mfma_f32_16x16x32_bf16 v[64:67], v[196:199], v[32:35], v[64:67]
v_mfma_f32_16x16x32_bf16 v[68:71], v[196:199], v[36:39], 0
v_mfma_f32_16x16x32_bf16 v[68:71], v[192:195], v[20:23], v[68:71]
v_mfma_f32_16x16x32_bf16 v[68:71], v[188:191], a[244:247], v[68:71]
v_mfma_f32_16x16x32_bf16 v[68:71], v[184:187], a[228:231], v[68:71]
v_mfma_f32_16x16x32_bf16 v[68:71], v[180:183], a[212:215], v[68:71]
v_mfma_f32_16x16x32_bf16 v[68:71], v[176:179], a[196:199], v[68:71]
v_mfma_f32_16x16x32_bf16 v[72:75], v[176:179], a[200:203], 0
v_mfma_f32_16x16x32_bf16 v[72:75], v[180:183], a[216:219], v[72:75]
v_mfma_f32_16x16x32_bf16 v[72:75], v[184:187], a[232:235], v[72:75]
v_mfma_f32_16x16x32_bf16 v[72:75], v[188:191], a[248:251], v[72:75]
v_mfma_f32_16x16x32_bf16 v[72:75], v[192:195], v[24:27], v[72:75]
v_mfma_f32_16x16x32_bf16 v[72:75], v[196:199], v[40:43], v[72:75]
v_mfma_f32_16x16x32_bf16 v[76:79], v[196:199], v[44:47], 0
v_mfma_f32_16x16x32_bf16 v[76:79], v[192:195], v[28:31], v[76:79]
v_mfma_f32_16x16x32_bf16 v[76:79], v[188:191], a[252:255], v[76:79]
v_mfma_f32_16x16x32_bf16 v[76:79], v[184:187], a[236:239], v[76:79]
v_mfma_f32_16x16x32_bf16 v[76:79], v[180:183], a[220:223], v[76:79]
v_mfma_f32_16x16x32_bf16 v[76:79], v[176:179], a[204:207], v[76:79]
s_waitcnt vmcnt(27) lgkmcnt(0)
s_barrier
v_mfma_f32_16x16x32_bf16 v[96:99], v[200:203], a[192:195], 0
ds_read_b128 v[176:179], v240 offset:12288
v_mfma_f32_16x16x32_bf16 v[96:99], v[204:207], a[208:211], v[96:99]
ds_read_b128 v[180:183], v241 offset:12288
v_mfma_f32_16x16x32_bf16 v[96:99], v[208:211], a[224:227], v[96:99]
ds_read_b128 v[184:187], v240 offset:12416
v_mfma_f32_16x16x32_bf16 v[96:99], v[212:215], a[240:243], v[96:99]
ds_read_b128 v[188:191], v241 offset:12416
v_mfma_f32_16x16x32_bf16 v[96:99], v[216:219], v[16:19], v[96:99]
ds_read_b128 v[192:195], v240 offset:12544
v_mfma_f32_16x16x32_bf16 v[96:99], v[220:223], v[32:35], v[96:99]
ds_read_b128 v[196:199], v241 offset:12544
v_mfma_f32_16x16x32_bf16 v[100:103], v[220:223], v[36:39], 0
v_mfma_f32_16x16x32_bf16 v[100:103], v[216:219], v[20:23], v[100:103]
v_mfma_f32_16x16x32_bf16 v[100:103], v[212:215], a[244:247], v[100:103]
v_mfma_f32_16x16x32_bf16 v[100:103], v[208:211], a[228:231], v[100:103]
v_mfma_f32_16x16x32_bf16 v[100:103], v[204:207], a[212:215], v[100:103]
v_mfma_f32_16x16x32_bf16 v[100:103], v[200:203], a[196:199], v[100:103]
v_mfma_f32_16x16x32_bf16 v[104:107], v[200:203], a[200:203], 0
v_mfma_f32_16x16x32_bf16 v[104:107], v[204:207], a[216:219], v[104:107]
v_mfma_f32_16x16x32_bf16 v[104:107], v[208:211], a[232:235], v[104:107]
v_mfma_f32_16x16x32_bf16 v[104:107], v[212:215], a[248:251], v[104:107]
v_mfma_f32_16x16x32_bf16 v[104:107], v[216:219], v[24:27], v[104:107]
v_mfma_f32_16x16x32_bf16 v[104:107], v[220:223], v[40:43], v[104:107]
v_mfma_f32_16x16x32_bf16 v[108:111], v[220:223], v[44:47], 0
v_mfma_f32_16x16x32_bf16 v[108:111], v[216:219], v[28:31], v[108:111]
v_mfma_f32_16x16x32_bf16 v[108:111], v[212:215], a[252:255], v[108:111]
v_mfma_f32_16x16x32_bf16 v[108:111], v[208:211], a[236:239], v[108:111]
v_mfma_f32_16x16x32_bf16 v[108:111], v[204:207], a[220:223], v[108:111]
v_mfma_f32_16x16x32_bf16 v[108:111], v[200:203], a[204:207], v[108:111]
s_nop 7
v_max3_f32 v2, v64, v65, v66
v_max3_f32 v2, v2, v67, v96
v_max3_f32 v2, v2, v97, v98
v_max_f32 v2, v2, v99
v_max3_f32 v3, v68, v69, v70
v_max3_f32 v3, v3, v71, v100
v_max3_f32 v3, v3, v101, v102
v_max_f32 v3, v3, v103
v_max3_f32 v4, v72, v73, v74
v_max3_f32 v4, v4, v75, v104
v_max3_f32 v4, v4, v105, v106
v_max_f32 v4, v4, v107
v_max3_f32 v5, v76, v77, v78
v_max3_f32 v5, v5, v79, v108
v_max3_f32 v5, v5, v109, v110
v_max_f32 v5, v5, v111
v_mov_b32 v6, v2
v_mov_b32 v7, v3
v_mov_b32 v8, v4
v_mov_b32 v9, v5
s_nop 1
v_permlane16_swap_b32 v2, v6
v_permlane16_swap_b32 v3, v7
v_permlane16_swap_b32 v4, v8
v_permlane16_swap_b32 v5, v9
v_max_f32 v2, v2, v6
v_max_f32 v3, v3, v7
v_max_f32 v4, v4, v8
v_max_f32 v5, v5, v9
v_mov_b32 v6, v2
v_mov_b32 v7, v3
v_mov_b32 v8, v4
v_mov_b32 v9, v5
s_nop 1
v_permlane32_swap_b32 v2, v6
v_permlane32_swap_b32 v3, v7
v_permlane32_swap_b32 v4, v8
v_permlane32_swap_b32 v5, v9
v_max_f32 v2, v2, v6
v_max_f32 v3, v3, v7
v_max_f32 v4, v4, v8
v_max_f32 v5, v5, v9
v_ceil_f32 v2, v2
v_ceil_f32 v3, v3
v_ceil_f32 v4, v4
v_ceil_f32 v5, v5
v_sub_f32 v48, 0, v2
v_sub_f32 v64, v64, v2
v_sub_f32 v96, v96, v2
v_sub_f32 v49, 0, v2
v_sub_f32 v65, v65, v2
v_sub_f32 v97, v97, v2
v_sub_f32 v50, 0, v2
v_sub_f32 v66, v66, v2
v_sub_f32 v98, v98, v2
v_sub_f32 v51, 0, v2
v_sub_f32 v67, v67, v2
v_sub_f32 v99, v99, v2
v_sub_f32 v52, 0, v3
v_sub_f32 v68, v68, v3
v_sub_f32 v100, v100, v3
v_sub_f32 v53, 0, v3
v_sub_f32 v69, v69, v3
v_sub_f32 v101, v101, v3
v_sub_f32 v54, 0, v3
v_sub_f32 v70, v70, v3
v_sub_f32 v102, v102, v3
v_sub_f32 v55, 0, v3
v_sub_f32 v71, v71, v3
v_sub_f32 v103, v103, v3
v_sub_f32 v56, 0, v4
v_sub_f32 v72, v72, v4
v_sub_f32 v104, v104, v4
v_sub_f32 v57, 0, v4
v_sub_f32 v73, v73, v4
v_sub_f32 v105, v105, v4
v_sub_f32 v58, 0, v4
v_sub_f32 v74, v74, v4
v_sub_f32 v106, v106, v4
v_sub_f32 v59, 0, v4
v_sub_f32 v75, v75, v4
v_sub_f32 v107, v107, v4
v_sub_f32 v60, 0, v5
v_sub_f32 v76, v76, v5
v_sub_f32 v108, v108, v5
v_sub_f32 v61, 0, v5
v_sub_f32 v77, v77, v5
v_sub_f32 v109, v109, v5
v_sub_f32 v62, 0, v5
v_sub_f32 v78, v78, v5
v_sub_f32 v110, v110, v5
v_sub_f32 v63, 0, v5
v_sub_f32 v79, v79, v5
v_sub_f32 v111, v111, v5
v_exp_f32 v224, v64
v_exp_f32 v225, v65
v_exp_f32 v226, v66
v_exp_f32 v227, v67
v_exp_f32 v228, v68
v_exp_f32 v229, v69
v_exp_f32 v230, v70
v_exp_f32 v231, v71
v_add_f32 v232, v224, v225
v_cvt_pk_bf16_f32 v112, v224, v225
v_add_f32 v232, v232, v226
v_add_f32 v232, v232, v227
v_cvt_pk_bf16_f32 v113, v226, v227
v_add_f32 v233, v228, v229
v_cvt_pk_bf16_f32 v116, v228, v229
v_add_f32 v233, v233, v230
v_add_f32 v233, v233, v231
v_cvt_pk_bf16_f32 v117, v230, v231
v_exp_f32 v224, v72
v_exp_f32 v225, v73
v_exp_f32 v226, v74
v_exp_f32 v227, v75
v_exp_f32 v228, v76
v_exp_f32 v229, v77
v_exp_f32 v230, v78
v_exp_f32 v231, v79
v_add_f32 v234, v224, v225
v_cvt_pk_bf16_f32 v120, v224, v225
v_add_f32 v234, v234, v226
v_add_f32 v234, v234, v227
v_cvt_pk_bf16_f32 v121, v226, v227
v_add_f32 v235, v228, v229
v_cvt_pk_bf16_f32 v124, v228, v229
v_add_f32 v235, v235, v230
v_add_f32 v235, v235, v231
v_cvt_pk_bf16_f32 v125, v230, v231
v_exp_f32 v224, v96
v_exp_f32 v225, v97
v_exp_f32 v226, v98
v_exp_f32 v227, v99
v_exp_f32 v228, v100
v_exp_f32 v229, v101
v_exp_f32 v230, v102
v_exp_f32 v231, v103
v_add_f32 v232, v232, v224
v_add_f32 v232, v232, v225
v_cvt_pk_bf16_f32 v114, v224, v225
v_add_f32 v232, v232, v226
v_add_f32 v232, v232, v227
v_cvt_pk_bf16_f32 v115, v226, v227
v_add_f32 v233, v233, v228
v_add_f32 v233, v233, v229
v_cvt_pk_bf16_f32 v118, v228, v229
v_add_f32 v233, v233, v230
v_add_f32 v233, v233, v231
v_cvt_pk_bf16_f32 v119, v230, v231
s_waitcnt lgkmcnt(0)
s_mov_b32 s57, 0
v_mfma_f32_16x16x32_bf16 v[80:83], v[176:179], a[192:195], v[48:51]
v_exp_f32 v224, v104
v_mfma_f32_16x16x32_bf16 v[80:83], v[180:183], a[208:211], v[80:83]
v_exp_f32 v225, v105
v_mfma_f32_16x16x32_bf16 v[80:83], v[184:187], a[224:227], v[80:83]
v_add_f32 v234, v234, v224
v_mfma_f32_16x16x32_bf16 v[80:83], v[188:191], a[240:243], v[80:83]
v_exp_f32 v226, v106
v_mfma_f32_16x16x32_bf16 v[80:83], v[192:195], v[16:19], v[80:83]
v_add_f32 v234, v234, v225
v_mfma_f32_16x16x32_bf16 v[80:83], v[196:199], v[32:35], v[80:83]
v_exp_f32 v227, v107
v_mfma_f32_16x16x32_bf16 v[84:87], v[196:199], v[36:39], v[52:55]
v_cvt_pk_bf16_f32 v122, v224, v225
v_mfma_f32_16x16x32_bf16 v[84:87], v[192:195], v[20:23], v[84:87]
v_exp_f32 v228, v108
v_mfma_f32_16x16x32_bf16 v[84:87], v[188:191], a[244:247], v[84:87]
v_add_f32 v234, v234, v226
v_mfma_f32_16x16x32_bf16 v[84:87], v[184:187], a[228:231], v[84:87]
v_exp_f32 v229, v109
v_mfma_f32_16x16x32_bf16 v[84:87], v[180:183], a[212:215], v[84:87]
v_add_f32 v234, v234, v227
v_mfma_f32_16x16x32_bf16 v[84:87], v[176:179], a[196:199], v[84:87]
v_exp_f32 v230, v110
v_mfma_f32_16x16x32_bf16 v[88:91], v[176:179], a[200:203], v[56:59]
v_cvt_pk_bf16_f32 v123, v226, v227
v_mfma_f32_16x16x32_bf16 v[88:91], v[180:183], a[216:219], v[88:91]
v_exp_f32 v231, v111
v_mfma_f32_16x16x32_bf16 v[88:91], v[184:187], a[232:235], v[88:91]
v_add_f32 v235, v235, v228
v_mfma_f32_16x16x32_bf16 v[88:91], v[188:191], a[248:251], v[88:91]
v_add_f32 v235, v235, v229
v_mfma_f32_16x16x32_bf16 v[88:91], v[192:195], v[24:27], v[88:91]
v_cvt_pk_bf16_f32 v126, v228, v229
v_mfma_f32_16x16x32_bf16 v[88:91], v[196:199], v[40:43], v[88:91]
v_add_f32 v235, v235, v230
v_mfma_f32_16x16x32_bf16 v[92:95], v[196:199], v[44:47], v[60:63]
v_add_f32 v235, v235, v231
v_mfma_f32_16x16x32_bf16 v[92:95], v[192:195], v[28:31], v[92:95]
v_cvt_pk_bf16_f32 v127, v230, v231
v_mfma_f32_16x16x32_bf16 v[92:95], v[188:191], a[252:255], v[92:95]
v_max3_f32 v224, v232, v233, v234
v_max_f32 v224, v224, v235
v_mfma_f32_16x16x32_bf16 v[92:95], v[184:187], a[236:239], v[92:95]
v_cmp_lt_f32 vcc, s60, v224
v_mfma_f32_16x16x32_bf16 v[92:95], v[180:183], a[220:223], v[92:95]
buffer_load_dwordx4 v248, s[12:15], s39 offen offset:2048 lds
v_mfma_f32_16x16x32_bf16 v[92:95], v[176:179], a[204:207], v[92:95]
s_cbranch_vccnz F_TR0
F_BK0:
ds_read_b128 v[176:179], v240 offset:18432
ds_read_b128 v[180:183], v241 offset:18432
ds_read_b128 v[184:187], v240 offset:18560
ds_read_b128 v[188:191], v241 offset:18560
ds_read_b128 v[192:195], v240 offset:18688
ds_read_b128 v[196:199], v241 offset:18688
s_add_u32 s39, s39, 12288
s_mov_b32 m0, s40
s_nop 3
buffer_load_dwordx4 v246, s[12:15], s39 offen offset:0 lds
buffer_load_dwordx4 v247, s[12:15], s39 offen offset:1024 lds
v_exp_f32 v224, v80
v_exp_f32 v225, v81
v_exp_f32 v226, v82
v_exp_f32 v227, v83
v_exp_f32 v228, v84
v_exp_f32 v229, v85
v_exp_f32 v230, v86
v_exp_f32 v231, v87
v_add_f32 v236, v236, v232
v_add_f32 v237, v237, v233
v_add_f32 v238, v238, v234
v_add_f32 v239, v239, v235
v_add_f32 v232, v224, v225
v_cvt_pk_bf16_f32 v128, v224, v225
v_add_f32 v232, v232, v226
v_add_f32 v232, v232, v227
v_cvt_pk_bf16_f32 v129, v226, v227
v_add_f32 v233, v228, v229
v_cvt_pk_bf16_f32 v132, v228, v229
v_add_f32 v233, v233, v230
v_add_f32 v233, v233, v231
v_cvt_pk_bf16_f32 v133, v230, v231
s_waitcnt lgkmcnt(0)
v_mfma_f32_16x16x32_bf16 v[96:99], v[176:179], a[192:195], v[48:51]
v_exp_f32 v224, v88
v_mfma_f32_16x16x32_bf16 v[96:99], v[180:183], a[208:211], v[96:99]
v_mfma_f32_16x16x32_bf16 v[96:99], v[184:187], a[224:227], v[96:99]
v_exp_f32 v225, v89
v_mfma_f32_16x16x32_bf16 v[96:99], v[188:191], a[240:243], v[96:99]
v_add_f32 v234, v224, v225
v_mfma_f32_16x16x32_bf16 v[96:99], v[192:195], v[16:19], v[96:99]
v_exp_f32 v226, v90
v_mfma_f32_16x16x32_bf16 v[96:99], v[196:199], v[32:35], v[96:99]
v_cvt_pk_bf16_f32 v136, v224, v225
v_mfma_f32_16x16x32_bf16 v[100:103], v[196:199], v[36:39], v[52:55]
v_exp_f32 v227, v91
v_mfma_f32_16x16x32_bf16 v[100:103], v[192:195], v[20:23], v[100:103]
v_add_f32 v234, v234, v226
v_mfma_f32_16x16x32_bf16 v[100:103], v[188:191], a[244:247], v[100:103]
v_exp_f32 v228, v92
v_mfma_f32_16x16x32_bf16 v[100:103], v[184:187], a[228:231], v[100:103]
v_add_f32 v234, v234, v227
v_mfma_f32_16x16x32_bf16 v[100:103], v[180:183], a[212:215], v[100:103]
v_exp_f32 v229, v93
v_mfma_f32_16x16x32_bf16 v[100:103], v[176:179], a[196:199], v[100:103]
v_cvt_pk_bf16_f32 v137, v226, v227
v_mfma_f32_16x16x32_bf16 v[104:107], v[176:179], a[200:203], v[56:59]
v_exp_f32 v230, v94
v_mfma_f32_16x16x32_bf16 v[104:107], v[180:183], a[216:219], v[104:107]
v_add_f32 v235, v228, v229
v_mfma_f32_16x16x32_bf16 v[104:107], v[184:187], a[232:235], v[104:107]
v_exp_f32 v231, v95
v_mfma_f32_16x16x32_bf16 v[104:107], v[188:191], a[248:251], v[104:107]
v_cvt_pk_bf16_f32 v140, v228, v229
v_mfma_f32_16x16x32_bf16 v[104:107], v[192:195], v[24:27], v[104:107]
v_add_f32 v235, v235, v230
v_mfma_f32_16x16x32_bf16 v[104:107], v[196:199], v[40:43], v[104:107]
v_add_f32 v235, v235, v231
v_mfma_f32_16x16x32_bf16 v[108:111], v[196:199], v[44:47], v[60:63]
v_cvt_pk_bf16_f32 v141, v230, v231
v_mfma_f32_16x16x32_bf16 v[108:111], v[192:195], v[28:31], v[108:111]
v_mfma_f32_16x16x32_bf16 v[108:111], v[188:191], a[252:255], v[108:111]
buffer_load_dwordx4 v248, s[12:15], s39 offen offset:2048 lds
v_mfma_f32_16x16x32_bf16 v[108:111], v[184:187], a[236:239], v[108:111]
s_add_u32 s39, s39, 12288
v_mfma_f32_16x16x32_bf16 v[108:111], v[180:183], a[220:223], v[108:111]
v_mfma_f32_16x16x32_bf16 v[108:111], v[176:179], a[204:207], v[108:111]
s_waitcnt vmcnt(10) lgkmcnt(0)
s_barrier
ds_read_b128 v[176:179], v240 offset:24576
ds_read_b128 v[180:183], v241 offset:24576
ds_read_b128 v[184:187], v240 offset:24704
ds_read_b128 v[188:191], v241 offset:24704
ds_read_b128 v[192:195], v240 offset:24832
ds_read_b128 v[196:199], v241 offset:24832
s_mov_b32 m0, s46
s_nop 3
buffer_load_dwordx4 v249, s[16:19], s63 offen offset:0 lds
buffer_load_dwordx4 v250, s[16:19], s63 offen offset:1024 lds
v_exp_f32 v224, v96
v_exp_f32 v225, v97
v_exp_f32 v226, v98
v_exp_f32 v227, v99
v_exp_f32 v228, v100
v_exp_f32 v229, v101
v_exp_f32 v230, v102
v_exp_f32 v231, v103
v_add_f32 v232, v232, v224
v_add_f32 v232, v232, v225
v_cvt_pk_bf16_f32 v130, v224, v225
v_add_f32 v232, v232, v226
v_add_f32 v232, v232, v227
v_cvt_pk_bf16_f32 v131, v226, v227
v_add_f32 v233, v233, v228
v_add_f32 v233, v233, v229
v_cvt_pk_bf16_f32 v134, v228, v229
v_add_f32 v233, v233, v230
v_add_f32 v233, v233, v231
v_cvt_pk_bf16_f32 v135, v230, v231
s_waitcnt lgkmcnt(0)
v_mfma_f32_16x16x32_bf16 v[64:67], v[176:179], a[192:195], v[48:51]
v_exp_f32 v224, v104
v_mfma_f32_16x16x32_bf16 v[64:67], v[180:183], a[208:211], v[64:67]
v_exp_f32 v225, v105
v_mfma_f32_16x16x32_bf16 v[64:67], v[184:187], a[224:227], v[64:67]
ds_read_b64_tr_b16 v[200:201], v242 offset:0
v_add_f32 v234, v234, v224
v_mfma_f32_16x16x32_bf16 v[64:67], v[188:191], a[240:243], v[64:67]
v_exp_f32 v226, v106
v_mfma_f32_16x16x32_bf16 v[64:67], v[192:195], v[16:19], v[64:67]
ds_read_b64_tr_b16 v[202:203], v242 offset:6144
v_add_f32 v234, v234, v225
v_mfma_f32_16x16x32_bf16 v[64:67], v[196:199], v[32:35], v[64:67]
v_exp_f32 v227, v107
v_mfma_f32_16x16x32_bf16 v[68:71], v[196:199], v[36:39], v[52:55]
ds_read_b64_tr_b16 v[204:205], v242 offset:12288
v_cvt_pk_bf16_f32 v138, v224, v225
v_mfma_f32_16x16x32_bf16 v[68:71], v[192:195], v[20:23], v[68:71]
v_exp_f32 v228, v108
v_mfma_f32_16x16x32_bf16 v[68:71], v[188:191], a[244:247], v[68:71]
ds_read_b64_tr_b16 v[206:207], v242 offset:18432
v_add_f32 v234, v234, v226
v_mfma_f32_16x16x32_bf16 v[68:71], v[184:187], a[228:231], v[68:71]
v_exp_f32 v229, v109
v_mfma_f32_16x16x32_bf16 v[68:71], v[180:183], a[212:215], v[68:71]
ds_read_b64_tr_b16 v[208:209], v243 offset:0
v_add_f32 v234, v234, v227
v_mfma_f32_16x16x32_bf16 v[68:71], v[176:179], a[196:199], v[68:71]
v_exp_f32 v230, v110
v_mfma_f32_16x16x32_bf16 v[72:75], v[176:179], a[200:203], v[56:59]
ds_read_b64_tr_b16 v[210:211], v243 offset:6144
v_cvt_pk_bf16_f32 v139, v226, v227
v_mfma_f32_16x16x32_bf16 v[72:75], v[180:183], a[216:219], v[72:75]
v_exp_f32 v231, v111
v_mfma_f32_16x16x32_bf16 v[72:75], v[184:187], a[232:235], v[72:75]
ds_read_b64_tr_b16 v[212:213], v243 offset:12288
v_add_f32 v235, v235, v228
v_mfma_f32_16x16x32_bf16 v[72:75], v[188:191], a[248:251], v[72:75]
ds_read_b64_tr_b16 v[214:215], v243 offset:18432
v_add_f32 v235, v235, v229
v_mfma_f32_16x16x32_bf16 v[72:75], v[192:195], v[24:27], v[72:75]
ds_read_b64_tr_b16 v[216:217], v244 offset:0
v_cvt_pk_bf16_f32 v142, v228, v229
v_mfma_f32_16x16x32_bf16 v[72:75], v[196:199], v[40:43], v[72:75]
ds_read_b64_tr_b16 v[218:219], v244 offset:6144
v_add_f32 v235, v235, v230
v_mfma_f32_16x16x32_bf16 v[76:79], v[196:199], v[44:47], v[60:63]
ds_read_b64_tr_b16 v[220:221], v244 offset:12288
v_add_f32 v235, v235, v231
v_mfma_f32_16x16x32_bf16 v[76:79], v[192:195], v[28:31], v[76:79]
ds_read_b64_tr_b16 v[222:223], v244 offset:18432
v_cvt_pk_bf16_f32 v143, v230, v231
v_mfma_f32_16x16x32_bf16 v[76:79], v[188:191], a[252:255], v[76:79]
v_max3_f32 v224, v232, v233, v234
v_max_f32 v224, v224, v235
v_mfma_f32_16x16x32_bf16 v[76:79], v[184:187], a[236:239], v[76:79]
v_cmp_lt_f32 vcc, s60, v224
v_mfma_f32_16x16x32_bf16 v[76:79], v[180:183], a[220:223], v[76:79]
buffer_load_dwordx4 v251, s[16:19], s63 offen offset:2048 lds
v_mfma_f32_16x16x32_bf16 v[76:79], v[176:179], a[204:207], v[76:79]
s_waitcnt lgkmcnt(6)
s_cbranch_vccnz F_TR1
F_BK1:
v_mfma_f32_16x16x32_bf16 a[0:3], v[200:203], v[112:115], 0
ds_read_b128 v[176:179], v240 offset:30720
v_add_f32 v236, v236, v232
v_mfma_f32_16x16x32_bf16 a[0:3], v[204:207], v[128:131], a[0:3]
v_exp_f32 v224, v64
v_mfma_f32_16x16x32_bf16 a[4:7], v[200:203], v[116:119], 0
ds_read_b128 v[180:183], v241 offset:30720
v_add_f32 v237, v237, v233
v_mfma_f32_16x16x32_bf16 a[4:7], v[204:207], v[132:135], a[4:7]
s_add_u32 s63, s63, 12288
v_exp_f32 v225, v65
v_mfma_f32_16x16x32_bf16 a[8:11], v[200:203], v[120:123], 0
ds_read_b128 v[184:187], v240 offset:30848
v_add_f32 v238, v238, v234
v_mfma_f32_16x16x32_bf16 a[8:11], v[204:207], v[136:139], a[8:11]
v_exp_f32 v226, v66
v_mfma_f32_16x16x32_bf16 a[12:15], v[200:203], v[124:127], 0
ds_read_b128 v[188:191], v241 offset:30848
v_add_f32 v239, v239, v235
v_mfma_f32_16x16x32_bf16 a[12:15], v[204:207], v[140:143], a[12:15]
s_waitcnt lgkmcnt(4)
v_exp_f32 v227, v67
v_mfma_f32_16x16x32_bf16 a[28:31], v[208:211], v[124:127], 0
ds_read_b128 v[192:195], v240 offset:30976
v_add_f32 v232, v224, v225
v_mfma_f32_16x16x32_bf16 a[28:31], v[212:215], v[140:143], a[28:31]
v_exp_f32 v228, v68
v_mfma_f32_16x16x32_bf16 a[24:27], v[208:211], v[120:123], 0
ds_read_b128 v[196:199], v241 offset:30976
v_cvt_pk_bf16_f32 v144, v224, v225
v_mfma_f32_16x16x32_bf16 a[24:27], v[212:215], v[136:139], a[24:27]
v_exp_f32 v229, v69
v_mfma_f32_16x16x32_bf16 a[20:23], v[208:211], v[116:119], 0
v_exp_f32 v230, v70
v_mfma_f32_16x16x32_bf16 a[20:23], v[212:215], v[132:135], a[20:23]
s_mov_b32 m0, s47
v_exp_f32 v231, v71
v_mfma_f32_16x16x32_bf16 a[16:19], v[208:211], v[112:115], 0
buffer_load_dwordx4 v249, s[16:19], s63 offen offset:0 lds
v_mfma_f32_16x16x32_bf16 a[16:19], v[212:215], v[128:131], a[16:19]
v_add_f32 v232, v232, v226
v_add_f32 v232, v232, v227
v_mfma_f32_16x16x32_bf16 a[32:35], v[216:219], v[112:115], 0
v_cvt_pk_bf16_f32 v145, v226, v227
v_add_f32 v233, v228, v229
v_mfma_f32_16x16x32_bf16 a[32:35], v[220:223], v[128:131], a[32:35]
buffer_load_dwordx4 v250, s[16:19], s63 offen offset:1024 lds
v_mfma_f32_16x16x32_bf16 a[36:39], v[216:219], v[116:119], 0
v_cvt_pk_bf16_f32 v148, v228, v229
v_add_f32 v233, v233, v230
v_mfma_f32_16x16x32_bf16 a[36:39], v[220:223], v[132:135], a[36:39]
v_add_f32 v233, v233, v231
v_cvt_pk_bf16_f32 v149, v230, v231
v_mfma_f32_16x16x32_bf16 a[40:43], v[216:219], v[120:123], 0
v_mfma_f32_16x16x32_bf16 a[40:43], v[220:223], v[136:139], a[40:43]
v_mfma_f32_16x16x32_bf16 a[44:47], v[216:219], v[124:127], 0
v_mfma_f32_16x16x32_bf16 a[44:47], v[220:223], v[140:143], a[44:47]
s_waitcnt lgkmcnt(0)
v_mfma_f32_16x16x32_bf16 v[96:99], v[176:179], a[192:195], v[48:51]
v_exp_f32 v224, v72
v_mfma_f32_16x16x32_bf16 v[96:99], v[180:183], a[208:211], v[96:99]
ds_read_b64_tr_b16 v[200:201], v245 offset:0
v_mfma_f32_16x16x32_bf16 v[96:99], v[184:187], a[224:227], v[96:99]
v_exp_f32 v225, v73
v_mfma_f32_16x16x32_bf16 v[96:99], v[188:191], a[240:243], v[96:99]
ds_read_b64_tr_b16 v[202:203], v245 offset:6144
v_add_f32 v234, v224, v225
v_mfma_f32_16x16x32_bf16 v[96:99], v[192:195], v[16:19], v[96:99]
v_exp_f32 v226, v74
v_mfma_f32_16x16x32_bf16 v[96:99], v[196:199], v[32:35], v[96:99]
ds_read_b64_tr_b16 v[204:205], v245 offset:12288
v_cvt_pk_bf16_f32 v152, v224, v225
v_mfma_f32_16x16x32_bf16 v[100:103], v[196:199], v[36:39], v[52:55]
v_exp_f32 v227, v75
v_mfma_f32_16x16x32_bf16 v[100:103], v[192:195], v[20:23], v[100:103]
ds_read_b64_tr_b16 v[206:207], v245 offset:18432
v_add_f32 v234, v234, v226
v_mfma_f32_16x16x32_bf16 v[100:103], v[188:191], a[244:247], v[100:103]
v_exp_f32 v228, v76
v_mfma_f32_16x16x32_bf16 v[100:103], v[184:187], a[228:231], v[100:103]
ds_read_b64_tr_b16 v[208:209], v242 offset:128
v_add_f32 v234, v234, v227
v_mfma_f32_16x16x32_bf16 v[100:103], v[180:183], a[212:215], v[100:103]
v_exp_f32 v229, v77
v_mfma_f32_16x16x32_bf16 v[100:103], v[176:179], a[196:199], v[100:103]
ds_read_b64_tr_b16 v[210:211], v242 offset:6272
v_cvt_pk_bf16_f32 v153, v226, v227
v_mfma_f32_16x16x32_bf16 v[104:107], v[176:179], a[200:203], v[56:59]
v_exp_f32 v230, v78
v_mfma_f32_16x16x32_bf16 v[104:107], v[180:183], a[216:219], v[104:107]
ds_read_b64_tr_b16 v[212:213], v242 offset:12416
v_add_f32 v235, v228, v229
v_mfma_f32_16x16x32_bf16 v[104:107], v[184:187], a[232:235], v[104:107]
v_exp_f32 v231, v79
v_mfma_f32_16x16x32_bf16 v[104:107], v[188:191], a[248:251], v[104:107]
ds_read_b64_tr_b16 v[214:215], v242 offset:18560
v_cvt_pk_bf16_f32 v156, v228, v229
v_mfma_f32_16x16x32_bf16 v[104:107], v[192:195], v[24:27], v[104:107]
ds_read_b64_tr_b16 v[216:217], v243 offset:128
v_add_f32 v235, v235, v230
v_mfma_f32_16x16x32_bf16 v[104:107], v[196:199], v[40:43], v[104:107]
ds_read_b64_tr_b16 v[218:219], v243 offset:6272
v_add_f32 v235, v235, v231
v_mfma_f32_16x16x32_bf16 v[108:111], v[196:199], v[44:47], v[60:63]
ds_read_b64_tr_b16 v[220:221], v243 offset:12416
v_cvt_pk_bf16_f32 v157, v230, v231
v_mfma_f32_16x16x32_bf16 v[108:111], v[192:195], v[28:31], v[108:111]
ds_read_b64_tr_b16 v[222:223], v243 offset:18560
v_mfma_f32_16x16x32_bf16 v[108:111], v[188:191], a[252:255], v[108:111]
buffer_load_dwordx4 v251, s[16:19], s63 offen offset:2048 lds
v_mfma_f32_16x16x32_bf16 v[108:111], v[184:187], a[236:239], v[108:111]
s_add_u32 s63, s63, 12288
v_mfma_f32_16x16x32_bf16 v[108:111], v[180:183], a[220:223], v[108:111]
v_mfma_f32_16x16x32_bf16 v[108:111], v[176:179], a[204:207], v[108:111]
s_waitcnt vmcnt(9) lgkmcnt(0)
s_barrier
v_mfma_f32_16x16x32_bf16 a[60:63], v[200:203], v[124:127], 0
s_mov_b32 m0, s41
v_exp_f32 v224, v96
v_mfma_f32_16x16x32_bf16 a[60:63], v[204:207], v[140:143], a[60:63]
buffer_load_dwordx4 v246, s[12:15], s39 offen offset:0 lds
v_mfma_f32_16x16x32_bf16 a[56:59], v[200:203], v[120:123], 0
v_exp_f32 v225, v97
v_mfma_f32_16x16x32_bf16 a[56:59], v[204:207], v[136:139], a[56:59]
buffer_load_dwordx4 v247, s[12:15], s39 offen offset:1024 lds
v_mfma_f32_16x16x32_bf16 a[52:55], v[200:203], v[116:119], 0
ds_read_b128 v[176:179], v240 offset:36864
v_add_f32 v232, v232, v224
v_mfma_f32_16x16x32_bf16 a[52:55], v[204:207], v[132:135], a[52:55]
v_exp_f32 v226, v98
v_mfma_f32_16x16x32_bf16 a[48:51], v[200:203], v[112:115], 0
ds_read_b128 v[180:183], v241 offset:36864
v_add_f32 v232, v232, v225
v_mfma_f32_16x16x32_bf16 a[48:51], v[204:207], v[128:131], a[48:51]
v_exp_f32 v227, v99
v_mfma_f32_16x16x32_bf16 a[64:67], v[208:211], v[112:115], 0
ds_read_b128 v[184:187], v240 offset:36992
v_cvt_pk_bf16_f32 v146, v224, v225
v_mfma_f32_16x16x32_bf16 a[64:67], v[212:215], v[128:131], a[64:67]
v_exp_f32 v228, v100
v_mfma_f32_16x16x32_bf16 a[68:71], v[208:211], v[116:119], 0
ds_read_b128 v[188:191], v241 offset:36992
v_add_f32 v232, v232, v226
v_mfma_f32_16x16x32_bf16 a[68:71], v[212:215], v[132:135], a[68:71]
v_exp_f32 v229, v101
v_mfma_f32_16x16x32_bf16 a[72:75], v[208:211], v[120:123], 0
ds_read_b128 v[192:195], v240 offset:37120
v_add_f32 v232, v232, v227
v_mfma_f32_16x16x32_bf16 a[72:75], v[212:215], v[136:139], a[72:75]
v_exp_f32 v230, v102
v_mfma_f32_16x16x32_bf16 a[76:79], v[208:211], v[124:127], 0
ds_read_b128 v[196:199], v241 offset:37120
v_cvt_pk_bf16_f32 v147, v226, v227
v_mfma_f32_16x16x32_bf16 a[76:79], v[212:215], v[140:143], a[76:79]
v_exp_f32 v231, v103
v_mfma_f32_16x16x32_bf16 a[92:95], v[216:219], v[124:127], 0
v_add_f32 v233, v233, v228
v_add_f32 v233, v233, v229
v_mfma_f32_16x16x32_bf16 a[92:95], v[220:223], v[140:143], a[92:95]
v_cvt_pk_bf16_f32 v150, v228, v229
v_add_f32 v233, v233, v230
v_mfma_f32_16x16x32_bf16 a[88:91], v[216:219], v[120:123], 0
v_add_f32 v233, v233, v231
v_cvt_pk_bf16_f32 v151, v230, v231
v_mfma_f32_16x16x32_bf16 a[88:91], v[220:223], v[136:139], a[88:91]
v_mfma_f32_16x16x32_bf16 a[84:87], v[216:219], v[116:119], 0
v_mfma_f32_16x16x32_bf16 a[84:87], v[220:223], v[132:135], a[84:87]
v_mfma_f32_16x16x32_bf16 a[80:83], v[216:219], v[112:115], 0
s_waitcnt lgkmcnt(0)
v_mfma_f32_16x16x32_bf16 a[80:83], v[220:223], v[128:131], a[80:83]
v_mfma_f32_16x16x32_bf16 v[80:83], v[176:179], a[192:195], v[48:51]
v_exp_f32 v224, v104
v_mfma_f32_16x16x32_bf16 v[80:83], v[180:183], a[208:211], v[80:83]
v_exp_f32 v225, v105
v_mfma_f32_16x16x32_bf16 v[80:83], v[184:187], a[224:227], v[80:83]
ds_read_b64_tr_b16 v[200:201], v244 offset:128
v_add_f32 v234, v234, v224
v_mfma_f32_16x16x32_bf16 v[80:83], v[188:191], a[240:243], v[80:83]
v_exp_f32 v226, v106
v_mfma_f32_16x16x32_bf16 v[80:83], v[192:195], v[16:19], v[80:83]
ds_read_b64_tr_b16 v[202:203], v244 offset:6272
v_add_f32 v234, v234, v225
v_mfma_f32_16x16x32_bf16 v[80:83], v[196:199], v[32:35], v[80:83]
v_exp_f32 v227, v107
v_mfma_f32_16x16x32_bf16 v[84:87], v[196:199], v[36:39], v[52:55]
ds_read_b64_tr_b16 v[204:205], v244 offset:12416
v_cvt_pk_bf16_f32 v154, v224, v225
v_mfma_f32_16x16x32_bf16 v[84:87], v[192:195], v[20:23], v[84:87]
v_exp_f32 v228, v108
v_mfma_f32_16x16x32_bf16 v[84:87], v[188:191], a[244:247], v[84:87]
ds_read_b64_tr_b16 v[206:207], v244 offset:18560
v_add_f32 v234, v234, v226
v_mfma_f32_16x16x32_bf16 v[84:87], v[184:187], a[228:231], v[84:87]
v_exp_f32 v229, v109
v_mfma_f32_16x16x32_bf16 v[84:87], v[180:183], a[212:215], v[84:87]
ds_read_b64_tr_b16 v[208:209], v245 offset:128
v_add_f32 v234, v234, v227
v_mfma_f32_16x16x32_bf16 v[84:87], v[176:179], a[196:199], v[84:87]
v_exp_f32 v230, v110
v_mfma_f32_16x16x32_bf16 v[88:91], v[176:179], a[200:203], v[56:59]
ds_read_b64_tr_b16 v[210:211], v245 offset:6272
v_cvt_pk_bf16_f32 v155, v226, v227
v_mfma_f32_16x16x32_bf16 v[88:91], v[180:183], a[216:219], v[88:91]
v_exp_f32 v231, v111
v_mfma_f32_16x16x32_bf16 v[88:91], v[184:187], a[232:235], v[88:91]
ds_read_b64_tr_b16 v[212:213], v245 offset:12416
v_add_f32 v235, v235, v228
v_mfma_f32_16x16x32_bf16 v[88:91], v[188:191], a[248:251], v[88:91]
ds_read_b64_tr_b16 v[214:215], v245 offset:18560
v_add_f32 v235, v235, v229
v_mfma_f32_16x16x32_bf16 v[88:91], v[192:195], v[24:27], v[88:91]
ds_read_b64_tr_b16 v[216:217], v242 offset:256
v_cvt_pk_bf16_f32 v158, v228, v229
v_mfma_f32_16x16x32_bf16 v[88:91], v[196:199], v[40:43], v[88:91]
ds_read_b64_tr_b16 v[218:219], v242 offset:6400
v_add_f32 v235, v235, v230
v_mfma_f32_16x16x32_bf16 v[92:95], v[196:199], v[44:47], v[60:63]
ds_read_b64_tr_b16 v[220:221], v242 offset:12544
v_add_f32 v235, v235, v231
v_mfma_f32_16x16x32_bf16 v[92:95], v[192:195], v[28:31], v[92:95]
ds_read_b64_tr_b16 v[222:223], v242 offset:18688
v_cvt_pk_bf16_f32 v159, v230, v231
v_mfma_f32_16x16x32_bf16 v[92:95], v[188:191], a[252:255], v[92:95]
v_max3_f32 v224, v232, v233, v234
v_max_f32 v224, v224, v235
v_mfma_f32_16x16x32_bf16 v[92:95], v[184:187], a[236:239], v[92:95]
v_cmp_lt_f32 vcc, s60, v224
v_mfma_f32_16x16x32_bf16 v[92:95], v[180:183], a[220:223], v[92:95]
buffer_load_dwordx4 v248, s[12:15], s39 offen offset:2048 lds
v_mfma_f32_16x16x32_bf16 v[92:95], v[176:179], a[204:207], v[92:95]
s_waitcnt lgkmcnt(6)
s_cbranch_vccnz F_TR2
F_BK2:
v_mfma_f32_16x16x32_bf16 a[96:99], v[200:203], v[112:115], 0
ds_read_b128 v[176:179], v240 offset:43008
v_add_f32 v236, v236, v232
v_mfma_f32_16x16x32_bf16 a[96:99], v[204:207], v[128:131], a[96:99]
v_exp_f32 v224, v80
v_mfma_f32_16x16x32_bf16 a[100:103], v[200:203], v[116:119], 0
ds_read_b128 v[180:183], v241 offset:43008
v_add_f32 v237, v237, v233
v_mfma_f32_16x16x32_bf16 a[100:103], v[204:207], v[132:135], a[100:103]
s_add_u32 s39, s39, 12288
v_exp_f32 v225, v81
v_mfma_f32_16x16x32_bf16 a[104:107], v[200:203], v[120:123], 0
ds_read_b128 v[184:187], v240 offset:43136
v_add_f32 v238, v238, v234
v_mfma_f32_16x16x32_bf16 a[104:107], v[204:207], v[136:139], a[104:107]
v_exp_f32 v226, v82
v_mfma_f32_16x16x32_bf16 a[108:111], v[200:203], v[124:127], 0
ds_read_b128 v[188:191], v241 offset:43136
v_add_f32 v239, v239, v235
v_mfma_f32_16x16x32_bf16 a[108:111], v[204:207], v[140:143], a[108:111]
s_waitcnt lgkmcnt(4)
v_exp_f32 v227, v83
v_mfma_f32_16x16x32_bf16 a[124:127], v[208:211], v[124:127], 0
ds_read_b128 v[192:195], v240 offset:43264
v_add_f32 v232, v224, v225
v_mfma_f32_16x16x32_bf16 a[124:127], v[212:215], v[140:143], a[124:127]
v_exp_f32 v228, v84
v_mfma_f32_16x16x32_bf16 a[120:123], v[208:211], v[120:123], 0
ds_read_b128 v[196:199], v241 offset:43264
v_cvt_pk_bf16_f32 v160, v224, v225
v_mfma_f32_16x16x32_bf16 a[120:123], v[212:215], v[136:139], a[120:123]
v_exp_f32 v229, v85
v_mfma_f32_16x16x32_bf16 a[116:119], v[208:211], v[116:119], 0
v_exp_f32 v230, v86
v_mfma_f32_16x16x32_bf16 a[116:119], v[212:215], v[132:135], a[116:119]
s_mov_b32 m0, s42
v_exp_f32 v231, v87
v_mfma_f32_16x16x32_bf16 a[112:115], v[208:211], v[112:115], 0
buffer_load_dwordx4 v246, s[12:15], s39 offen offset:0 lds
v_mfma_f32_16x16x32_bf16 a[112:115], v[212:215], v[128:131], a[112:115]
v_add_f32 v232, v232, v226
v_add_f32 v232, v232, v227
v_mfma_f32_16x16x32_bf16 a[128:131], v[216:219], v[112:115], 0
v_cvt_pk_bf16_f32 v161, v226, v227
v_add_f32 v233, v228, v229
v_mfma_f32_16x16x32_bf16 a[128:131], v[220:223], v[128:131], a[128:131]
buffer_load_dwordx4 v247, s[12:15], s39 offen offset:1024 lds
v_mfma_f32_16x16x32_bf16 a[132:135], v[216:219], v[116:119], 0
v_cvt_pk_bf16_f32 v164, v228, v229
v_add_f32 v233, v233, v230
v_mfma_f32_16x16x32_bf16 a[132:135], v[220:223], v[132:135], a[132:135]
v_add_f32 v233, v233, v231
v_cvt_pk_bf16_f32 v165, v230, v231
v_mfma_f32_16x16x32_bf16 a[136:139], v[216:219], v[120:123], 0
v_mfma_f32_16x16x32_bf16 a[136:139], v[220:223], v[136:139], a[136:139]
v_mfma_f32_16x16x32_bf16 a[140:143], v[216:219], v[124:127], 0
v_mfma_f32_16x16x32_bf16 a[140:143], v[220:223], v[140:143], a[140:143]
s_waitcnt lgkmcnt(0)
v_mfma_f32_16x16x32_bf16 v[96:99], v[176:179], a[192:195], v[48:51]
v_exp_f32 v224, v88
v_mfma_f32_16x16x32_bf16 v[96:99], v[180:183], a[208:211], v[96:99]
ds_read_b64_tr_b16 v[200:201], v243 offset:256
v_mfma_f32_16x16x32_bf16 v[96:99], v[184:187], a[224:227], v[96:99]
v_exp_f32 v225, v89
v_mfma_f32_16x16x32_bf16 v[96:99], v[188:191], a[240:243], v[96:99]
ds_read_b64_tr_b16 v[202:203], v243 offset:6400
v_add_f32 v234, v224, v225
v_mfma_f32_16x16x32_bf16 v[96:99], v[192:195], v[16:19], v[96:99]
v_exp_f32 v226, v90
v_mfma_f32_16x16x32_bf16 v[96:99], v[196:199], v[32:35], v[96:99]
ds_read_b64_tr_b16 v[204:205], v243 offset:12544
v_cvt_pk_bf16_f32 v168, v224, v225
v_mfma_f32_16x16x32_bf16 v[100:103], v[196:199], v[36:39], v[52:55]
v_exp_f32 v227, v91
v_mfma_f32_16x16x32_bf16 v[100:103], v[192:195], v[20:23], v[100:103]
ds_read_b64_tr_b16 v[206:207], v243 offset:18688
v_add_f32 v234, v234, v226
v_mfma_f32_16x16x32_bf16 v[100:103], v[188:191], a[244:247], v[100:103]
v_exp_f32 v228, v92
v_mfma_f32_16x16x32_bf16 v[100:103], v[184:187], a[228:231], v[100:103]
ds_read_b64_tr_b16 v[208:209], v244 offset:256
v_add_f32 v234, v234, v227
v_mfma_f32_16x16x32_bf16 v[100:103], v[180:183], a[212:215], v[100:103]
v_exp_f32 v229, v93
v_mfma_f32_16x16x32_bf16 v[100:103], v[176:179], a[196:199], v[100:103]
ds_read_b64_tr_b16 v[210:211], v244 offset:6400
v_cvt_pk_bf16_f32 v169, v226, v227
v_mfma_f32_16x16x32_bf16 v[104:107], v[176:179], a[200:203], v[56:59]
v_exp_f32 v230, v94
v_mfma_f32_16x16x32_bf16 v[104:107], v[180:183], a[216:219], v[104:107]
ds_read_b64_tr_b16 v[212:213], v244 offset:12544
v_add_f32 v235, v228, v229
v_mfma_f32_16x16x32_bf16 v[104:107], v[184:187], a[232:235], v[104:107]
v_exp_f32 v231, v95
v_mfma_f32_16x16x32_bf16 v[104:107], v[188:191], a[248:251], v[104:107]
ds_read_b64_tr_b16 v[214:215], v244 offset:18688
v_cvt_pk_bf16_f32 v172, v228, v229
v_mfma_f32_16x16x32_bf16 v[104:107], v[192:195], v[24:27], v[104:107]
ds_read_b64_tr_b16 v[216:217], v245 offset:256
v_add_f32 v235, v235, v230
v_mfma_f32_16x16x32_bf16 v[104:107], v[196:199], v[40:43], v[104:107]
ds_read_b64_tr_b16 v[218:219], v245 offset:6400
v_add_f32 v235, v235, v231
v_mfma_f32_16x16x32_bf16 v[108:111], v[196:199], v[44:47], v[60:63]
ds_read_b64_tr_b16 v[220:221], v245 offset:12544
v_cvt_pk_bf16_f32 v173, v230, v231
v_mfma_f32_16x16x32_bf16 v[108:111], v[192:195], v[28:31], v[108:111]
ds_read_b64_tr_b16 v[222:223], v245 offset:18688
v_mfma_f32_16x16x32_bf16 v[108:111], v[188:191], a[252:255], v[108:111]
buffer_load_dwordx4 v248, s[12:15], s39 offen offset:2048 lds
v_mfma_f32_16x16x32_bf16 v[108:111], v[184:187], a[236:239], v[108:111]
s_add_u32 s39, s39, 12288
v_mfma_f32_16x16x32_bf16 v[108:111], v[180:183], a[220:223], v[108:111]
v_mfma_f32_16x16x32_bf16 v[108:111], v[176:179], a[204:207], v[108:111]
s_waitcnt vmcnt(6) lgkmcnt(0)
s_barrier
v_mfma_f32_16x16x32_bf16 a[156:159], v[200:203], v[124:127], 0
s_mov_b32 m0, s44
v_exp_f32 v224, v96
v_mfma_f32_16x16x32_bf16 a[156:159], v[204:207], v[140:143], a[156:159]
buffer_load_dwordx4 v249, s[16:19], s63 offen offset:0 lds
v_mfma_f32_16x16x32_bf16 a[152:155], v[200:203], v[120:123], 0
v_exp_f32 v225, v97
v_mfma_f32_16x16x32_bf16 a[152:155], v[204:207], v[136:139], a[152:155]
buffer_load_dwordx4 v250, s[16:19], s63 offen offset:1024 lds
v_mfma_f32_16x16x32_bf16 a[148:151], v[200:203], v[116:119], 0
ds_read_b128 v[176:179], v240 offset:0
v_add_f32 v232, v232, v224
v_mfma_f32_16x16x32_bf16 a[148:151], v[204:207], v[132:135], a[148:151]
v_exp_f32 v226, v98
v_mfma_f32_16x16x32_bf16 a[144:147], v[200:203], v[112:115], 0
ds_read_b128 v[180:183], v241 offset:0
v_add_f32 v232, v232, v225
v_mfma_f32_16x16x32_bf16 a[144:147], v[204:207], v[128:131], a[144:147]
v_exp_f32 v227, v99
v_mfma_f32_16x16x32_bf16 a[160:163], v[208:211], v[112:115], 0
ds_read_b128 v[184:187], v240 offset:128
v_cvt_pk_bf16_f32 v162, v224, v225
v_mfma_f32_16x16x32_bf16 a[160:163], v[212:215], v[128:131], a[160:163]
v_exp_f32 v228, v100
v_mfma_f32_16x16x32_bf16 a[164:167], v[208:211], v[116:119], 0
ds_read_b128 v[188:191], v241 offset:128
v_add_f32 v232, v232, v226
v_mfma_f32_16x16x32_bf16 a[164:167], v[212:215], v[132:135], a[164:167]
v_exp_f32 v229, v101
v_mfma_f32_16x16x32_bf16 a[168:171], v[208:211], v[120:123], 0
ds_read_b128 v[192:195], v240 offset:256
v_add_f32 v232, v232, v227
v_mfma_f32_16x16x32_bf16 a[168:171], v[212:215], v[136:139], a[168:171]
v_exp_f32 v230, v102
v_mfma_f32_16x16x32_bf16 a[172:175], v[208:211], v[124:127], 0
ds_read_b128 v[196:199], v241 offset:256
v_cvt_pk_bf16_f32 v163, v226, v227
v_mfma_f32_16x16x32_bf16 a[172:175], v[212:215], v[140:143], a[172:175]
v_exp_f32 v231, v103
v_mfma_f32_16x16x32_bf16 a[188:191], v[216:219], v[124:127], 0
v_add_f32 v233, v233, v228
v_add_f32 v233, v233, v229
v_mfma_f32_16x16x32_bf16 a[188:191], v[220:223], v[140:143], a[188:191]
v_cvt_pk_bf16_f32 v166, v228, v229
v_add_f32 v233, v233, v230
v_mfma_f32_16x16x32_bf16 a[184:187], v[216:219], v[120:123], 0
v_add_f32 v233, v233, v231
v_cvt_pk_bf16_f32 v167, v230, v231
v_mfma_f32_16x16x32_bf16 a[184:187], v[220:223], v[136:139], a[184:187]
v_mfma_f32_16x16x32_bf16 a[180:183], v[216:219], v[116:119], 0
v_mfma_f32_16x16x32_bf16 a[180:183], v[220:223], v[132:135], a[180:183]
v_mfma_f32_16x16x32_bf16 a[176:179], v[216:219], v[112:115], 0
s_waitcnt lgkmcnt(0)
v_mfma_f32_16x16x32_bf16 a[176:179], v[220:223], v[128:131], a[176:179]
.p2align 6
F_AL:
v_mfma_f32_16x16x32_bf16 v[64:67], v[176:179], a[192:195], v[48:51]
v_exp_f32 v224, v104
v_mfma_f32_16x16x32_bf16 v[64:67], v[180:183], a[208:211], v[64:67]
v_exp_f32 v225, v105
v_mfma_f32_16x16x32_bf16 v[64:67], v[184:187], a[224:227], v[64:67]
ds_read_b64_tr_b16 v[200:201], v242 offset:24576
v_add_f32 v234, v234, v224
v_mfma_f32_16x16x32_bf16 v[64:67], v[188:191], a[240:243], v[64:67]
v_exp_f32 v226, v106
v_mfma_f32_16x16x32_bf16 v[64:67], v[192:195], v[16:19], v[64:67]
ds_read_b64_tr_b16 v[202:203], v242 offset:30720
v_add_f32 v234, v234, v225
v_mfma_f32_16x16x32_bf16 v[64:67], v[196:199], v[32:35], v[64:67]
v_exp_f32 v227, v107
v_mfma_f32_16x16x32_bf16 v[68:71], v[196:199], v[36:39], v[52:55]
ds_read_b64_tr_b16 v[204:205], v242 offset:36864
v_cvt_pk_bf16_f32 v170, v224, v225
v_mfma_f32_16x16x32_bf16 v[68:71], v[192:195], v[20:23], v[68:71]
v_exp_f32 v228, v108
v_mfma_f32_16x16x32_bf16 v[68:71], v[188:191], a[244:247], v[68:71]
ds_read_b64_tr_b16 v[206:207], v242 offset:43008
v_add_f32 v234, v234, v226
v_mfma_f32_16x16x32_bf16 v[68:71], v[184:187], a[228:231], v[68:71]
v_exp_f32 v229, v109
v_mfma_f32_16x16x32_bf16 v[68:71], v[180:183], a[212:215], v[68:71]
ds_read_b64_tr_b16 v[208:209], v243 offset:24576
v_add_f32 v234, v234, v227
v_mfma_f32_16x16x32_bf16 v[68:71], v[176:179], a[196:199], v[68:71]
v_exp_f32 v230, v110
v_mfma_f32_16x16x32_bf16 v[72:75], v[176:179], a[200:203], v[56:59]
ds_read_b64_tr_b16 v[210:211], v243 offset:30720
v_cvt_pk_bf16_f32 v171, v226, v227
v_mfma_f32_16x16x32_bf16 v[72:75], v[180:183], a[216:219], v[72:75]
v_exp_f32 v231, v111
v_mfma_f32_16x16x32_bf16 v[72:75], v[184:187], a[232:235], v[72:75]
ds_read_b64_tr_b16 v[212:213], v243 offset:36864
v_add_f32 v235, v235, v228
v_mfma_f32_16x16x32_bf16 v[72:75], v[188:191], a[248:251], v[72:75]
ds_read_b64_tr_b16 v[214:215], v243 offset:43008
v_add_f32 v235, v235, v229
v_mfma_f32_16x16x32_bf16 v[72:75], v[192:195], v[24:27], v[72:75]
ds_read_b64_tr_b16 v[216:217], v244 offset:24576
v_cvt_pk_bf16_f32 v174, v228, v229
v_mfma_f32_16x16x32_bf16 v[72:75], v[196:199], v[40:43], v[72:75]
ds_read_b64_tr_b16 v[218:219], v244 offset:30720
v_add_f32 v235, v235, v230
v_mfma_f32_16x16x32_bf16 v[76:79], v[196:199], v[44:47], v[60:63]
ds_read_b64_tr_b16 v[220:221], v244 offset:36864
v_add_f32 v235, v235, v231
v_mfma_f32_16x16x32_bf16 v[76:79], v[192:195], v[28:31], v[76:79]
ds_read_b64_tr_b16 v[222:223], v244 offset:43008
v_cvt_pk_bf16_f32 v175, v230, v231
v_mfma_f32_16x16x32_bf16 v[76:79], v[188:191], a[252:255], v[76:79]
v_max3_f32 v224, v232, v233, v234
v_max_f32 v224, v224, v235
v_mfma_f32_16x16x32_bf16 v[76:79], v[184:187], a[236:239], v[76:79]
v_cmp_lt_f32 vcc, s60, v224
v_mfma_f32_16x16x32_bf16 v[76:79], v[180:183], a[220:223], v[76:79]
buffer_load_dwordx4 v251, s[16:19], s63 offen offset:2048 lds
v_mfma_f32_16x16x32_bf16 v[76:79], v[176:179], a[204:207], v[76:79]
s_waitcnt lgkmcnt(6)
s_cbranch_vccnz F_TR3
F_BK3:
v_mfma_f32_16x16x32_bf16 a[0:3], v[200:203], v[144:147], a[0:3]
ds_read_b128 v[176:179], v240 offset:6144
v_add_f32 v236, v236, v232
v_mfma_f32_16x16x32_bf16 a[0:3], v[204:207], v[160:163], a[0:3]
v_exp_f32 v224, v64
v_mfma_f32_16x16x32_bf16 a[4:7], v[200:203], v[148:151], a[4:7]
ds_read_b128 v[180:183], v241 offset:6144
v_add_f32 v237, v237, v233
v_mfma_f32_16x16x32_bf16 a[4:7], v[204:207], v[164:167], a[4:7]
s_add_u32 s63, s63, 12288
v_exp_f32 v225, v65
v_mfma_f32_16x16x32_bf16 a[8:11], v[200:203], v[152:155], a[8:11]
ds_read_b128 v[184:187], v240 offset:6272
v_add_f32 v238, v238, v234
v_mfma_f32_16x16x32_bf16 a[8:11], v[204:207], v[168:171], a[8:11]
v_exp_f32 v226, v66
v_mfma_f32_16x16x32_bf16 a[12:15], v[200:203], v[156:159], a[12:15]
ds_read_b128 v[188:191], v241 offset:6272
v_add_f32 v239, v239, v235
v_mfma_f32_16x16x32_bf16 a[12:15], v[204:207], v[172:175], a[12:15]
s_waitcnt lgkmcnt(4)
v_exp_f32 v227, v67
v_mfma_f32_16x16x32_bf16 a[28:31], v[208:211], v[156:159], a[28:31]
ds_read_b128 v[192:195], v240 offset:6400
v_add_f32 v232, v224, v225
v_mfma_f32_16x16x32_bf16 a[28:31], v[212:215], v[172:175], a[28:31]
v_exp_f32 v228, v68
v_mfma_f32_16x16x32_bf16 a[24:27], v[208:211], v[152:155], a[24:27]
ds_read_b128 v[196:199], v241 offset:6400
v_cvt_pk_bf16_f32 v112, v224, v225
v_mfma_f32_16x16x32_bf16 a[24:27], v[212:215], v[168:171], a[24:27]
v_exp_f32 v229, v69
v_mfma_f32_16x16x32_bf16 a[20:23], v[208:211], v[148:151], a[20:23]
v_exp_f32 v230, v70
v_mfma_f32_16x16x32_bf16 a[20:23], v[212:215], v[164:167], a[20:23]
s_mov_b32 m0, s45
v_exp_f32 v231, v71
v_mfma_f32_16x16x32_bf16 a[16:19], v[208:211], v[144:147], a[16:19]
buffer_load_dwordx4 v249, s[16:19], s63 offen offset:0 lds
v_mfma_f32_16x16x32_bf16 a[16:19], v[212:215], v[160:163], a[16:19]
v_add_f32 v232, v232, v226
v_add_f32 v232, v232, v227
v_mfma_f32_16x16x32_bf16 a[32:35], v[216:219], v[144:147], a[32:35]
v_cvt_pk_bf16_f32 v113, v226, v227
v_add_f32 v233, v228, v229
v_mfma_f32_16x16x32_bf16 a[32:35], v[220:223], v[160:163], a[32:35]
buffer_load_dwordx4 v250, s[16:19], s63 offen offset:1024 lds
v_mfma_f32_16x16x32_bf16 a[36:39], v[216:219], v[148:151], a[36:39]
v_cvt_pk_bf16_f32 v116, v228, v229
v_add_f32 v233, v233, v230
v_mfma_f32_16x16x32_bf16 a[36:39], v[220:223], v[164:167], a[36:39]
v_add_f32 v233, v233, v231
v_cvt_pk_bf16_f32 v117, v230, v231
v_mfma_f32_16x16x32_bf16 a[40:43], v[216:219], v[152:155], a[40:43]
ds_read_b64_tr_b16 v[12:13], v255
v_mfma_f32_16x16x32_bf16 a[40:43], v[220:223], v[168:171], a[40:43]
v_xor_b32 v14, s48, v255
v_add_u32 v14, s49, v14
v_mfma_f32_16x16x32_bf16 a[44:47], v[216:219], v[156:159], a[44:47]
ds_read_b64_tr_b16 v[14:15], v14
v_mfma_f32_16x16x32_bf16 a[44:47], v[220:223], v[172:175], a[44:47]
s_waitcnt lgkmcnt(2)
v_mfma_f32_16x16x32_bf16 v[96:99], v[176:179], a[192:195], v[48:51]
v_exp_f32 v224, v72
v_mfma_f32_16x16x32_bf16 v[96:99], v[180:183], a[208:211], v[96:99]
ds_read_b64_tr_b16 v[200:201], v245 offset:24576
v_mfma_f32_16x16x32_bf16 v[96:99], v[184:187], a[224:227], v[96:99]
v_exp_f32 v225, v73
v_mfma_f32_16x16x32_bf16 v[96:99], v[188:191], a[240:243], v[96:99]
ds_read_b64_tr_b16 v[202:203], v245 offset:30720
v_add_f32 v234, v224, v225
v_mfma_f32_16x16x32_bf16 v[96:99], v[192:195], v[16:19], v[96:99]
v_exp_f32 v226, v74
v_mfma_f32_16x16x32_bf16 v[96:99], v[196:199], v[32:35], v[96:99]
ds_read_b64_tr_b16 v[204:205], v245 offset:36864
v_cvt_pk_bf16_f32 v120, v224, v225
v_mfma_f32_16x16x32_bf16 v[100:103], v[196:199], v[36:39], v[52:55]
v_exp_f32 v227, v75
v_mfma_f32_16x16x32_bf16 v[100:103], v[192:195], v[20:23], v[100:103]
ds_read_b64_tr_b16 v[206:207], v245 offset:43008
v_add_f32 v234, v234, v226
v_mfma_f32_16x16x32_bf16 v[100:103], v[188:191], a[244:247], v[100:103]
v_exp_f32 v228, v76
v_mfma_f32_16x16x32_bf16 v[100:103], v[184:187], a[228:231], v[100:103]
ds_read_b64_tr_b16 v[208:209], v242 offset:24704
v_add_f32 v234, v234, v227
v_mfma_f32_16x16x32_bf16 v[100:103], v[180:183], a[212:215], v[100:103]
v_exp_f32 v229, v77
v_mfma_f32_16x16x32_bf16 v[100:103], v[176:179], a[196:199], v[100:103]
ds_read_b64_tr_b16 v[210:211], v242 offset:30848
v_cvt_pk_bf16_f32 v121, v226, v227
v_mfma_f32_16x16x32_bf16 v[104:107], v[176:179], a[200:203], v[56:59]
v_exp_f32 v230, v78
v_mfma_f32_16x16x32_bf16 v[104:107], v[180:183], a[216:219], v[104:107]
ds_read_b64_tr_b16 v[212:213], v242 offset:36992
v_add_f32 v235, v228, v229
v_mfma_f32_16x16x32_bf16 v[104:107], v[184:187], a[232:235], v[104:107]
v_exp_f32 v231, v79
v_mfma_f32_16x16x32_bf16 v[104:107], v[188:191], a[248:251], v[104:107]
ds_read_b64_tr_b16 v[214:215], v242 offset:43136
v_cvt_pk_bf16_f32 v124, v228, v229
v_mfma_f32_16x16x32_bf16 v[104:107], v[192:195], v[24:27], v[104:107]
ds_read_b64_tr_b16 v[216:217], v243 offset:24704
v_add_f32 v235, v235, v230
v_mfma_f32_16x16x32_bf16 v[104:107], v[196:199], v[40:43], v[104:107]
ds_read_b64_tr_b16 v[218:219], v243 offset:30848
v_add_f32 v235, v235, v231
v_mfma_f32_16x16x32_bf16 v[108:111], v[196:199], v[44:47], v[60:63]
ds_read_b64_tr_b16 v[220:221], v243 offset:36992
v_cvt_pk_bf16_f32 v125, v230, v231
v_mfma_f32_16x16x32_bf16 v[108:111], v[192:195], v[28:31], v[108:111]
ds_read_b64_tr_b16 v[222:223], v243 offset:43136
v_mfma_f32_16x16x32_bf16 v[108:111], v[188:191], a[252:255], v[108:111]
buffer_load_dwordx4 v251, s[16:19], s63 offen offset:2048 lds
v_mfma_f32_16x16x32_bf16 v[108:111], v[184:187], a[236:239], v[108:111]
s_add_u32 s63, s63, 12288
v_mfma_f32_16x16x32_bf16 v[108:111], v[180:183], a[220:223], v[108:111]
v_mfma_f32_16x16x32_bf16 v[108:111], v[176:179], a[204:207], v[108:111]
s_waitcnt vmcnt(9) lgkmcnt(0)
s_barrier
v_mfma_f32_16x16x32_bf16 a[60:63], v[200:203], v[156:159], a[60:63]
s_mov_b32 m0, s43
v_exp_f32 v224, v96
v_mfma_f32_16x16x32_bf16 a[60:63], v[204:207], v[172:175], a[60:63]
buffer_load_dwordx4 v246, s[12:15], s39 offen offset:0 lds
v_mfma_f32_16x16x32_bf16 a[56:59], v[200:203], v[152:155], a[56:59]
v_exp_f32 v225, v97
v_mfma_f32_16x16x32_bf16 a[56:59], v[204:207], v[168:171], a[56:59]
buffer_load_dwordx4 v247, s[12:15], s39 offen offset:1024 lds
v_mfma_f32_16x16x32_bf16 a[52:55], v[200:203], v[148:151], a[52:55]
ds_read_b128 v[176:179], v240 offset:12288
v_add_f32 v232, v232, v224
v_mfma_f32_16x16x32_bf16 a[52:55], v[204:207], v[164:167], a[52:55]
s_cmp_lt_u32 s57, 10
v_exp_f32 v226, v98
v_mfma_f32_16x16x32_bf16 a[48:51], v[200:203], v[144:147], a[48:51]
ds_read_b128 v[180:183], v241 offset:12288
v_add_f32 v232, v232, v225
v_mfma_f32_16x16x32_bf16 a[48:51], v[204:207], v[160:163], a[48:51]
s_cselect_b32 s59, 1024, 0
v_exp_f32 v227, v99
v_mfma_f32_16x16x32_bf16 a[64:67], v[208:211], v[144:147], a[64:67]
ds_read_b128 v[184:187], v240 offset:12416
v_cvt_pk_bf16_f32 v114, v224, v225
v_mfma_f32_16x16x32_bf16 a[64:67], v[212:215], v[160:163], a[64:67]
s_sub_u32 s66, s57, 1
v_exp_f32 v228, v100
v_mfma_f32_16x16x32_bf16 a[68:71], v[208:211], v[148:151], a[68:71]
ds_read_b128 v[188:191], v241 offset:12416
v_add_f32 v232, v232, v226
v_mfma_f32_16x16x32_bf16 a[68:71], v[212:215], v[164:167], a[68:71]
s_cmp_lt_u32 s66, 10
v_exp_f32 v229, v101
v_mfma_f32_16x16x32_bf16 a[72:75], v[208:211], v[152:155], a[72:75]
ds_read_b128 v[192:195], v240 offset:12544
v_add_f32 v232, v232, v227
v_mfma_f32_16x16x32_bf16 a[72:75], v[212:215], v[168:171], a[72:75]
s_cselect_b32 s66, s26, s3
v_exp_f32 v230, v102
v_mfma_f32_16x16x32_bf16 a[76:79], v[208:211], v[156:159], a[76:79]
ds_read_b128 v[196:199], v241 offset:12544
v_cvt_pk_bf16_f32 v115, v226, v227
v_mfma_f32_16x16x32_bf16 a[76:79], v[212:215], v[172:175], a[76:79]
s_cselect_b32 s62, 4096, 0
v_exp_f32 v231, v103
v_mfma_f32_16x16x32_bf16 a[92:95], v[216:219], v[156:159], a[92:95]
s_add_u32 s26, s26, s62
v_add_f32 v233, v233, v228
v_add_f32 v233, v233, v229
v_mfma_f32_16x16x32_bf16 a[92:95], v[220:223], v[172:175], a[92:95]
s_lshr_b32 s62, s62, 10
v_cvt_pk_bf16_f32 v118, v228, v229
v_add_f32 v233, v233, v230
v_mfma_f32_16x16x32_bf16 a[88:91], v[216:219], v[152:155], a[88:91]
s_add_u32 s27, s27, s62
v_add_f32 v233, v233, v231
v_cvt_pk_bf16_f32 v119, v230, v231
v_mfma_f32_16x16x32_bf16 a[88:91], v[220:223], v[168:171], a[88:91]
buffer_store_dwordx4 v[12:15], v253, s[20:23], s66 offen sc1
v_mfma_f32_16x16x32_bf16 a[84:87], v[216:219], v[148:151], a[84:87]
s_cmp_gt_u32 s27, 9
v_add_u32 v255, s59, v255
v_mfma_f32_16x16x32_bf16 a[84:87], v[220:223], v[164:167], a[84:87]
s_cselect_b32 s62, 2447360, 0
s_cselect_b32 s66, 10, 0
v_mfma_f32_16x16x32_bf16 a[80:83], v[216:219], v[144:147], a[80:83]
s_waitcnt lgkmcnt(0)
s_add_u32 s26, s26, s62
v_mfma_f32_16x16x32_bf16 a[80:83], v[220:223], v[160:163], a[80:83]
s_sub_u32 s27, s27, s66
v_mfma_f32_16x16x32_bf16 v[80:83], v[176:179], a[192:195], v[48:51]
v_exp_f32 v224, v104
v_mfma_f32_16x16x32_bf16 v[80:83], v[180:183], a[208:211], v[80:83]
v_exp_f32 v225, v105
v_mfma_f32_16x16x32_bf16 v[80:83], v[184:187], a[224:227], v[80:83]
ds_read_b64_tr_b16 v[200:201], v244 offset:24704
v_add_f32 v234, v234, v224
v_mfma_f32_16x16x32_bf16 v[80:83], v[188:191], a[240:243], v[80:83]
v_exp_f32 v226, v106
v_mfma_f32_16x16x32_bf16 v[80:83], v[192:195], v[16:19], v[80:83]
ds_read_b64_tr_b16 v[202:203], v244 offset:30848
v_add_f32 v234, v234, v225
v_mfma_f32_16x16x32_bf16 v[80:83], v[196:199], v[32:35], v[80:83]
v_exp_f32 v227, v107
v_mfma_f32_16x16x32_bf16 v[84:87], v[196:199], v[36:39], v[52:55]
ds_read_b64_tr_b16 v[204:205], v244 offset:36992
v_cvt_pk_bf16_f32 v122, v224, v225
v_mfma_f32_16x16x32_bf16 v[84:87], v[192:195], v[20:23], v[84:87]
v_exp_f32 v228, v108
v_mfma_f32_16x16x32_bf16 v[84:87], v[188:191], a[244:247], v[84:87]
ds_read_b64_tr_b16 v[206:207], v244 offset:43136
v_add_f32 v234, v234, v226
v_mfma_f32_16x16x32_bf16 v[84:87], v[184:187], a[228:231], v[84:87]
v_exp_f32 v229, v109
v_mfma_f32_16x16x32_bf16 v[84:87], v[180:183], a[212:215], v[84:87]
ds_read_b64_tr_b16 v[208:209], v245 offset:24704
v_add_f32 v234, v234, v227
v_mfma_f32_16x16x32_bf16 v[84:87], v[176:179], a[196:199], v[84:87]
v_exp_f32 v230, v110
v_mfma_f32_16x16x32_bf16 v[88:91], v[176:179], a[200:203], v[56:59]
ds_read_b64_tr_b16 v[210:211], v245 offset:30848
v_cvt_pk_bf16_f32 v123, v226, v227
v_mfma_f32_16x16x32_bf16 v[88:91], v[180:183], a[216:219], v[88:91]
v_exp_f32 v231, v111
v_mfma_f32_16x16x32_bf16 v[88:91], v[184:187], a[232:235], v[88:91]
ds_read_b64_tr_b16 v[212:213], v245 offset:36992
v_add_f32 v235, v235, v228
v_mfma_f32_16x16x32_bf16 v[88:91], v[188:191], a[248:251], v[88:91]
ds_read_b64_tr_b16 v[214:215], v245 offset:43136
v_add_f32 v235, v235, v229
v_mfma_f32_16x16x32_bf16 v[88:91], v[192:195], v[24:27], v[88:91]
ds_read_b64_tr_b16 v[216:217], v242 offset:24832
v_cvt_pk_bf16_f32 v126, v228, v229
v_mfma_f32_16x16x32_bf16 v[88:91], v[196:199], v[40:43], v[88:91]
ds_read_b64_tr_b16 v[218:219], v242 offset:30976
v_add_f32 v235, v235, v230
v_mfma_f32_16x16x32_bf16 v[92:95], v[196:199], v[44:47], v[60:63]
ds_read_b64_tr_b16 v[220:221], v242 offset:37120
v_add_f32 v235, v235, v231
v_mfma_f32_16x16x32_bf16 v[92:95], v[192:195], v[28:31], v[92:95]
ds_read_b64_tr_b16 v[222:223], v242 offset:43264
v_cvt_pk_bf16_f32 v127, v230, v231
v_mfma_f32_16x16x32_bf16 v[92:95], v[188:191], a[252:255], v[92:95]
v_max3_f32 v224, v232, v233, v234
v_max_f32 v224, v224, v235
v_mfma_f32_16x16x32_bf16 v[92:95], v[184:187], a[236:239], v[92:95]
v_cmp_lt_f32 vcc, s60, v224
v_mfma_f32_16x16x32_bf16 v[92:95], v[180:183], a[220:223], v[92:95]
buffer_load_dwordx4 v248, s[12:15], s39 offen offset:2048 lds
v_mfma_f32_16x16x32_bf16 v[92:95], v[176:179], a[204:207], v[92:95]
s_waitcnt lgkmcnt(6)
s_cbranch_vccnz F_TR4
F_BK4:
v_mfma_f32_16x16x32_bf16 a[96:99], v[200:203], v[144:147], a[96:99]
ds_read_b128 v[176:179], v240 offset:18432
v_add_f32 v236, v236, v232
v_mfma_f32_16x16x32_bf16 a[96:99], v[204:207], v[160:163], a[96:99]
v_exp_f32 v224, v80
v_mfma_f32_16x16x32_bf16 a[100:103], v[200:203], v[148:151], a[100:103]
ds_read_b128 v[180:183], v241 offset:18432
v_add_f32 v237, v237, v233
v_mfma_f32_16x16x32_bf16 a[100:103], v[204:207], v[164:167], a[100:103]
s_add_u32 s39, s39, 12288
v_exp_f32 v225, v81
v_mfma_f32_16x16x32_bf16 a[104:107], v[200:203], v[152:155], a[104:107]
ds_read_b128 v[184:187], v240 offset:18560
v_add_f32 v238, v238, v234
v_mfma_f32_16x16x32_bf16 a[104:107], v[204:207], v[168:171], a[104:107]
v_exp_f32 v226, v82
v_mfma_f32_16x16x32_bf16 a[108:111], v[200:203], v[156:159], a[108:111]
ds_read_b128 v[188:191], v241 offset:18560
v_add_f32 v239, v239, v235
v_mfma_f32_16x16x32_bf16 a[108:111], v[204:207], v[172:175], a[108:111]
s_waitcnt lgkmcnt(4)
v_exp_f32 v227, v83
v_mfma_f32_16x16x32_bf16 a[124:127], v[208:211], v[156:159], a[124:127]
ds_read_b128 v[192:195], v240 offset:18688
v_add_f32 v232, v224, v225
v_mfma_f32_16x16x32_bf16 a[124:127], v[212:215], v[172:175], a[124:127]
v_exp_f32 v228, v84
v_mfma_f32_16x16x32_bf16 a[120:123], v[208:211], v[152:155], a[120:123]
ds_read_b128 v[196:199], v241 offset:18688
v_cvt_pk_bf16_f32 v128, v224, v225
v_mfma_f32_16x16x32_bf16 a[120:123], v[212:215], v[168:171], a[120:123]
v_exp_f32 v229, v85
v_mfma_f32_16x16x32_bf16 a[116:119], v[208:211], v[148:151], a[116:119]
v_exp_f32 v230, v86
v_mfma_f32_16x16x32_bf16 a[116:119], v[212:215], v[164:167], a[116:119]
s_mov_b32 m0, s40
v_exp_f32 v231, v87
v_mfma_f32_16x16x32_bf16 a[112:115], v[208:211], v[144:147], a[112:115]
buffer_load_dwordx4 v246, s[12:15], s39 offen offset:0 lds
v_mfma_f32_16x16x32_bf16 a[112:115], v[212:215], v[160:163], a[112:115]
v_add_f32 v232, v232, v226
v_add_f32 v232, v232, v227
v_mfma_f32_16x16x32_bf16 a[128:131], v[216:219], v[144:147], a[128:131]
v_cvt_pk_bf16_f32 v129, v226, v227
v_add_f32 v233, v228, v229
v_mfma_f32_16x16x32_bf16 a[128:131], v[220:223], v[160:163], a[128:131]
buffer_load_dwordx4 v247, s[12:15], s39 offen offset:1024 lds
v_mfma_f32_16x16x32_bf16 a[132:135], v[216:219], v[148:151], a[132:135]
v_cvt_pk_bf16_f32 v132, v228, v229
v_add_f32 v233, v233, v230
v_mfma_f32_16x16x32_bf16 a[132:135], v[220:223], v[164:167], a[132:135]
v_add_f32 v233, v233, v231
v_cvt_pk_bf16_f32 v133, v230, v231
v_mfma_f32_16x16x32_bf16 a[136:139], v[216:219], v[152:155], a[136:139]
buffer_load_dword v1, v252, s[16:19], s58 offen
v_mfma_f32_16x16x32_bf16 a[136:139], v[220:223], v[168:171], a[136:139]
v_mfma_f32_16x16x32_bf16 a[140:143], v[216:219], v[156:159], a[140:143]
v_mfma_f32_16x16x32_bf16 a[140:143], v[220:223], v[172:175], a[140:143]
s_waitcnt lgkmcnt(0)
v_mfma_f32_16x16x32_bf16 v[96:99], v[176:179], a[192:195], v[48:51]
v_exp_f32 v224, v88
v_mfma_f32_16x16x32_bf16 v[96:99], v[180:183], a[208:211], v[96:99]
ds_read_b64_tr_b16 v[200:201], v243 offset:24832
v_mfma_f32_16x16x32_bf16 v[96:99], v[184:187], a[224:227], v[96:99]
v_exp_f32 v225, v89
v_mfma_f32_16x16x32_bf16 v[96:99], v[188:191], a[240:243], v[96:99]
ds_read_b64_tr_b16 v[202:203], v243 offset:30976
v_add_f32 v234, v224, v225
v_mfma_f32_16x16x32_bf16 v[96:99], v[192:195], v[16:19], v[96:99]
v_exp_f32 v226, v90
v_mfma_f32_16x16x32_bf16 v[96:99], v[196:199], v[32:35], v[96:99]
ds_read_b64_tr_b16 v[204:205], v243 offset:37120
v_cvt_pk_bf16_f32 v136, v224, v225
v_mfma_f32_16x16x32_bf16 v[100:103], v[196:199], v[36:39], v[52:55]
v_exp_f32 v227, v91
v_mfma_f32_16x16x32_bf16 v[100:103], v[192:195], v[20:23], v[100:103]
ds_read_b64_tr_b16 v[206:207], v243 offset:43264
v_add_f32 v234, v234, v226
v_mfma_f32_16x16x32_bf16 v[100:103], v[188:191], a[244:247], v[100:103]
v_exp_f32 v228, v92
v_mfma_f32_16x16x32_bf16 v[100:103], v[184:187], a[228:231], v[100:103]
ds_read_b64_tr_b16 v[208:209], v244 offset:24832
v_add_f32 v234, v234, v227
v_mfma_f32_16x16x32_bf16 v[100:103], v[180:183], a[212:215], v[100:103]
v_exp_f32 v229, v93
v_mfma_f32_16x16x32_bf16 v[100:103], v[176:179], a[196:199], v[100:103]
ds_read_b64_tr_b16 v[210:211], v244 offset:30976
v_cvt_pk_bf16_f32 v137, v226, v227
v_mfma_f32_16x16x32_bf16 v[104:107], v[176:179], a[200:203], v[56:59]
v_exp_f32 v230, v94
v_mfma_f32_16x16x32_bf16 v[104:107], v[180:183], a[216:219], v[104:107]
ds_read_b64_tr_b16 v[212:213], v244 offset:37120
v_add_f32 v235, v228, v229
v_mfma_f32_16x16x32_bf16 v[104:107], v[184:187], a[232:235], v[104:107]
v_exp_f32 v231, v95
v_mfma_f32_16x16x32_bf16 v[104:107], v[188:191], a[248:251], v[104:107]
ds_read_b64_tr_b16 v[214:215], v244 offset:43264
v_cvt_pk_bf16_f32 v140, v228, v229
v_mfma_f32_16x16x32_bf16 v[104:107], v[192:195], v[24:27], v[104:107]
ds_read_b64_tr_b16 v[216:217], v245 offset:24832
v_add_f32 v235, v235, v230
v_mfma_f32_16x16x32_bf16 v[104:107], v[196:199], v[40:43], v[104:107]
ds_read_b64_tr_b16 v[218:219], v245 offset:30976
v_add_f32 v235, v235, v231
v_mfma_f32_16x16x32_bf16 v[108:111], v[196:199], v[44:47], v[60:63]
ds_read_b64_tr_b16 v[220:221], v245 offset:37120
v_cvt_pk_bf16_f32 v141, v230, v231
v_mfma_f32_16x16x32_bf16 v[108:111], v[192:195], v[28:31], v[108:111]
ds_read_b64_tr_b16 v[222:223], v245 offset:43264
v_mfma_f32_16x16x32_bf16 v[108:111], v[188:191], a[252:255], v[108:111]
buffer_load_dwordx4 v248, s[12:15], s39 offen offset:2048 lds
v_mfma_f32_16x16x32_bf16 v[108:111], v[184:187], a[236:239], v[108:111]
s_add_u32 s39, s39, 12288
v_mfma_f32_16x16x32_bf16 v[108:111], v[180:183], a[220:223], v[108:111]
v_mfma_f32_16x16x32_bf16 v[108:111], v[176:179], a[204:207], v[108:111]
s_waitcnt vmcnt(8) lgkmcnt(0)
s_barrier
v_mfma_f32_16x16x32_bf16 a[156:159], v[200:203], v[156:159], a[156:159]
s_mov_b32 m0, s46
v_exp_f32 v224, v96
v_mfma_f32_16x16x32_bf16 a[156:159], v[204:207], v[172:175], a[156:159]
buffer_load_dwordx4 v249, s[16:19], s63 offen offset:0 lds
v_mfma_f32_16x16x32_bf16 a[152:155], v[200:203], v[152:155], a[152:155]
v_exp_f32 v225, v97
v_mfma_f32_16x16x32_bf16 a[152:155], v[204:207], v[168:171], a[152:155]
buffer_load_dwordx4 v250, s[16:19], s63 offen offset:1024 lds
v_mfma_f32_16x16x32_bf16 a[148:151], v[200:203], v[148:151], a[148:151]
ds_read_b128 v[176:179], v240 offset:24576
v_add_f32 v232, v232, v224
v_mfma_f32_16x16x32_bf16 a[148:151], v[204:207], v[164:167], a[148:151]
v_exp_f32 v226, v98
v_mfma_f32_16x16x32_bf16 a[144:147], v[200:203], v[144:147], a[144:147]
ds_read_b128 v[180:183], v241 offset:24576
v_add_f32 v232, v232, v225
v_mfma_f32_16x16x32_bf16 a[144:147], v[204:207], v[160:163], a[144:147]
v_exp_f32 v227, v99
v_mfma_f32_16x16x32_bf16 a[160:163], v[208:211], v[144:147], a[160:163]
ds_read_b128 v[184:187], v240 offset:24704
v_cvt_pk_bf16_f32 v130, v224, v225
v_mfma_f32_16x16x32_bf16 a[160:163], v[212:215], v[160:163], a[160:163]
v_exp_f32 v228, v100
v_mfma_f32_16x16x32_bf16 a[164:167], v[208:211], v[148:151], a[164:167]
ds_read_b128 v[188:191], v241 offset:24704
v_add_f32 v232, v232, v226
v_mfma_f32_16x16x32_bf16 a[164:167], v[212:215], v[164:167], a[164:167]
v_exp_f32 v229, v101
v_mfma_f32_16x16x32_bf16 a[168:171], v[208:211], v[152:155], a[168:171]
ds_read_b128 v[192:195], v240 offset:24832
v_add_f32 v232, v232, v227
v_mfma_f32_16x16x32_bf16 a[168:171], v[212:215], v[168:171], a[168:171]
v_exp_f32 v230, v102
v_mfma_f32_16x16x32_bf16 a[172:175], v[208:211], v[156:159], a[172:175]
ds_read_b128 v[196:199], v241 offset:24832
v_cvt_pk_bf16_f32 v131, v226, v227
v_mfma_f32_16x16x32_bf16 a[172:175], v[212:215], v[172:175], a[172:175]
v_exp_f32 v231, v103
v_mfma_f32_16x16x32_bf16 a[188:191], v[216:219], v[156:159], a[188:191]
v_add_f32 v233, v233, v228
v_add_f32 v233, v233, v229
v_mfma_f32_16x16x32_bf16 a[188:191], v[220:223], v[172:175], a[188:191]
v_cvt_pk_bf16_f32 v134, v228, v229
v_add_f32 v233, v233, v230
v_mfma_f32_16x16x32_bf16 a[184:187], v[216:219], v[152:155], a[184:187]
v_add_f32 v233, v233, v231
v_cvt_pk_bf16_f32 v135, v230, v231
v_mfma_f32_16x16x32_bf16 a[184:187], v[220:223], v[168:171], a[184:187]
v_mfma_f32_16x16x32_bf16 a[180:183], v[216:219], v[148:151], a[180:183]
v_mfma_f32_16x16x32_bf16 a[180:183], v[220:223], v[164:167], a[180:183]
v_mfma_f32_16x16x32_bf16 a[176:179], v[216:219], v[144:147], a[176:179]
s_waitcnt lgkmcnt(0)
v_mfma_f32_16x16x32_bf16 a[176:179], v[220:223], v[160:163], a[176:179]
v_mfma_f32_16x16x32_bf16 v[64:67], v[176:179], a[192:195], v[48:51]
v_exp_f32 v224, v104
v_mfma_f32_16x16x32_bf16 v[64:67], v[180:183], a[208:211], v[64:67]
v_exp_f32 v225, v105
v_mfma_f32_16x16x32_bf16 v[64:67], v[184:187], a[224:227], v[64:67]
ds_read_b64_tr_b16 v[200:201], v242 offset:0
v_add_f32 v234, v234, v224
v_mfma_f32_16x16x32_bf16 v[64:67], v[188:191], a[240:243], v[64:67]
v_exp_f32 v226, v106
v_mfma_f32_16x16x32_bf16 v[64:67], v[192:195], v[16:19], v[64:67]
ds_read_b64_tr_b16 v[202:203], v242 offset:6144
v_add_f32 v234, v234, v225
v_mfma_f32_16x16x32_bf16 v[64:67], v[196:199], v[32:35], v[64:67]
v_exp_f32 v227, v107
v_mfma_f32_16x16x32_bf16 v[68:71], v[196:199], v[36:39], v[52:55]
ds_read_b64_tr_b16 v[204:205], v242 offset:12288
v_cvt_pk_bf16_f32 v138, v224, v225
v_mfma_f32_16x16x32_bf16 v[68:71], v[192:195], v[20:23], v[68:71]
v_exp_f32 v228, v108
v_mfma_f32_16x16x32_bf16 v[68:71], v[188:191], a[244:247], v[68:71]
ds_read_b64_tr_b16 v[206:207], v242 offset:18432
v_add_f32 v234, v234, v226
v_mfma_f32_16x16x32_bf16 v[68:71], v[184:187], a[228:231], v[68:71]
v_exp_f32 v229, v109
v_mfma_f32_16x16x32_bf16 v[68:71], v[180:183], a[212:215], v[68:71]
ds_read_b64_tr_b16 v[208:209], v243 offset:0
v_add_f32 v234, v234, v227
v_mfma_f32_16x16x32_bf16 v[68:71], v[176:179], a[196:199], v[68:71]
v_exp_f32 v230, v110
v_mfma_f32_16x16x32_bf16 v[72:75], v[176:179], a[200:203], v[56:59]
ds_read_b64_tr_b16 v[210:211], v243 offset:6144
v_cvt_pk_bf16_f32 v139, v226, v227
v_mfma_f32_16x16x32_bf16 v[72:75], v[180:183], a[216:219], v[72:75]
v_exp_f32 v231, v111
v_mfma_f32_16x16x32_bf16 v[72:75], v[184:187], a[232:235], v[72:75]
ds_read_b64_tr_b16 v[212:213], v243 offset:12288
v_add_f32 v235, v235, v228
v_mfma_f32_16x16x32_bf16 v[72:75], v[188:191], a[248:251], v[72:75]
ds_read_b64_tr_b16 v[214:215], v243 offset:18432
v_add_f32 v235, v235, v229
v_mfma_f32_16x16x32_bf16 v[72:75], v[192:195], v[24:27], v[72:75]
ds_read_b64_tr_b16 v[216:217], v244 offset:0
v_cvt_pk_bf16_f32 v142, v228, v229
v_mfma_f32_16x16x32_bf16 v[72:75], v[196:199], v[40:43], v[72:75]
ds_read_b64_tr_b16 v[218:219], v244 offset:6144
v_add_f32 v235, v235, v230
v_mfma_f32_16x16x32_bf16 v[76:79], v[196:199], v[44:47], v[60:63]
ds_read_b64_tr_b16 v[220:221], v244 offset:12288
v_add_f32 v235, v235, v231
v_mfma_f32_16x16x32_bf16 v[76:79], v[192:195], v[28:31], v[76:79]
ds_read_b64_tr_b16 v[222:223], v244 offset:18432
v_cvt_pk_bf16_f32 v143, v230, v231
v_mfma_f32_16x16x32_bf16 v[76:79], v[188:191], a[252:255], v[76:79]
v_max3_f32 v224, v232, v233, v234
v_max_f32 v224, v224, v235
v_mfma_f32_16x16x32_bf16 v[76:79], v[184:187], a[236:239], v[76:79]
v_cmp_lt_f32 vcc, s60, v224
v_mfma_f32_16x16x32_bf16 v[76:79], v[180:183], a[220:223], v[76:79]
buffer_load_dwordx4 v251, s[16:19], s63 offen offset:2048 lds
v_mfma_f32_16x16x32_bf16 v[76:79], v[176:179], a[204:207], v[76:79]
s_waitcnt lgkmcnt(6)
s_cbranch_vccnz F_TR5
F_BK5:
v_mfma_f32_16x16x32_bf16 a[0:3], v[200:203], v[112:115], a[0:3]
ds_read_b128 v[176:179], v240 offset:30720
v_add_f32 v236, v236, v232
v_mfma_f32_16x16x32_bf16 a[0:3], v[204:207], v[128:131], a[0:3]
v_exp_f32 v224, v64
v_mfma_f32_16x16x32_bf16 a[4:7], v[200:203], v[116:119], a[4:7]
ds_read_b128 v[180:183], v241 offset:30720
v_add_f32 v237, v237, v233
v_mfma_f32_16x16x32_bf16 a[4:7], v[204:207], v[132:135], a[4:7]
s_add_u32 s63, s63, 12288
v_exp_f32 v225, v65
v_mfma_f32_16x16x32_bf16 a[8:11], v[200:203], v[120:123], a[8:11]
ds_read_b128 v[184:187], v240 offset:30848
v_add_f32 v238, v238, v234
v_mfma_f32_16x16x32_bf16 a[8:11], v[204:207], v[136:139], a[8:11]
v_exp_f32 v226, v66
v_mfma_f32_16x16x32_bf16 a[12:15], v[200:203], v[124:127], a[12:15]
ds_read_b128 v[188:191], v241 offset:30848
v_add_f32 v239, v239, v235
v_mfma_f32_16x16x32_bf16 a[12:15], v[204:207], v[140:143], a[12:15]
s_waitcnt lgkmcnt(4)
v_exp_f32 v227, v67
v_mfma_f32_16x16x32_bf16 a[28:31], v[208:211], v[124:127], a[28:31]
ds_read_b128 v[192:195], v240 offset:30976
v_add_f32 v232, v224, v225
v_mfma_f32_16x16x32_bf16 a[28:31], v[212:215], v[140:143], a[28:31]
v_exp_f32 v228, v68
v_mfma_f32_16x16x32_bf16 a[24:27], v[208:211], v[120:123], a[24:27]
ds_read_b128 v[196:199], v241 offset:30976
v_cvt_pk_bf16_f32 v144, v224, v225
v_mfma_f32_16x16x32_bf16 a[24:27], v[212:215], v[136:139], a[24:27]
v_exp_f32 v229, v69
v_mfma_f32_16x16x32_bf16 a[20:23], v[208:211], v[116:119], a[20:23]
v_exp_f32 v230, v70
v_mfma_f32_16x16x32_bf16 a[20:23], v[212:215], v[132:135], a[20:23]
s_mov_b32 m0, s47
v_exp_f32 v231, v71
v_mfma_f32_16x16x32_bf16 a[16:19], v[208:211], v[112:115], a[16:19]
buffer_load_dwordx4 v249, s[16:19], s63 offen offset:0 lds
v_mfma_f32_16x16x32_bf16 a[16:19], v[212:215], v[128:131], a[16:19]
v_add_f32 v232, v232, v226
v_add_f32 v232, v232, v227
v_mfma_f32_16x16x32_bf16 a[32:35], v[216:219], v[112:115], a[32:35]
v_cvt_pk_bf16_f32 v145, v226, v227
v_add_f32 v233, v228, v229
v_mfma_f32_16x16x32_bf16 a[32:35], v[220:223], v[128:131], a[32:35]
buffer_load_dwordx4 v250, s[16:19], s63 offen offset:1024 lds
v_mfma_f32_16x16x32_bf16 a[36:39], v[216:219], v[116:119], a[36:39]
s_cmp_lt_u32 s57, 9
v_cvt_pk_bf16_f32 v148, v228, v229
v_add_f32 v233, v233, v230
v_mfma_f32_16x16x32_bf16 a[36:39], v[220:223], v[132:135], a[36:39]
s_mov_b32 m0, s24
v_add_f32 v233, v233, v231
v_cvt_pk_bf16_f32 v149, v230, v231
v_mfma_f32_16x16x32_bf16 a[40:43], v[216:219], v[120:123], a[40:43]
buffer_load_dwordx4 v254, s[8:11], s25 offen lds
v_mfma_f32_16x16x32_bf16 a[40:43], v[220:223], v[136:139], a[40:43]
s_cselect_b32 s66, 128, s3
s_cselect_b32 s62, 1024, 0
v_mfma_f32_16x16x32_bf16 a[44:47], v[216:219], v[124:127], a[44:47]
s_mov_b32 m0, s47
s_add_u32 s25, s25, s66
v_mfma_f32_16x16x32_bf16 a[44:47], v[220:223], v[140:143], a[44:47]
s_waitcnt lgkmcnt(0)
s_add_u32 s24, s24, s62
v_mfma_f32_16x16x32_bf16 v[96:99], v[176:179], a[192:195], v[48:51]
v_exp_f32 v224, v72
v_mfma_f32_16x16x32_bf16 v[96:99], v[180:183], a[208:211], v[96:99]
ds_read_b64_tr_b16 v[200:201], v245 offset:0
v_mfma_f32_16x16x32_bf16 v[96:99], v[184:187], a[224:227], v[96:99]
v_exp_f32 v225, v73
v_mfma_f32_16x16x32_bf16 v[96:99], v[188:191], a[240:243], v[96:99]
ds_read_b64_tr_b16 v[202:203], v245 offset:6144
v_add_f32 v234, v224, v225
v_mfma_f32_16x16x32_bf16 v[96:99], v[192:195], v[16:19], v[96:99]
v_exp_f32 v226, v74
v_mfma_f32_16x16x32_bf16 v[96:99], v[196:199], v[32:35], v[96:99]
ds_read_b64_tr_b16 v[204:205], v245 offset:12288
v_cvt_pk_bf16_f32 v152, v224, v225
v_mfma_f32_16x16x32_bf16 v[100:103], v[196:199], v[36:39], v[52:55]
v_exp_f32 v227, v75
v_mfma_f32_16x16x32_bf16 v[100:103], v[192:195], v[20:23], v[100:103]
ds_read_b64_tr_b16 v[206:207], v245 offset:18432
v_add_f32 v234, v234, v226
v_mfma_f32_16x16x32_bf16 v[100:103], v[188:191], a[244:247], v[100:103]
v_exp_f32 v228, v76
v_mfma_f32_16x16x32_bf16 v[100:103], v[184:187], a[228:231], v[100:103]
ds_read_b64_tr_b16 v[208:209], v242 offset:128
v_add_f32 v234, v234, v227
v_mfma_f32_16x16x32_bf16 v[100:103], v[180:183], a[212:215], v[100:103]
v_exp_f32 v229, v77
v_mfma_f32_16x16x32_bf16 v[100:103], v[176:179], a[196:199], v[100:103]
ds_read_b64_tr_b16 v[210:211], v242 offset:6272
v_cvt_pk_bf16_f32 v153, v226, v227
v_mfma_f32_16x16x32_bf16 v[104:107], v[176:179], a[200:203], v[56:59]
v_exp_f32 v230, v78
v_mfma_f32_16x16x32_bf16 v[104:107], v[180:183], a[216:219], v[104:107]
ds_read_b64_tr_b16 v[212:213], v242 offset:12416
v_add_f32 v235, v228, v229
v_mfma_f32_16x16x32_bf16 v[104:107], v[184:187], a[232:235], v[104:107]
v_exp_f32 v231, v79
v_mfma_f32_16x16x32_bf16 v[104:107], v[188:191], a[248:251], v[104:107]
ds_read_b64_tr_b16 v[214:215], v242 offset:18560
v_cvt_pk_bf16_f32 v156, v228, v229
v_mfma_f32_16x16x32_bf16 v[104:107], v[192:195], v[24:27], v[104:107]
ds_read_b64_tr_b16 v[216:217], v243 offset:128
v_add_f32 v235, v235, v230
v_mfma_f32_16x16x32_bf16 v[104:107], v[196:199], v[40:43], v[104:107]
ds_read_b64_tr_b16 v[218:219], v243 offset:6272
v_add_f32 v235, v235, v231
v_mfma_f32_16x16x32_bf16 v[108:111], v[196:199], v[44:47], v[60:63]
ds_read_b64_tr_b16 v[220:221], v243 offset:12416
v_cvt_pk_bf16_f32 v157, v230, v231
v_mfma_f32_16x16x32_bf16 v[108:111], v[192:195], v[28:31], v[108:111]
ds_read_b64_tr_b16 v[222:223], v243 offset:18560
v_mfma_f32_16x16x32_bf16 v[108:111], v[188:191], a[252:255], v[108:111]
buffer_load_dwordx4 v251, s[16:19], s63 offen offset:2048 lds
v_mfma_f32_16x16x32_bf16 v[108:111], v[184:187], a[236:239], v[108:111]
s_add_u32 s63, s63, 12288
v_mfma_f32_16x16x32_bf16 v[108:111], v[180:183], a[220:223], v[108:111]
v_mfma_f32_16x16x32_bf16 v[108:111], v[176:179], a[204:207], v[108:111]
s_waitcnt vmcnt(11) lgkmcnt(0)
s_barrier
v_mfma_f32_16x16x32_bf16 a[60:63], v[200:203], v[124:127], a[60:63]
s_mov_b32 m0, s41
v_exp_f32 v224, v96
v_mfma_f32_16x16x32_bf16 a[60:63], v[204:207], v[140:143], a[60:63]
buffer_load_dwordx4 v246, s[12:15], s39 offen offset:0 lds
v_mfma_f32_16x16x32_bf16 a[56:59], v[200:203], v[120:123], a[56:59]
v_exp_f32 v225, v97
v_mfma_f32_16x16x32_bf16 a[56:59], v[204:207], v[136:139], a[56:59]
buffer_load_dwordx4 v247, s[12:15], s39 offen offset:1024 lds
v_mfma_f32_16x16x32_bf16 a[52:55], v[200:203], v[116:119], a[52:55]
ds_read_b128 v[176:179], v240 offset:36864
v_add_f32 v232, v232, v224
v_mfma_f32_16x16x32_bf16 a[52:55], v[204:207], v[132:135], a[52:55]
v_exp_f32 v226, v98
v_mfma_f32_16x16x32_bf16 a[48:51], v[200:203], v[112:115], a[48:51]
ds_read_b128 v[180:183], v241 offset:36864
v_add_f32 v232, v232, v225
v_mfma_f32_16x16x32_bf16 a[48:51], v[204:207], v[128:131], a[48:51]
v_exp_f32 v227, v99
v_mfma_f32_16x16x32_bf16 a[64:67], v[208:211], v[112:115], a[64:67]
ds_read_b128 v[184:187], v240 offset:36992
v_cvt_pk_bf16_f32 v146, v224, v225
v_mfma_f32_16x16x32_bf16 a[64:67], v[212:215], v[128:131], a[64:67]
v_exp_f32 v228, v100
v_mfma_f32_16x16x32_bf16 a[68:71], v[208:211], v[116:119], a[68:71]
ds_read_b128 v[188:191], v241 offset:36992
v_add_f32 v232, v232, v226
v_mfma_f32_16x16x32_bf16 a[68:71], v[212:215], v[132:135], a[68:71]
v_exp_f32 v229, v101
v_mfma_f32_16x16x32_bf16 a[72:75], v[208:211], v[120:123], a[72:75]
ds_read_b128 v[192:195], v240 offset:37120
v_add_f32 v232, v232, v227
v_mfma_f32_16x16x32_bf16 a[72:75], v[212:215], v[136:139], a[72:75]
v_exp_f32 v230, v102
v_mfma_f32_16x16x32_bf16 a[76:79], v[208:211], v[124:127], a[76:79]
ds_read_b128 v[196:199], v241 offset:37120
v_cvt_pk_bf16_f32 v147, v226, v227
v_mfma_f32_16x16x32_bf16 a[76:79], v[212:215], v[140:143], a[76:79]
v_exp_f32 v231, v103
v_mfma_f32_16x16x32_bf16 a[92:95], v[216:219], v[124:127], a[92:95]
v_add_f32 v233, v233, v228
v_add_f32 v233, v233, v229
v_mfma_f32_16x16x32_bf16 a[92:95], v[220:223], v[140:143], a[92:95]
v_cvt_pk_bf16_f32 v150, v228, v229
v_add_f32 v233, v233, v230
v_mfma_f32_16x16x32_bf16 a[88:91], v[216:219], v[120:123], a[88:91]
v_add_f32 v233, v233, v231
v_cvt_pk_bf16_f32 v151, v230, v231
v_mfma_f32_16x16x32_bf16 a[88:91], v[220:223], v[136:139], a[88:91]
v_mfma_f32_16x16x32_bf16 a[84:87], v[216:219], v[116:119], a[84:87]
v_mfma_f32_16x16x32_bf16 a[84:87], v[220:223], v[132:135], a[84:87]
v_mfma_f32_16x16x32_bf16 a[80:83], v[216:219], v[112:115], a[80:83]
s_waitcnt lgkmcnt(0)
v_mfma_f32_16x16x32_bf16 a[80:83], v[220:223], v[128:131], a[80:83]
v_mfma_f32_16x16x32_bf16 v[80:83], v[176:179], a[192:195], v[48:51]
v_exp_f32 v224, v104
v_mfma_f32_16x16x32_bf16 v[80:83], v[180:183], a[208:211], v[80:83]
v_exp_f32 v225, v105
v_mfma_f32_16x16x32_bf16 v[80:83], v[184:187], a[224:227], v[80:83]
ds_read_b64_tr_b16 v[200:201], v244 offset:128
v_add_f32 v234, v234, v224
v_mfma_f32_16x16x32_bf16 v[80:83], v[188:191], a[240:243], v[80:83]
v_exp_f32 v226, v106
v_mfma_f32_16x16x32_bf16 v[80:83], v[192:195], v[16:19], v[80:83]
ds_read_b64_tr_b16 v[202:203], v244 offset:6272
v_add_f32 v234, v234, v225
v_mfma_f32_16x16x32_bf16 v[80:83], v[196:199], v[32:35], v[80:83]
v_exp_f32 v227, v107
v_mfma_f32_16x16x32_bf16 v[84:87], v[196:199], v[36:39], v[52:55]
ds_read_b64_tr_b16 v[204:205], v244 offset:12416
v_cvt_pk_bf16_f32 v154, v224, v225
v_mfma_f32_16x16x32_bf16 v[84:87], v[192:195], v[20:23], v[84:87]
v_exp_f32 v228, v108
v_mfma_f32_16x16x32_bf16 v[84:87], v[188:191], a[244:247], v[84:87]
ds_read_b64_tr_b16 v[206:207], v244 offset:18560
v_add_f32 v234, v234, v226
v_mfma_f32_16x16x32_bf16 v[84:87], v[184:187], a[228:231], v[84:87]
v_exp_f32 v229, v109
v_mfma_f32_16x16x32_bf16 v[84:87], v[180:183], a[212:215], v[84:87]
ds_read_b64_tr_b16 v[208:209], v245 offset:128
v_add_f32 v234, v234, v227
v_mfma_f32_16x16x32_bf16 v[84:87], v[176:179], a[196:199], v[84:87]
v_exp_f32 v230, v110
v_mfma_f32_16x16x32_bf16 v[88:91], v[176:179], a[200:203], v[56:59]
ds_read_b64_tr_b16 v[210:211], v245 offset:6272
v_cvt_pk_bf16_f32 v155, v226, v227
v_mfma_f32_16x16x32_bf16 v[88:91], v[180:183], a[216:219], v[88:91]
v_exp_f32 v231, v111
v_mfma_f32_16x16x32_bf16 v[88:91], v[184:187], a[232:235], v[88:91]
ds_read_b64_tr_b16 v[212:213], v245 offset:12416
v_add_f32 v235, v235, v228
v_mfma_f32_16x16x32_bf16 v[88:91], v[188:191], a[248:251], v[88:91]
ds_read_b64_tr_b16 v[214:215], v245 offset:18560
v_add_f32 v235, v235, v229
v_mfma_f32_16x16x32_bf16 v[88:91], v[192:195], v[24:27], v[88:91]
ds_read_b64_tr_b16 v[216:217], v242 offset:256
v_cvt_pk_bf16_f32 v158, v228, v229
v_mfma_f32_16x16x32_bf16 v[88:91], v[196:199], v[40:43], v[88:91]
ds_read_b64_tr_b16 v[218:219], v242 offset:6400
v_add_f32 v235, v235, v230
v_mfma_f32_16x16x32_bf16 v[92:95], v[196:199], v[44:47], v[60:63]
ds_read_b64_tr_b16 v[220:221], v242 offset:12544
v_add_f32 v235, v235, v231
v_mfma_f32_16x16x32_bf16 v[92:95], v[192:195], v[28:31], v[92:95]
ds_read_b64_tr_b16 v[222:223], v242 offset:18688
v_cvt_pk_bf16_f32 v159, v230, v231
v_mfma_f32_16x16x32_bf16 v[92:95], v[188:191], a[252:255], v[92:95]
v_max3_f32 v224, v232, v233, v234
v_max_f32 v224, v224, v235
v_mfma_f32_16x16x32_bf16 v[92:95], v[184:187], a[236:239], v[92:95]
v_cmp_lt_f32 vcc, s60, v224
v_mfma_f32_16x16x32_bf16 v[92:95], v[180:183], a[220:223], v[92:95]
buffer_load_dwordx4 v248, s[12:15], s39 offen offset:2048 lds
v_mfma_f32_16x16x32_bf16 v[92:95], v[176:179], a[204:207], v[92:95]
s_waitcnt lgkmcnt(6)
s_cbranch_vccnz F_TR6
F_BK6:
v_mfma_f32_16x16x32_bf16 a[96:99], v[200:203], v[112:115], a[96:99]
ds_read_b128 v[176:179], v240 offset:43008
v_add_f32 v236, v236, v232
v_mfma_f32_16x16x32_bf16 a[96:99], v[204:207], v[128:131], a[96:99]
v_exp_f32 v224, v80
v_mfma_f32_16x16x32_bf16 a[100:103], v[200:203], v[116:119], a[100:103]
ds_read_b128 v[180:183], v241 offset:43008
v_add_f32 v237, v237, v233
v_mfma_f32_16x16x32_bf16 a[100:103], v[204:207], v[132:135], a[100:103]
s_add_u32 s39, s39, 12288
v_exp_f32 v225, v81
v_mfma_f32_16x16x32_bf16 a[104:107], v[200:203], v[120:123], a[104:107]
ds_read_b128 v[184:187], v240 offset:43136
v_add_f32 v238, v238, v234
v_mfma_f32_16x16x32_bf16 a[104:107], v[204:207], v[136:139], a[104:107]
v_exp_f32 v226, v82
v_mfma_f32_16x16x32_bf16 a[108:111], v[200:203], v[124:127], a[108:111]
ds_read_b128 v[188:191], v241 offset:43136
v_add_f32 v239, v239, v235
v_mfma_f32_16x16x32_bf16 a[108:111], v[204:207], v[140:143], a[108:111]
s_waitcnt lgkmcnt(4)
v_exp_f32 v227, v83
v_mfma_f32_16x16x32_bf16 a[124:127], v[208:211], v[124:127], a[124:127]
ds_read_b128 v[192:195], v240 offset:43264
v_add_f32 v232, v224, v225
v_mfma_f32_16x16x32_bf16 a[124:127], v[212:215], v[140:143], a[124:127]
v_exp_f32 v228, v84
v_mfma_f32_16x16x32_bf16 a[120:123], v[208:211], v[120:123], a[120:123]
ds_read_b128 v[196:199], v241 offset:43264
v_cvt_pk_bf16_f32 v160, v224, v225
v_mfma_f32_16x16x32_bf16 a[120:123], v[212:215], v[136:139], a[120:123]
v_exp_f32 v229, v85
v_mfma_f32_16x16x32_bf16 a[116:119], v[208:211], v[116:119], a[116:119]
v_exp_f32 v230, v86
v_mfma_f32_16x16x32_bf16 a[116:119], v[212:215], v[132:135], a[116:119]
s_mov_b32 m0, s42
v_exp_f32 v231, v87
v_mfma_f32_16x16x32_bf16 a[112:115], v[208:211], v[112:115], a[112:115]
buffer_load_dwordx4 v246, s[12:15], s39 offen offset:0 lds
v_mfma_f32_16x16x32_bf16 a[112:115], v[212:215], v[128:131], a[112:115]
v_add_f32 v232, v232, v226
v_add_f32 v232, v232, v227
v_mfma_f32_16x16x32_bf16 a[128:131], v[216:219], v[112:115], a[128:131]
v_cvt_pk_bf16_f32 v161, v226, v227
v_add_f32 v233, v228, v229
v_mfma_f32_16x16x32_bf16 a[128:131], v[220:223], v[128:131], a[128:131]
buffer_load_dwordx4 v247, s[12:15], s39 offen offset:1024 lds
v_mfma_f32_16x16x32_bf16 a[132:135], v[216:219], v[116:119], a[132:135]
v_cvt_pk_bf16_f32 v164, v228, v229
v_add_f32 v233, v233, v230
v_mfma_f32_16x16x32_bf16 a[132:135], v[220:223], v[132:135], a[132:135]
v_add_f32 v233, v233, v231
v_cvt_pk_bf16_f32 v165, v230, v231
v_mfma_f32_16x16x32_bf16 a[136:139], v[216:219], v[120:123], a[136:139]
buffer_load_dword v1, v252, s[12:15], s58 offen
v_mfma_f32_16x16x32_bf16 a[136:139], v[220:223], v[136:139], a[136:139]
v_mfma_f32_16x16x32_bf16 a[140:143], v[216:219], v[124:127], a[140:143]
s_add_u32 s58, s58, 49152
v_mfma_f32_16x16x32_bf16 a[140:143], v[220:223], v[140:143], a[140:143]
s_waitcnt lgkmcnt(0)
v_mfma_f32_16x16x32_bf16 v[96:99], v[176:179], a[192:195], v[48:51]
v_exp_f32 v224, v88
v_mfma_f32_16x16x32_bf16 v[96:99], v[180:183], a[208:211], v[96:99]
ds_read_b64_tr_b16 v[200:201], v243 offset:256
v_mfma_f32_16x16x32_bf16 v[96:99], v[184:187], a[224:227], v[96:99]
v_exp_f32 v225, v89
v_mfma_f32_16x16x32_bf16 v[96:99], v[188:191], a[240:243], v[96:99]
ds_read_b64_tr_b16 v[202:203], v243 offset:6400
v_add_f32 v234, v224, v225
v_mfma_f32_16x16x32_bf16 v[96:99], v[192:195], v[16:19], v[96:99]
v_exp_f32 v226, v90
v_mfma_f32_16x16x32_bf16 v[96:99], v[196:199], v[32:35], v[96:99]
ds_read_b64_tr_b16 v[204:205], v243 offset:12544
v_cvt_pk_bf16_f32 v168, v224, v225
v_mfma_f32_16x16x32_bf16 v[100:103], v[196:199], v[36:39], v[52:55]
v_exp_f32 v227, v91
v_mfma_f32_16x16x32_bf16 v[100:103], v[192:195], v[20:23], v[100:103]
ds_read_b64_tr_b16 v[206:207], v243 offset:18688
v_add_f32 v234, v234, v226
v_mfma_f32_16x16x32_bf16 v[100:103], v[188:191], a[244:247], v[100:103]
v_exp_f32 v228, v92
v_mfma_f32_16x16x32_bf16 v[100:103], v[184:187], a[228:231], v[100:103]
ds_read_b64_tr_b16 v[208:209], v244 offset:256
v_add_f32 v234, v234, v227
v_mfma_f32_16x16x32_bf16 v[100:103], v[180:183], a[212:215], v[100:103]
v_exp_f32 v229, v93
v_mfma_f32_16x16x32_bf16 v[100:103], v[176:179], a[196:199], v[100:103]
ds_read_b64_tr_b16 v[210:211], v244 offset:6400
v_cvt_pk_bf16_f32 v169, v226, v227
v_mfma_f32_16x16x32_bf16 v[104:107], v[176:179], a[200:203], v[56:59]
v_exp_f32 v230, v94
v_mfma_f32_16x16x32_bf16 v[104:107], v[180:183], a[216:219], v[104:107]
ds_read_b64_tr_b16 v[212:213], v244 offset:12544
v_add_f32 v235, v228, v229
v_mfma_f32_16x16x32_bf16 v[104:107], v[184:187], a[232:235], v[104:107]
v_exp_f32 v231, v95
v_mfma_f32_16x16x32_bf16 v[104:107], v[188:191], a[248:251], v[104:107]
ds_read_b64_tr_b16 v[214:215], v244 offset:18688
v_cvt_pk_bf16_f32 v172, v228, v229
v_mfma_f32_16x16x32_bf16 v[104:107], v[192:195], v[24:27], v[104:107]
ds_read_b64_tr_b16 v[216:217], v245 offset:256
v_add_f32 v235, v235, v230
v_mfma_f32_16x16x32_bf16 v[104:107], v[196:199], v[40:43], v[104:107]
ds_read_b64_tr_b16 v[218:219], v245 offset:6400
v_add_f32 v235, v235, v231
v_mfma_f32_16x16x32_bf16 v[108:111], v[196:199], v[44:47], v[60:63]
ds_read_b64_tr_b16 v[220:221], v245 offset:12544
v_cvt_pk_bf16_f32 v173, v230, v231
v_mfma_f32_16x16x32_bf16 v[108:111], v[192:195], v[28:31], v[108:111]
ds_read_b64_tr_b16 v[222:223], v245 offset:18688
v_mfma_f32_16x16x32_bf16 v[108:111], v[188:191], a[252:255], v[108:111]
buffer_load_dwordx4 v248, s[12:15], s39 offen offset:2048 lds
v_mfma_f32_16x16x32_bf16 v[108:111], v[184:187], a[236:239], v[108:111]
s_add_u32 s39, s39, 12288
v_mfma_f32_16x16x32_bf16 v[108:111], v[180:183], a[220:223], v[108:111]
v_mfma_f32_16x16x32_bf16 v[108:111], v[176:179], a[204:207], v[108:111]
s_waitcnt vmcnt(7) lgkmcnt(0)
s_barrier
v_mfma_f32_16x16x32_bf16 a[156:159], v[200:203], v[124:127], a[156:159]
s_mov_b32 m0, s44
v_exp_f32 v224, v96
v_mfma_f32_16x16x32_bf16 a[156:159], v[204:207], v[140:143], a[156:159]
buffer_load_dwordx4 v249, s[16:19], s63 offen offset:0 lds
v_mfma_f32_16x16x32_bf16 a[152:155], v[200:203], v[120:123], a[152:155]
v_exp_f32 v225, v97
v_mfma_f32_16x16x32_bf16 a[152:155], v[204:207], v[136:139], a[152:155]
buffer_load_dwordx4 v250, s[16:19], s63 offen offset:1024 lds
v_mfma_f32_16x16x32_bf16 a[148:151], v[200:203], v[116:119], a[148:151]
ds_read_b128 v[176:179], v240 offset:0
v_add_f32 v232, v232, v224
v_mfma_f32_16x16x32_bf16 a[148:151], v[204:207], v[132:135], a[148:151]
v_exp_f32 v226, v98
v_mfma_f32_16x16x32_bf16 a[144:147], v[200:203], v[112:115], a[144:147]
ds_read_b128 v[180:183], v241 offset:0
v_add_f32 v232, v232, v225
v_mfma_f32_16x16x32_bf16 a[144:147], v[204:207], v[128:131], a[144:147]
v_exp_f32 v227, v99
v_mfma_f32_16x16x32_bf16 a[160:163], v[208:211], v[112:115], a[160:163]
ds_read_b128 v[184:187], v240 offset:128
v_cvt_pk_bf16_f32 v162, v224, v225
v_mfma_f32_16x16x32_bf16 a[160:163], v[212:215], v[128:131], a[160:163]
v_exp_f32 v228, v100
v_mfma_f32_16x16x32_bf16 a[164:167], v[208:211], v[116:119], a[164:167]
ds_read_b128 v[188:191], v241 offset:128
v_add_f32 v232, v232, v226
v_mfma_f32_16x16x32_bf16 a[164:167], v[212:215], v[132:135], a[164:167]
v_exp_f32 v229, v101
v_mfma_f32_16x16x32_bf16 a[168:171], v[208:211], v[120:123], a[168:171]
ds_read_b128 v[192:195], v240 offset:256
v_add_f32 v232, v232, v227
v_mfma_f32_16x16x32_bf16 a[168:171], v[212:215], v[136:139], a[168:171]
v_exp_f32 v230, v102
v_mfma_f32_16x16x32_bf16 a[172:175], v[208:211], v[124:127], a[172:175]
ds_read_b128 v[196:199], v241 offset:256
v_cvt_pk_bf16_f32 v163, v226, v227
v_mfma_f32_16x16x32_bf16 a[172:175], v[212:215], v[140:143], a[172:175]
v_exp_f32 v231, v103
v_mfma_f32_16x16x32_bf16 a[188:191], v[216:219], v[124:127], a[188:191]
v_add_f32 v233, v233, v228
v_add_f32 v233, v233, v229
v_mfma_f32_16x16x32_bf16 a[188:191], v[220:223], v[140:143], a[188:191]
v_cvt_pk_bf16_f32 v166, v228, v229
v_add_f32 v233, v233, v230
v_mfma_f32_16x16x32_bf16 a[184:187], v[216:219], v[120:123], a[184:187]
v_add_f32 v233, v233, v231
v_cvt_pk_bf16_f32 v167, v230, v231
v_mfma_f32_16x16x32_bf16 a[184:187], v[220:223], v[136:139], a[184:187]
s_add_u32 s57, s57, 1
v_mfma_f32_16x16x32_bf16 a[180:183], v[216:219], v[116:119], a[180:183]
s_bitcmp1_b32 0x9800, s57
v_mfma_f32_16x16x32_bf16 a[180:183], v[220:223], v[132:135], a[180:183]
v_mfma_f32_16x16x32_bf16 a[176:179], v[216:219], v[112:115], a[176:179]
s_waitcnt lgkmcnt(0)
v_mfma_f32_16x16x32_bf16 a[176:179], v[220:223], v[128:131], a[176:179]
s_cbranch_scc0 F_AL
s_cmp_eq_u32 s57, 15
s_cbranch_scc1 F_LAST
s_cmp_lg_u32 s36, 0
s_cbranch_scc1 F_AL
s_cmp_eq_u32 s57, 12
s_cbranch_scc1 F_H1
s_add_u32 s66, s84, 2
s_lshl_b32 s67, s85, 5
s_add_u32 s67, s67, s37
s_lshl_b32 s67, s67, 2
v_mov_b32 v4, s66
v_mov_b32 v5, 0
s_mov_b64 exec, 1
buffer_store_dword v4, v5, s[80:83], s67 offen sc1
s_mov_b64 exec, -1
s_mov_b32 s66, 4
s_cmp_ge_u32 s2, 8
s_cbranch_scc1 F_AL
s_mov_b32 s28, s78
s_mov_b32 s29, s79
s_mov_b32 s30, 0x40
s_mov_b32 s31, 0x20000
s_mov_b64 exec, 1
v_mov_b32 v254, 1
buffer_atomic_add v254, off, s[28:31], s66 sc0 sc1
s_mov_b64 exec, -1
s_branch F_AL
F_H1:
s_cmp_ge_u32 s2, 8
s_cbranch_scc1 F_AL
s_lshl_b32 s66, s2, 2
s_add_u32 s66, s66, 32
s_mov_b64 exec, 1
v_and_b32 v254, 7, v254
v_add_u32 v254, s84, v254
buffer_store_dword v254, off, s[28:31], s66 sc1
s_mov_b64 exec, -1
s_branch F_AL
F_LAST:
ds_read_b64_tr_b16 v[200:201], v242 offset:24576
ds_read_b64_tr_b16 v[202:203], v242 offset:30720
ds_read_b64_tr_b16 v[204:205], v242 offset:36864
ds_read_b64_tr_b16 v[206:207], v242 offset:43008
ds_read_b64_tr_b16 v[208:209], v243 offset:24576
ds_read_b64_tr_b16 v[210:211], v243 offset:30720
ds_read_b64_tr_b16 v[212:213], v243 offset:36864
ds_read_b64_tr_b16 v[214:215], v243 offset:43008
ds_read_b64_tr_b16 v[216:217], v244 offset:24576
ds_read_b64_tr_b16 v[218:219], v244 offset:30720
ds_read_b64_tr_b16 v[220:221], v244 offset:36864
ds_read_b64_tr_b16 v[222:223], v244 offset:43008
s_cmp_lg_u32 s36, 0
s_cbranch_scc1 F_W9
buffer_load_dwordx4 v[140:143], v253, s[80:83], 0 offen sc1
F_W9:
s_mov_b32 s28, s78
s_mov_b32 s29, s79
s_mov_b32 s30, 0x40
s_mov_b32 s31, 0x20000
v_and_b32 v138, 15, v0
v_lshlrev_b32 v137, 2, v138
buffer_load_dword v136, v137, s[28:31], 0 offen sc1
v_exp_f32 v224, v104
v_exp_f32 v225, v105
v_exp_f32 v226, v106
v_exp_f32 v227, v107
v_exp_f32 v228, v108
v_exp_f32 v229, v109
v_exp_f32 v230, v110
v_exp_f32 v231, v111
ds_read_b64_tr_b16 v[176:177], v245 offset:24576
ds_read_b64_tr_b16 v[178:179], v245 offset:30720
ds_read_b64_tr_b16 v[180:181], v245 offset:36864
ds_read_b64_tr_b16 v[182:183], v245 offset:43008
ds_read_b64_tr_b16 v[184:185], v242 offset:24704
ds_read_b64_tr_b16 v[186:187], v242 offset:30848
ds_read_b64_tr_b16 v[188:189], v242 offset:36992
ds_read_b64_tr_b16 v[190:191], v242 offset:43136
ds_read_b64_tr_b16 v[192:193], v243 offset:24704
ds_read_b64_tr_b16 v[194:195], v243 offset:30848
ds_read_b64_tr_b16 v[196:197], v243 offset:36992
ds_read_b64_tr_b16 v[198:199], v243 offset:43136
v_add_f32 v234, v234, v224
v_add_f32 v234, v234, v225
v_cvt_pk_bf16_f32 v170, v224, v225
v_add_f32 v234, v234, v226
v_add_f32 v234, v234, v227
v_cvt_pk_bf16_f32 v171, v226, v227
v_add_f32 v235, v235, v228
v_add_f32 v235, v235, v229
v_cvt_pk_bf16_f32 v174, v228, v229
v_add_f32 v235, v235, v230
v_add_f32 v235, v235, v231
v_cvt_pk_bf16_f32 v175, v230, v231
v_max3_f32 v224, v232, v233, v234
v_max_f32 v224, v224, v235
v_cmp_lt_f32 vcc, s60, v224
s_waitcnt lgkmcnt(12)
s_cbranch_vccnz F_TR7
F_BK7:
v_add_f32 v236, v236, v232
v_add_f32 v237, v237, v233
v_add_f32 v238, v238, v234
v_add_f32 v239, v239, v235
s_nop 0
v_mfma_f32_16x16x32_bf16 a[0:3], v[200:203], v[144:147], a[0:3]
v_mov_b32 v2, v236
v_mov_b32 v3, v237
v_mfma_f32_16x16x32_bf16 a[0:3], v[204:207], v[160:163], a[0:3]
v_mov_b32 v4, v238
v_mov_b32 v5, v239
v_mfma_f32_16x16x32_bf16 a[4:7], v[200:203], v[148:151], a[4:7]
s_nop 1
v_permlane16_swap_b32 v236, v2
v_mfma_f32_16x16x32_bf16 a[4:7], v[204:207], v[164:167], a[4:7]
v_permlane16_swap_b32 v237, v3
v_permlane16_swap_b32 v238, v4
v_mfma_f32_16x16x32_bf16 a[8:11], v[200:203], v[152:155], a[8:11]
v_permlane16_swap_b32 v239, v5
v_add_f32 v236, v236, v2
v_mfma_f32_16x16x32_bf16 a[8:11], v[204:207], v[168:171], a[8:11]
v_add_f32 v237, v237, v3
v_add_f32 v238, v238, v4
v_mfma_f32_16x16x32_bf16 a[12:15], v[200:203], v[156:159], a[12:15]
v_add_f32 v239, v239, v5
v_mov_b32 v2, v236
v_mfma_f32_16x16x32_bf16 a[12:15], v[204:207], v[172:175], a[12:15]
v_mov_b32 v3, v237
v_mov_b32 v4, v238
v_mfma_f32_16x16x32_bf16 a[28:31], v[208:211], v[156:159], a[28:31]
v_mov_b32 v5, v239
s_nop 1
v_mfma_f32_16x16x32_bf16 a[28:31], v[212:215], v[172:175], a[28:31]
v_permlane32_swap_b32 v236, v2
v_permlane32_swap_b32 v237, v3
v_mfma_f32_16x16x32_bf16 a[24:27], v[208:211], v[152:155], a[24:27]
v_permlane32_swap_b32 v238, v4
v_permlane32_swap_b32 v239, v5
v_mfma_f32_16x16x32_bf16 a[24:27], v[212:215], v[168:171], a[24:27]
v_add_f32 v236, v236, v2
v_add_f32 v237, v237, v3
v_mfma_f32_16x16x32_bf16 a[20:23], v[208:211], v[148:151], a[20:23]
v_add_f32 v238, v238, v4
v_add_f32 v239, v239, v5
v_mfma_f32_16x16x32_bf16 a[20:23], v[212:215], v[164:167], a[20:23]
v_rcp_f32 v8, v236
v_rcp_f32 v10, v237
v_mfma_f32_16x16x32_bf16 a[16:19], v[208:211], v[144:147], a[16:19]
v_rcp_f32 v12, v238
v_rcp_f32 v14, v239
v_mfma_f32_16x16x32_bf16 a[16:19], v[212:215], v[160:163], a[16:19]
v_mfma_f32_16x16x32_bf16 a[32:35], v[216:219], v[144:147], a[32:35]
v_mfma_f32_16x16x32_bf16 a[32:35], v[220:223], v[160:163], a[32:35]
v_mfma_f32_16x16x32_bf16 a[36:39], v[216:219], v[148:151], a[36:39]
v_mfma_f32_16x16x32_bf16 a[36:39], v[220:223], v[164:167], a[36:39]
v_mfma_f32_16x16x32_bf16 a[40:43], v[216:219], v[152:155], a[40:43]
v_mfma_f32_16x16x32_bf16 a[40:43], v[220:223], v[168:171], a[40:43]
v_mfma_f32_16x16x32_bf16 a[44:47], v[216:219], v[156:159], a[44:47]
v_mfma_f32_16x16x32_bf16 a[44:47], v[220:223], v[172:175], a[44:47]
s_waitcnt lgkmcnt(0)
v_mfma_f32_16x16x32_bf16 a[60:63], v[176:179], v[156:159], a[60:63]
ds_read_b64_tr_b16 v[200:201], v244 offset:24704
v_mfma_f32_16x16x32_bf16 a[60:63], v[180:183], v[172:175], a[60:63]
ds_read_b64_tr_b16 v[202:203], v244 offset:30848
v_mfma_f32_16x16x32_bf16 a[56:59], v[176:179], v[152:155], a[56:59]
ds_read_b64_tr_b16 v[204:205], v244 offset:36992
v_mfma_f32_16x16x32_bf16 a[56:59], v[180:183], v[168:171], a[56:59]
ds_read_b64_tr_b16 v[206:207], v244 offset:43136
v_mfma_f32_16x16x32_bf16 a[52:55], v[176:179], v[148:151], a[52:55]
ds_read_b64_tr_b16 v[208:209], v245 offset:24704
v_mfma_f32_16x16x32_bf16 a[52:55], v[180:183], v[164:167], a[52:55]
ds_read_b64_tr_b16 v[210:211], v245 offset:30848
v_mfma_f32_16x16x32_bf16 a[48:51], v[176:179], v[144:147], a[48:51]
ds_read_b64_tr_b16 v[212:213], v245 offset:36992
v_mfma_f32_16x16x32_bf16 a[48:51], v[180:183], v[160:163], a[48:51]
ds_read_b64_tr_b16 v[214:215], v245 offset:43136
v_mfma_f32_16x16x32_bf16 a[64:67], v[184:187], v[144:147], a[64:67]
ds_read_b64_tr_b16 v[216:217], v242 offset:24832
v_mfma_f32_16x16x32_bf16 a[64:67], v[188:191], v[160:163], a[64:67]
ds_read_b64_tr_b16 v[218:219], v242 offset:30976
v_mfma_f32_16x16x32_bf16 a[68:71], v[184:187], v[148:151], a[68:71]
ds_read_b64_tr_b16 v[220:221], v242 offset:37120
v_mfma_f32_16x16x32_bf16 a[68:71], v[188:191], v[164:167], a[68:71]
ds_read_b64_tr_b16 v[222:223], v242 offset:43264
v_mfma_f32_16x16x32_bf16 a[72:75], v[184:187], v[152:155], a[72:75]
v_mfma_f32_16x16x32_bf16 a[72:75], v[188:191], v[168:171], a[72:75]
v_mfma_f32_16x16x32_bf16 a[76:79], v[184:187], v[156:159], a[76:79]
v_mfma_f32_16x16x32_bf16 a[76:79], v[188:191], v[172:175], a[76:79]
v_mfma_f32_16x16x32_bf16 a[92:95], v[192:195], v[156:159], a[92:95]
v_mfma_f32_16x16x32_bf16 a[92:95], v[196:199], v[172:175], a[92:95]
v_mfma_f32_16x16x32_bf16 a[88:91], v[192:195], v[152:155], a[88:91]
v_mfma_f32_16x16x32_bf16 a[88:91], v[196:199], v[168:171], a[88:91]
v_mfma_f32_16x16x32_bf16 a[84:87], v[192:195], v[148:151], a[84:87]
v_mfma_f32_16x16x32_bf16 a[84:87], v[196:199], v[164:167], a[84:87]
v_mfma_f32_16x16x32_bf16 a[80:83], v[192:195], v[144:147], a[80:83]
v_mfma_f32_16x16x32_bf16 a[80:83], v[196:199], v[160:163], a[80:83]
s_add_u32 s66, s61, 0
v_accvgpr_read_b32 v64, a0
v_accvgpr_read_b32 v65, a1
v_accvgpr_read_b32 v66, a2
v_accvgpr_read_b32 v67, a3
v_accvgpr_read_b32 v68, a16
v_accvgpr_read_b32 v69, a17
v_accvgpr_read_b32 v70, a18
v_accvgpr_read_b32 v71, a19
v_pk_mul_f32 v[64:65], v[64:65], v[8:9] op_sel_hi:[1,0]
v_pk_mul_f32 v[66:67], v[66:67], v[8:9] op_sel_hi:[1,0]
v_pk_mul_f32 v[68:69], v[68:69], v[8:9] op_sel_hi:[1,0]
v_pk_mul_f32 v[70:71], v[70:71], v[8:9] op_sel_hi:[1,0]
v_cvt_pk_bf16_f32 v112, v64, v65
v_cvt_pk_bf16_f32 v113, v66, v67
v_cvt_pk_bf16_f32 v114, v68, v69
v_cvt_pk_bf16_f32 v115, v70, v71
buffer_store_dwordx4 v[112:115], v253, s[32:35], s66 offen offset:0 sc1
v_accvgpr_read_b32 v72, a4
v_accvgpr_read_b32 v73, a5
v_accvgpr_read_b32 v74, a6
v_accvgpr_read_b32 v75, a7
v_accvgpr_read_b32 v76, a20
v_accvgpr_read_b32 v77, a21
v_accvgpr_read_b32 v78, a22
v_accvgpr_read_b32 v79, a23
v_pk_mul_f32 v[72:73], v[72:73], v[10:11] op_sel_hi:[1,0]
v_pk_mul_f32 v[74:75], v[74:75], v[10:11] op_sel_hi:[1,0]
v_pk_mul_f32 v[76:77], v[76:77], v[10:11] op_sel_hi:[1,0]
v_pk_mul_f32 v[78:79], v[78:79], v[10:11] op_sel_hi:[1,0]
v_cvt_pk_bf16_f32 v116, v72, v73
v_cvt_pk_bf16_f32 v117, v74, v75
v_cvt_pk_bf16_f32 v118, v76, v77
v_cvt_pk_bf16_f32 v119, v78, v79
buffer_store_dwordx4 v[116:119], v253, s[32:35], s66 offen offset:1024 sc1
v_accvgpr_read_b32 v80, a8
v_accvgpr_read_b32 v81, a9
v_accvgpr_read_b32 v82, a10
v_accvgpr_read_b32 v83, a11
v_accvgpr_read_b32 v84, a24
v_accvgpr_read_b32 v85, a25
v_accvgpr_read_b32 v86, a26
v_accvgpr_read_b32 v87, a27
v_pk_mul_f32 v[80:81], v[80:81], v[12:13] op_sel_hi:[1,0]
v_pk_mul_f32 v[82:83], v[82:83], v[12:13] op_sel_hi:[1,0]
v_pk_mul_f32 v[84:85], v[84:85], v[12:13] op_sel_hi:[1,0]
v_pk_mul_f32 v[86:87], v[86:87], v[12:13] op_sel_hi:[1,0]
v_cvt_pk_bf16_f32 v120, v80, v81
v_cvt_pk_bf16_f32 v121, v82, v83
v_cvt_pk_bf16_f32 v122, v84, v85
v_cvt_pk_bf16_f32 v123, v86, v87
buffer_store_dwordx4 v[120:123], v253, s[32:35], s66 offen offset:2048 sc1
v_accvgpr_read_b32 v88, a12
v_accvgpr_read_b32 v89, a13
v_accvgpr_read_b32 v90, a14
v_accvgpr_read_b32 v91, a15
v_accvgpr_read_b32 v92, a28
v_accvgpr_read_b32 v93, a29
v_accvgpr_read_b32 v94, a30
v_accvgpr_read_b32 v95, a31
v_pk_mul_f32 v[88:89], v[88:89], v[14:15] op_sel_hi:[1,0]
v_pk_mul_f32 v[90:91], v[90:91], v[14:15] op_sel_hi:[1,0]
v_pk_mul_f32 v[92:93], v[92:93], v[14:15] op_sel_hi:[1,0]
v_pk_mul_f32 v[94:95], v[94:95], v[14:15] op_sel_hi:[1,0]
v_cvt_pk_bf16_f32 v124, v88, v89
v_cvt_pk_bf16_f32 v125, v90, v91
v_cvt_pk_bf16_f32 v126, v92, v93
v_cvt_pk_bf16_f32 v127, v94, v95
buffer_store_dwordx4 v[124:127], v253, s[32:35], s66 offen offset:3072 sc1
s_waitcnt lgkmcnt(0)
v_mfma_f32_16x16x32_bf16 a[96:99], v[200:203], v[144:147], a[96:99]
ds_read_b64_tr_b16 v[176:177], v243 offset:24832
v_mfma_f32_16x16x32_bf16 a[96:99], v[204:207], v[160:163], a[96:99]
ds_read_b64_tr_b16 v[178:179], v243 offset:30976
v_mfma_f32_16x16x32_bf16 a[100:103], v[200:203], v[148:151], a[100:103]
ds_read_b64_tr_b16 v[180:181], v243 offset:37120
v_mfma_f32_16x16x32_bf16 a[100:103], v[204:207], v[164:167], a[100:103]
ds_read_b64_tr_b16 v[182:183], v243 offset:43264
v_mfma_f32_16x16x32_bf16 a[104:107], v[200:203], v[152:155], a[104:107]
ds_read_b64_tr_b16 v[184:185], v244 offset:24832
v_mfma_f32_16x16x32_bf16 a[104:107], v[204:207], v[168:171], a[104:107]
ds_read_b64_tr_b16 v[186:187], v244 offset:30976
v_mfma_f32_16x16x32_bf16 a[108:111], v[200:203], v[156:159], a[108:111]
ds_read_b64_tr_b16 v[188:189], v244 offset:37120
v_mfma_f32_16x16x32_bf16 a[108:111], v[204:207], v[172:175], a[108:111]
ds_read_b64_tr_b16 v[190:191], v244 offset:43264
v_mfma_f32_16x16x32_bf16 a[124:127], v[208:211], v[156:159], a[124:127]
ds_read_b64_tr_b16 v[192:193], v245 offset:24832
v_mfma_f32_16x16x32_bf16 a[124:127], v[212:215], v[172:175], a[124:127]
ds_read_b64_tr_b16 v[194:195], v245 offset:30976
v_mfma_f32_16x16x32_bf16 a[120:123], v[208:211], v[152:155], a[120:123]
ds_read_b64_tr_b16 v[196:197], v245 offset:37120
v_mfma_f32_16x16x32_bf16 a[120:123], v[212:215], v[168:171], a[120:123]
ds_read_b64_tr_b16 v[198:199], v245 offset:43264
v_mfma_f32_16x16x32_bf16 a[116:119], v[208:211], v[148:151], a[116:119]
v_mfma_f32_16x16x32_bf16 a[116:119], v[212:215], v[164:167], a[116:119]
v_mfma_f32_16x16x32_bf16 a[112:115], v[208:211], v[144:147], a[112:115]
v_mfma_f32_16x16x32_bf16 a[112:115], v[212:215], v[160:163], a[112:115]
v_mfma_f32_16x16x32_bf16 a[128:131], v[216:219], v[144:147], a[128:131]
v_mfma_f32_16x16x32_bf16 a[128:131], v[220:223], v[160:163], a[128:131]
v_mfma_f32_16x16x32_bf16 a[132:135], v[216:219], v[148:151], a[132:135]
v_mfma_f32_16x16x32_bf16 a[132:135], v[220:223], v[164:167], a[132:135]
v_mfma_f32_16x16x32_bf16 a[136:139], v[216:219], v[152:155], a[136:139]
v_mfma_f32_16x16x32_bf16 a[136:139], v[220:223], v[168:171], a[136:139]
v_mfma_f32_16x16x32_bf16 a[140:143], v[216:219], v[156:159], a[140:143]
v_mfma_f32_16x16x32_bf16 a[140:143], v[220:223], v[172:175], a[140:143]
s_add_u32 s66, s61, 4096
v_accvgpr_read_b32 v64, a32
v_accvgpr_read_b32 v65, a33
v_accvgpr_read_b32 v66, a34
v_accvgpr_read_b32 v67, a35
v_accvgpr_read_b32 v68, a48
v_accvgpr_read_b32 v69, a49
v_accvgpr_read_b32 v70, a50
v_accvgpr_read_b32 v71, a51
v_pk_mul_f32 v[64:65], v[64:65], v[8:9] op_sel_hi:[1,0]
v_pk_mul_f32 v[66:67], v[66:67], v[8:9] op_sel_hi:[1,0]
v_pk_mul_f32 v[68:69], v[68:69], v[8:9] op_sel_hi:[1,0]
v_pk_mul_f32 v[70:71], v[70:71], v[8:9] op_sel_hi:[1,0]
v_cvt_pk_bf16_f32 v128, v64, v65
v_cvt_pk_bf16_f32 v129, v66, v67
v_cvt_pk_bf16_f32 v130, v68, v69
v_cvt_pk_bf16_f32 v131, v70, v71
buffer_store_dwordx4 v[128:131], v253, s[32:35], s66 offen offset:0 sc1
v_accvgpr_read_b32 v72, a36
v_accvgpr_read_b32 v73, a37
v_accvgpr_read_b32 v74, a38
v_accvgpr_read_b32 v75, a39
v_accvgpr_read_b32 v76, a52
v_accvgpr_read_b32 v77, a53
v_accvgpr_read_b32 v78, a54
v_accvgpr_read_b32 v79, a55
v_pk_mul_f32 v[72:73], v[72:73], v[10:11] op_sel_hi:[1,0]
v_pk_mul_f32 v[74:75], v[74:75], v[10:11] op_sel_hi:[1,0]
v_pk_mul_f32 v[76:77], v[76:77], v[10:11] op_sel_hi:[1,0]
v_pk_mul_f32 v[78:79], v[78:79], v[10:11] op_sel_hi:[1,0]
v_cvt_pk_bf16_f32 v132, v72, v73
v_cvt_pk_bf16_f32 v133, v74, v75
v_cvt_pk_bf16_f32 v134, v76, v77
v_cvt_pk_bf16_f32 v135, v78, v79
buffer_store_dwordx4 v[132:135], v253, s[32:35], s66 offen offset:1024 sc1
v_accvgpr_read_b32 v80, a40
v_accvgpr_read_b32 v81, a41
v_accvgpr_read_b32 v82, a42
v_accvgpr_read_b32 v83, a43
v_accvgpr_read_b32 v84, a56
v_accvgpr_read_b32 v85, a57
v_accvgpr_read_b32 v86, a58
v_accvgpr_read_b32 v87, a59
v_pk_mul_f32 v[80:81], v[80:81], v[12:13] op_sel_hi:[1,0]
v_pk_mul_f32 v[82:83], v[82:83], v[12:13] op_sel_hi:[1,0]
v_pk_mul_f32 v[84:85], v[84:85], v[12:13] op_sel_hi:[1,0]
v_pk_mul_f32 v[86:87], v[86:87], v[12:13] op_sel_hi:[1,0]
v_cvt_pk_bf16_f32 v112, v80, v81
v_cvt_pk_bf16_f32 v113, v82, v83
v_cvt_pk_bf16_f32 v114, v84, v85
v_cvt_pk_bf16_f32 v115, v86, v87
buffer_store_dwordx4 v[112:115], v253, s[32:35], s66 offen offset:2048 sc1
v_accvgpr_read_b32 v88, a44
v_accvgpr_read_b32 v89, a45
v_accvgpr_read_b32 v90, a46
v_accvgpr_read_b32 v91, a47
v_accvgpr_read_b32 v92, a60
v_accvgpr_read_b32 v93, a61
v_accvgpr_read_b32 v94, a62
v_accvgpr_read_b32 v95, a63
v_pk_mul_f32 v[88:89], v[88:89], v[14:15] op_sel_hi:[1,0]
v_pk_mul_f32 v[90:91], v[90:91], v[14:15] op_sel_hi:[1,0]
v_pk_mul_f32 v[92:93], v[92:93], v[14:15] op_sel_hi:[1,0]
v_pk_mul_f32 v[94:95], v[94:95], v[14:15] op_sel_hi:[1,0]
v_cvt_pk_bf16_f32 v116, v88, v89
v_cvt_pk_bf16_f32 v117, v90, v91
v_cvt_pk_bf16_f32 v118, v92, v93
v_cvt_pk_bf16_f32 v119, v94, v95
buffer_store_dwordx4 v[116:119], v253, s[32:35], s66 offen offset:3072 sc1
s_add_u32 s66, s61, 8192
v_accvgpr_read_b32 v64, a64
v_accvgpr_read_b32 v65, a65
v_accvgpr_read_b32 v66, a66
v_accvgpr_read_b32 v67, a67
v_accvgpr_read_b32 v68, a80
v_accvgpr_read_b32 v69, a81
v_accvgpr_read_b32 v70, a82
v_accvgpr_read_b32 v71, a83
v_pk_mul_f32 v[64:65], v[64:65], v[8:9] op_sel_hi:[1,0]
v_pk_mul_f32 v[66:67], v[66:67], v[8:9] op_sel_hi:[1,0]
v_pk_mul_f32 v[68:69], v[68:69], v[8:9] op_sel_hi:[1,0]
v_pk_mul_f32 v[70:71], v[70:71], v[8:9] op_sel_hi:[1,0]
v_cvt_pk_bf16_f32 v120, v64, v65
v_cvt_pk_bf16_f32 v121, v66, v67
v_cvt_pk_bf16_f32 v122, v68, v69
v_cvt_pk_bf16_f32 v123, v70, v71
buffer_store_dwordx4 v[120:123], v253, s[32:35], s66 offen offset:0 sc1
v_accvgpr_read_b32 v72, a68
v_accvgpr_read_b32 v73, a69
v_accvgpr_read_b32 v74, a70
v_accvgpr_read_b32 v75, a71
v_accvgpr_read_b32 v76, a84
v_accvgpr_read_b32 v77, a85
v_accvgpr_read_b32 v78, a86
v_accvgpr_read_b32 v79, a87
v_pk_mul_f32 v[72:73], v[72:73], v[10:11] op_sel_hi:[1,0]
v_pk_mul_f32 v[74:75], v[74:75], v[10:11] op_sel_hi:[1,0]
v_pk_mul_f32 v[76:77], v[76:77], v[10:11] op_sel_hi:[1,0]
v_pk_mul_f32 v[78:79], v[78:79], v[10:11] op_sel_hi:[1,0]
v_cvt_pk_bf16_f32 v124, v72, v73
v_cvt_pk_bf16_f32 v125, v74, v75
v_cvt_pk_bf16_f32 v126, v76, v77
v_cvt_pk_bf16_f32 v127, v78, v79
buffer_store_dwordx4 v[124:127], v253, s[32:35], s66 offen offset:1024 sc1
v_accvgpr_read_b32 v80, a72
v_accvgpr_read_b32 v81, a73
v_accvgpr_read_b32 v82, a74
v_accvgpr_read_b32 v83, a75
v_accvgpr_read_b32 v84, a88
v_accvgpr_read_b32 v85, a89
v_accvgpr_read_b32 v86, a90
v_accvgpr_read_b32 v87, a91
v_pk_mul_f32 v[80:81], v[80:81], v[12:13] op_sel_hi:[1,0]
v_pk_mul_f32 v[82:83], v[82:83], v[12:13] op_sel_hi:[1,0]
v_pk_mul_f32 v[84:85], v[84:85], v[12:13] op_sel_hi:[1,0]
v_pk_mul_f32 v[86:87], v[86:87], v[12:13] op_sel_hi:[1,0]
v_cvt_pk_bf16_f32 v128, v80, v81
v_cvt_pk_bf16_f32 v129, v82, v83
v_cvt_pk_bf16_f32 v130, v84, v85
v_cvt_pk_bf16_f32 v131, v86, v87
buffer_store_dwordx4 v[128:131], v253, s[32:35], s66 offen offset:2048 sc1
v_accvgpr_read_b32 v88, a76
v_accvgpr_read_b32 v89, a77
v_accvgpr_read_b32 v90, a78
v_accvgpr_read_b32 v91, a79
v_accvgpr_read_b32 v92, a92
v_accvgpr_read_b32 v93, a93
v_accvgpr_read_b32 v94, a94
v_accvgpr_read_b32 v95, a95
v_pk_mul_f32 v[88:89], v[88:89], v[14:15] op_sel_hi:[1,0]
v_pk_mul_f32 v[90:91], v[90:91], v[14:15] op_sel_hi:[1,0]
v_pk_mul_f32 v[92:93], v[92:93], v[14:15] op_sel_hi:[1,0]
v_pk_mul_f32 v[94:95], v[94:95], v[14:15] op_sel_hi:[1,0]
v_cvt_pk_bf16_f32 v132, v88, v89
v_cvt_pk_bf16_f32 v133, v90, v91
v_cvt_pk_bf16_f32 v134, v92, v93
v_cvt_pk_bf16_f32 v135, v94, v95
buffer_store_dwordx4 v[132:135], v253, s[32:35], s66 offen offset:3072 sc1
s_waitcnt lgkmcnt(0)
v_mfma_f32_16x16x32_bf16 a[156:159], v[176:179], v[156:159], a[156:159]
v_mfma_f32_16x16x32_bf16 a[156:159], v[180:183], v[172:175], a[156:159]
v_mfma_f32_16x16x32_bf16 a[152:155], v[176:179], v[152:155], a[152:155]
v_mfma_f32_16x16x32_bf16 a[152:155], v[180:183], v[168:171], a[152:155]
v_mfma_f32_16x16x32_bf16 a[148:151], v[176:179], v[148:151], a[148:151]
v_mfma_f32_16x16x32_bf16 a[148:151], v[180:183], v[164:167], a[148:151]
v_mfma_f32_16x16x32_bf16 a[144:147], v[176:179], v[144:147], a[144:147]
v_mfma_f32_16x16x32_bf16 a[144:147], v[180:183], v[160:163], a[144:147]
v_mfma_f32_16x16x32_bf16 a[160:163], v[184:187], v[144:147], a[160:163]
v_mfma_f32_16x16x32_bf16 a[160:163], v[188:191], v[160:163], a[160:163]
v_mfma_f32_16x16x32_bf16 a[164:167], v[184:187], v[148:151], a[164:167]
v_mfma_f32_16x16x32_bf16 a[164:167], v[188:191], v[164:167], a[164:167]
v_mfma_f32_16x16x32_bf16 a[168:171], v[184:187], v[152:155], a[168:171]
v_mfma_f32_16x16x32_bf16 a[168:171], v[188:191], v[168:171], a[168:171]
v_mfma_f32_16x16x32_bf16 a[172:175], v[184:187], v[156:159], a[172:175]
v_mfma_f32_16x16x32_bf16 a[172:175], v[188:191], v[172:175], a[172:175]
v_mfma_f32_16x16x32_bf16 a[188:191], v[192:195], v[156:159], a[188:191]
v_mfma_f32_16x16x32_bf16 a[188:191], v[196:199], v[172:175], a[188:191]
v_mfma_f32_16x16x32_bf16 a[184:187], v[192:195], v[152:155], a[184:187]
v_mfma_f32_16x16x32_bf16 a[184:187], v[196:199], v[168:171], a[184:187]
v_mfma_f32_16x16x32_bf16 a[180:183], v[192:195], v[148:151], a[180:183]
v_mfma_f32_16x16x32_bf16 a[180:183], v[196:199], v[164:167], a[180:183]
v_mfma_f32_16x16x32_bf16 a[176:179], v[192:195], v[144:147], a[176:179]
v_mfma_f32_16x16x32_bf16 a[176:179], v[196:199], v[160:163], a[176:179]
s_add_u32 s66, s61, 12288
v_accvgpr_read_b32 v64, a96
v_accvgpr_read_b32 v65, a97
v_accvgpr_read_b32 v66, a98
v_accvgpr_read_b32 v67, a99
v_accvgpr_read_b32 v68, a112
v_accvgpr_read_b32 v69, a113
v_accvgpr_read_b32 v70, a114
v_accvgpr_read_b32 v71, a115
v_pk_mul_f32 v[64:65], v[64:65], v[8:9] op_sel_hi:[1,0]
v_pk_mul_f32 v[66:67], v[66:67], v[8:9] op_sel_hi:[1,0]
v_pk_mul_f32 v[68:69], v[68:69], v[8:9] op_sel_hi:[1,0]
v_pk_mul_f32 v[70:71], v[70:71], v[8:9] op_sel_hi:[1,0]
v_cvt_pk_bf16_f32 v112, v64, v65
v_cvt_pk_bf16_f32 v113, v66, v67
v_cvt_pk_bf16_f32 v114, v68, v69
v_cvt_pk_bf16_f32 v115, v70, v71
buffer_store_dwordx4 v[112:115], v253, s[32:35], s66 offen offset:0 sc1
v_accvgpr_read_b32 v72, a100
v_accvgpr_read_b32 v73, a101
v_accvgpr_read_b32 v74, a102
v_accvgpr_read_b32 v75, a103
v_accvgpr_read_b32 v76, a116
v_accvgpr_read_b32 v77, a117
v_accvgpr_read_b32 v78, a118
v_accvgpr_read_b32 v79, a119
v_pk_mul_f32 v[72:73], v[72:73], v[10:11] op_sel_hi:[1,0]
v_pk_mul_f32 v[74:75], v[74:75], v[10:11] op_sel_hi:[1,0]
v_pk_mul_f32 v[76:77], v[76:77], v[10:11] op_sel_hi:[1,0]
v_pk_mul_f32 v[78:79], v[78:79], v[10:11] op_sel_hi:[1,0]
v_cvt_pk_bf16_f32 v116, v72, v73
v_cvt_pk_bf16_f32 v117, v74, v75
v_cvt_pk_bf16_f32 v118, v76, v77
v_cvt_pk_bf16_f32 v119, v78, v79
buffer_store_dwordx4 v[116:119], v253, s[32:35], s66 offen offset:1024 sc1
v_accvgpr_read_b32 v80, a104
v_accvgpr_read_b32 v81, a105
v_accvgpr_read_b32 v82, a106
v_accvgpr_read_b32 v83, a107
v_accvgpr_read_b32 v84, a120
v_accvgpr_read_b32 v85, a121
v_accvgpr_read_b32 v86, a122
v_accvgpr_read_b32 v87, a123
v_pk_mul_f32 v[80:81], v[80:81], v[12:13] op_sel_hi:[1,0]
v_pk_mul_f32 v[82:83], v[82:83], v[12:13] op_sel_hi:[1,0]
v_pk_mul_f32 v[84:85], v[84:85], v[12:13] op_sel_hi:[1,0]
v_pk_mul_f32 v[86:87], v[86:87], v[12:13] op_sel_hi:[1,0]
v_cvt_pk_bf16_f32 v120, v80, v81
v_cvt_pk_bf16_f32 v121, v82, v83
v_cvt_pk_bf16_f32 v122, v84, v85
v_cvt_pk_bf16_f32 v123, v86, v87
buffer_store_dwordx4 v[120:123], v253, s[32:35], s66 offen offset:2048 sc1
v_accvgpr_read_b32 v88, a108
v_accvgpr_read_b32 v89, a109
v_accvgpr_read_b32 v90, a110
v_accvgpr_read_b32 v91, a111
v_accvgpr_read_b32 v92, a124
v_accvgpr_read_b32 v93, a125
v_accvgpr_read_b32 v94, a126
v_accvgpr_read_b32 v95, a127
v_pk_mul_f32 v[88:89], v[88:89], v[14:15] op_sel_hi:[1,0]
v_pk_mul_f32 v[90:91], v[90:91], v[14:15] op_sel_hi:[1,0]
v_pk_mul_f32 v[92:93], v[92:93], v[14:15] op_sel_hi:[1,0]
v_pk_mul_f32 v[94:95], v[94:95], v[14:15] op_sel_hi:[1,0]
v_cvt_pk_bf16_f32 v124, v88, v89
v_cvt_pk_bf16_f32 v125, v90, v91
v_cvt_pk_bf16_f32 v126, v92, v93
v_cvt_pk_bf16_f32 v127, v94, v95
buffer_store_dwordx4 v[124:127], v253, s[32:35], s66 offen offset:3072 sc1
s_add_u32 s66, s61, 16384
v_accvgpr_read_b32 v64, a128
v_accvgpr_read_b32 v65, a129
v_accvgpr_read_b32 v66, a130
v_accvgpr_read_b32 v67, a131
v_accvgpr_read_b32 v68, a144
v_accvgpr_read_b32 v69, a145
v_accvgpr_read_b32 v70, a146
v_accvgpr_read_b32 v71, a147
v_pk_mul_f32 v[64:65], v[64:65], v[8:9] op_sel_hi:[1,0]
v_pk_mul_f32 v[66:67], v[66:67], v[8:9] op_sel_hi:[1,0]
v_pk_mul_f32 v[68:69], v[68:69], v[8:9] op_sel_hi:[1,0]
v_pk_mul_f32 v[70:71], v[70:71], v[8:9] op_sel_hi:[1,0]
v_cvt_pk_bf16_f32 v128, v64, v65
v_cvt_pk_bf16_f32 v129, v66, v67
v_cvt_pk_bf16_f32 v130, v68, v69
v_cvt_pk_bf16_f32 v131, v70, v71
buffer_store_dwordx4 v[128:131], v253, s[32:35], s66 offen offset:0 sc1
v_accvgpr_read_b32 v72, a132
v_accvgpr_read_b32 v73, a133
v_accvgpr_read_b32 v74, a134
v_accvgpr_read_b32 v75, a135
v_accvgpr_read_b32 v76, a148
v_accvgpr_read_b32 v77, a149
v_accvgpr_read_b32 v78, a150
v_accvgpr_read_b32 v79, a151
v_pk_mul_f32 v[72:73], v[72:73], v[10:11] op_sel_hi:[1,0]
v_pk_mul_f32 v[74:75], v[74:75], v[10:11] op_sel_hi:[1,0]
v_pk_mul_f32 v[76:77], v[76:77], v[10:11] op_sel_hi:[1,0]
v_pk_mul_f32 v[78:79], v[78:79], v[10:11] op_sel_hi:[1,0]
v_cvt_pk_bf16_f32 v132, v72, v73
v_cvt_pk_bf16_f32 v133, v74, v75
v_cvt_pk_bf16_f32 v134, v76, v77
v_cvt_pk_bf16_f32 v135, v78, v79
buffer_store_dwordx4 v[132:135], v253, s[32:35], s66 offen offset:1024 sc1
v_accvgpr_read_b32 v80, a136
v_accvgpr_read_b32 v81, a137
v_accvgpr_read_b32 v82, a138
v_accvgpr_read_b32 v83, a139
v_accvgpr_read_b32 v84, a152
v_accvgpr_read_b32 v85, a153
v_accvgpr_read_b32 v86, a154
v_accvgpr_read_b32 v87, a155
v_pk_mul_f32 v[80:81], v[80:81], v[12:13] op_sel_hi:[1,0]
v_pk_mul_f32 v[82:83], v[82:83], v[12:13] op_sel_hi:[1,0]
v_pk_mul_f32 v[84:85], v[84:85], v[12:13] op_sel_hi:[1,0]
v_pk_mul_f32 v[86:87], v[86:87], v[12:13] op_sel_hi:[1,0]
v_cvt_pk_bf16_f32 v112, v80, v81
v_cvt_pk_bf16_f32 v113, v82, v83
v_cvt_pk_bf16_f32 v114, v84, v85
v_cvt_pk_bf16_f32 v115, v86, v87
buffer_store_dwordx4 v[112:115], v253, s[32:35], s66 offen offset:2048 sc1
v_accvgpr_read_b32 v88, a140
v_accvgpr_read_b32 v89, a141
v_accvgpr_read_b32 v90, a142
v_accvgpr_read_b32 v91, a143
v_accvgpr_read_b32 v92, a156
v_accvgpr_read_b32 v93, a157
v_accvgpr_read_b32 v94, a158
v_accvgpr_read_b32 v95, a159
v_pk_mul_f32 v[88:89], v[88:89], v[14:15] op_sel_hi:[1,0]
v_pk_mul_f32 v[90:91], v[90:91], v[14:15] op_sel_hi:[1,0]
v_pk_mul_f32 v[92:93], v[92:93], v[14:15] op_sel_hi:[1,0]
v_pk_mul_f32 v[94:95], v[94:95], v[14:15] op_sel_hi:[1,0]
v_cvt_pk_bf16_f32 v116, v88, v89
v_cvt_pk_bf16_f32 v117, v90, v91
v_cvt_pk_bf16_f32 v118, v92, v93
v_cvt_pk_bf16_f32 v119, v94, v95
buffer_store_dwordx4 v[116:119], v253, s[32:35], s66 offen offset:3072 sc1
s_add_u32 s66, s61, 20480
v_accvgpr_read_b32 v64, a160
v_accvgpr_read_b32 v65, a161
v_accvgpr_read_b32 v66, a162
v_accvgpr_read_b32 v67, a163
v_accvgpr_read_b32 v68, a176
v_accvgpr_read_b32 v69, a177
v_accvgpr_read_b32 v70, a178
v_accvgpr_read_b32 v71, a179
v_pk_mul_f32 v[64:65], v[64:65], v[8:9] op_sel_hi:[1,0]
v_pk_mul_f32 v[66:67], v[66:67], v[8:9] op_sel_hi:[1,0]
v_pk_mul_f32 v[68:69], v[68:69], v[8:9] op_sel_hi:[1,0]
v_pk_mul_f32 v[70:71], v[70:71], v[8:9] op_sel_hi:[1,0]
v_cvt_pk_bf16_f32 v120, v64, v65
v_cvt_pk_bf16_f32 v121, v66, v67
v_cvt_pk_bf16_f32 v122, v68, v69
v_cvt_pk_bf16_f32 v123, v70, v71
buffer_store_dwordx4 v[120:123], v253, s[32:35], s66 offen offset:0 sc1
v_accvgpr_read_b32 v72, a164
v_accvgpr_read_b32 v73, a165
v_accvgpr_read_b32 v74, a166
v_accvgpr_read_b32 v75, a167
v_accvgpr_read_b32 v76, a180
v_accvgpr_read_b32 v77, a181
v_accvgpr_read_b32 v78, a182
v_accvgpr_read_b32 v79, a183
v_pk_mul_f32 v[72:73], v[72:73], v[10:11] op_sel_hi:[1,0]
v_pk_mul_f32 v[74:75], v[74:75], v[10:11] op_sel_hi:[1,0]
v_pk_mul_f32 v[76:77], v[76:77], v[10:11] op_sel_hi:[1,0]
v_pk_mul_f32 v[78:79], v[78:79], v[10:11] op_sel_hi:[1,0]
v_cvt_pk_bf16_f32 v124, v72, v73
v_cvt_pk_bf16_f32 v125, v74, v75
v_cvt_pk_bf16_f32 v126, v76, v77
v_cvt_pk_bf16_f32 v127, v78, v79
buffer_store_dwordx4 v[124:127], v253, s[32:35], s66 offen offset:1024 sc1
v_accvgpr_read_b32 v80, a168
v_accvgpr_read_b32 v81, a169
v_accvgpr_read_b32 v82, a170
v_accvgpr_read_b32 v83, a171
v_accvgpr_read_b32 v84, a184
v_accvgpr_read_b32 v85, a185
v_accvgpr_read_b32 v86, a186
v_accvgpr_read_b32 v87, a187
v_pk_mul_f32 v[80:81], v[80:81], v[12:13] op_sel_hi:[1,0]
v_pk_mul_f32 v[82:83], v[82:83], v[12:13] op_sel_hi:[1,0]
v_pk_mul_f32 v[84:85], v[84:85], v[12:13] op_sel_hi:[1,0]
v_pk_mul_f32 v[86:87], v[86:87], v[12:13] op_sel_hi:[1,0]
v_cvt_pk_bf16_f32 v128, v80, v81
v_cvt_pk_bf16_f32 v129, v82, v83
v_cvt_pk_bf16_f32 v130, v84, v85
v_cvt_pk_bf16_f32 v131, v86, v87
buffer_store_dwordx4 v[128:131], v253, s[32:35], s66 offen offset:2048 sc1
v_accvgpr_read_b32 v88, a172
v_accvgpr_read_b32 v89, a173
v_accvgpr_read_b32 v90, a174
v_accvgpr_read_b32 v91, a175
v_accvgpr_read_b32 v92, a188
v_accvgpr_read_b32 v93, a189
v_accvgpr_read_b32 v94, a190
v_accvgpr_read_b32 v95, a191
v_pk_mul_f32 v[88:89], v[88:89], v[14:15] op_sel_hi:[1,0]
v_pk_mul_f32 v[90:91], v[90:91], v[14:15] op_sel_hi:[1,0]
v_pk_mul_f32 v[92:93], v[92:93], v[14:15] op_sel_hi:[1,0]
v_pk_mul_f32 v[94:95], v[94:95], v[14:15] op_sel_hi:[1,0]
v_cvt_pk_bf16_f32 v132, v88, v89
v_cvt_pk_bf16_f32 v133, v90, v91
v_cvt_pk_bf16_f32 v134, v92, v93
v_cvt_pk_bf16_f32 v135, v94, v95
buffer_store_dwordx4 v[132:135], v253, s[32:35], s66 offen offset:3072 sc1
s_waitcnt vmcnt(24)
s_cmp_lg_u32 s36, 0
s_cbranch_scc1 F_W13
s_add_u32 s66, s84, 2
v_subrev_u32 v140, s66, v140
v_subrev_u32 v141, s66, v141
v_subrev_u32 v142, s66, v142
v_subrev_u32 v143, s66, v143
v_max3_u32 v140, v140, v141, v142
v_max_u32 v140, v140, v143
v_cmp_lt_u32 vcc, 2, v140
s_nop 1
s_cbranch_vccz F_K10
v_mov_b32 v2, v253
s_mov_b32 exec_lo, -1
s_mov_b32 exec_hi, -1
s_add_u32 s66, s84, 2
s_mov_b32 s67, 0
F_P11:
buffer_load_dwordx4 v[4:7], v2, s[80:83], 0 offen sc1
s_waitcnt vmcnt(0)
v_subrev_u32 v4, s66, v4
v_subrev_u32 v5, s66, v5
v_subrev_u32 v6, s66, v6
v_subrev_u32 v7, s66, v7
v_max3_u32 v4, v4, v5, v6
v_max_u32 v4, v4, v7
v_cmp_lt_u32 vcc, 2, v4
s_add_u32 s67, s67, 1
s_cmp_gt_u32 s67, 262144
s_cbranch_scc1 F_D12
s_cbranch_vccnz F_P11
F_D12:
s_mov_b64 exec, -1
F_K10:
F_W13:
s_mov_b32 s67, 0
F_R14:
v_readlane_b32 s84, v136, 0
s_add_u32 s67, s67, 1
s_nop 0
v_subrev_u32 v138, s84, v136
v_cmp_lt_u32 vcc, 7, v138
s_nop 3
s_and_b32 s41, vcc_lo, 0xff00
s_cbranch_scc0 F_D15
s_cmp_gt_u32 s67, 262144
s_cbranch_scc1 F_D15
buffer_load_dword v136, v137, s[28:31], 0 offen sc1
s_waitcnt vmcnt(0)
s_branch F_R14
F_D15:
s_mov_b32 s52, 0
s_and_b32 s41, s2, 7
s_add_u32 s41, s41, 8
v_readlane_b32 s42, v138, s41
v_readlane_b32 s12, v138, 8
v_readlane_b32 s13, v138, 9
v_readlane_b32 s14, v138, 10
v_readlane_b32 s15, v138, 11
v_readlane_b32 s16, v138, 12
v_readlane_b32 s17, v138, 13
v_readlane_b32 s18, v138, 14
v_readlane_b32 s19, v138, 15
s_nop 3
s_and_b32 s41, s13, 7
s_lshl_b32 s41, s41, 2
s_lshl_b32 s41, 1, s41
s_or_b32 s52, s52, s41
s_and_b32 s41, s14, 7
s_lshl_b32 s41, s41, 2
s_lshl_b32 s41, 2, s41
s_or_b32 s52, s52, s41
s_and_b32 s41, s15, 7
s_lshl_b32 s41, s41, 2
s_lshl_b32 s41, 3, s41
s_or_b32 s52, s52, s41
s_and_b32 s41, s16, 7
s_lshl_b32 s41, s41, 2
s_lshl_b32 s41, 4, s41
s_or_b32 s52, s52, s41
s_and_b32 s41, s17, 7
s_lshl_b32 s41, s41, 2
s_lshl_b32 s41, 5, s41
s_or_b32 s52, s52, s41
s_and_b32 s41, s18, 7
s_lshl_b32 s41, s41, 2
s_lshl_b32 s41, 6, s41
s_or_b32 s52, s52, s41
s_and_b32 s41, s19, 7
s_lshl_b32 s41, s41, 2
s_lshl_b32 s41, 7, s41
s_or_b32 s52, s52, s41
s_and_b32 s42, s42, 7
s_lshr_b32 s54, s42, 1
s_add_u32 s55, s42, 1
s_lshr_b32 s55, s55, 1
s_and_b32 s55, s55, 1
s_and_b32 s56, s37, 3
s_mov_b32 s50, 0x2290c100
s_mov_b32 s51, 0x0
s_mov_b32 s46, 5
s_cmp_eq_u32 s54, 2
s_cselect_b32 s50, 0xde7b38d5, s50
s_cselect_b32 s51, 0x5, s51
s_cselect_b32 s46, 6, s46
s_cmp_eq_u32 s54, 1
s_cselect_b32 s50, 0x66b1c521, s50
s_cselect_b32 s51, 0x69, s51
s_cselect_b32 s46, 7, s46
s_cmp_eq_u32 s54, 0
s_cselect_b32 s50, 0x24a14100, s50
s_cselect_b32 s51, 0x1461, s51
s_cselect_b32 s46, 8, s46
s_lshl_b32 s41, s85, 7
s_lshl_b32 s42, s37, 2
s_add_u32 s42, s42, s41
s_cmp_eq_u32 s54, 3
s_cselect_b32 s52, 0x98, s52
s_cselect_b32 s60, 0, 16
s_cselect_b32 s62, s42, s41
s_cselect_b32 s40, 0, 3
v_and_b32 v1, s40, v0
v_lshlrev_b32 v165, 2, v1
s_mul_i32 s41, s56, 2457600
s_add_u32 s41, s41, 0x300000
s_add_u32 s12, s70, s41
s_addc_u32 s13, s71, 0
s_mov_b32 s14, 0x258000
s_mov_b32 s15, 0x20000
s_lshl_b32 s41, s85, 2
s_lshl_b32 s42, s55, 1
s_add_u32 s41, s41, s42
s_lshr_b32 s42, s36, 1
s_add_u32 s41, s41, s42
s_mul_i32 s41, s41, 983040
s_and_b32 s42, s36, 1
s_lshl_b32 s42, s42, 11
s_add_u32 s41, s41, s42
s_add_u32 s41, s41, 0x1000000
s_sub_u32 s43, 983040, s42
s_add_u32 s16, s70, s41
s_addc_u32 s17, s71, 0
s_mov_b32 s18, s43
s_mov_b32 s19, 0x20000
s_mov_b32 s58, 0
s_mov_b32 s59, 4096
s_mov_b32 s39, 0
s_mul_i32 s40, s36, 5120
s_lshl_b32 s41, s85, 1
s_add_u32 s41, s41, s55
s_lshl_b32 s41, s41, 2
s_add_u32 s41, s41, s56
s_mul_i32 s41, s41, 327680
s_add_u32 s41, s41, 0x5000000
s_add_u32 s20, s70, s41
s_addc_u32 s21, s71, 0
s_mov_b32 s22, 0x50000
s_mov_b32 s23, 0x20000
s_lshl_b32 s41, s85, 3
s_lshl_b32 s42, s55, 2
s_add_u32 s41, s41, s42
s_add_u32 s41, s41, s54
s_lshl_b32 s41, s41, 1
s_and_b32 s42, s36, 1
s_add_u32 s41, s41, s42
s_mul_i32 s41, s41, 20480
s_mul_i32 s42, s56, 320
s_add_u32 s41, s41, s42
s_lshr_b32 s42, s36, 1
s_mul_i32 s42, s42, 160
s_add_u32 s41, s41, s42
s_sub_u32 s42, 2621440, s41
s_add_u32 s24, s4, s41
s_addc_u32 s25, s5, 0
s_mov_b32 s26, s42
s_mov_b32 s27, 0x20000
s_add_u32 s28, s76, s41
s_addc_u32 s29, s77, 0
s_mov_b32 s30, s42
s_mov_b32 s31, 0x20000
s_lshl_b32 s44, 0x11111111, s56
s_lshl_b32 s48, s85, 7
v_add_u32 v162, s40, v253
v_add_u32 v163, 4096, v162
v_mov_b32 v160, v253
v_add_u32 v161, 61440, v253
v_accvgpr_write_b32 a0, 0
v_accvgpr_write_b32 a1, 0
v_accvgpr_write_b32 a2, 0
v_accvgpr_write_b32 a3, 0
v_accvgpr_write_b32 a4, 0
v_accvgpr_write_b32 a5, 0
v_accvgpr_write_b32 a6, 0
v_accvgpr_write_b32 a7, 0
v_accvgpr_write_b32 a8, 0
v_accvgpr_write_b32 a9, 0
v_accvgpr_write_b32 a10, 0
v_accvgpr_write_b32 a11, 0
v_accvgpr_write_b32 a12, 0
v_accvgpr_write_b32 a13, 0
v_accvgpr_write_b32 a14, 0
v_accvgpr_write_b32 a15, 0
v_accvgpr_write_b32 a16, 0
v_accvgpr_write_b32 a17, 0
v_accvgpr_write_b32 a18, 0
v_accvgpr_write_b32 a19, 0
v_accvgpr_write_b32 a20, 0
v_accvgpr_write_b32 a21, 0
v_accvgpr_write_b32 a22, 0
v_accvgpr_write_b32 a23, 0
v_accvgpr_write_b32 a24, 0
v_accvgpr_write_b32 a25, 0
v_accvgpr_write_b32 a26, 0
v_accvgpr_write_b32 a27, 0
v_accvgpr_write_b32 a28, 0
v_accvgpr_write_b32 a29, 0
v_accvgpr_write_b32 a30, 0
v_accvgpr_write_b32 a31, 0
v_accvgpr_write_b32 a32, 0
v_accvgpr_write_b32 a33, 0
v_accvgpr_write_b32 a34, 0
v_accvgpr_write_b32 a35, 0
v_accvgpr_write_b32 a36, 0
v_accvgpr_write_b32 a37, 0
v_accvgpr_write_b32 a38, 0
v_accvgpr_write_b32 a39, 0
v_accvgpr_write_b32 a40, 0
v_accvgpr_write_b32 a41, 0
v_accvgpr_write_b32 a42, 0
v_accvgpr_write_b32 a43, 0
v_accvgpr_write_b32 a44, 0
v_accvgpr_write_b32 a45, 0
v_accvgpr_write_b32 a46, 0
v_accvgpr_write_b32 a47, 0
v_accvgpr_write_b32 a48, 0
v_accvgpr_write_b32 a49, 0
v_accvgpr_write_b32 a50, 0
v_accvgpr_write_b32 a51, 0
v_accvgpr_write_b32 a52, 0
v_accvgpr_write_b32 a53, 0
v_accvgpr_write_b32 a54, 0
v_accvgpr_write_b32 a55, 0
v_accvgpr_write_b32 a56, 0
v_accvgpr_write_b32 a57, 0
v_accvgpr_write_b32 a58, 0
v_accvgpr_write_b32 a59, 0
v_accvgpr_write_b32 a60, 0
v_accvgpr_write_b32 a61, 0
v_accvgpr_write_b32 a62, 0
v_accvgpr_write_b32 a63, 0
v_accvgpr_write_b32 a64, 0
v_accvgpr_write_b32 a65, 0
v_accvgpr_write_b32 a66, 0
v_accvgpr_write_b32 a67, 0
v_accvgpr_write_b32 a68, 0
v_accvgpr_write_b32 a69, 0
v_accvgpr_write_b32 a70, 0
v_accvgpr_write_b32 a71, 0
v_accvgpr_write_b32 a72, 0
v_accvgpr_write_b32 a73, 0
v_accvgpr_write_b32 a74, 0
v_accvgpr_write_b32 a75, 0
v_accvgpr_write_b32 a76, 0
v_accvgpr_write_b32 a77, 0
v_accvgpr_write_b32 a78, 0
v_accvgpr_write_b32 a79, 0
s_waitcnt vmcnt(0)
s_barrier
s_cmp_lg_u32 s36, 0
s_cbranch_scc1 F_W16
s_add_u32 s66, s84, 3
s_lshl_b32 s67, s85, 5
s_add_u32 s67, s67, s37
s_lshl_b32 s67, s67, 2
v_mov_b32 v4, s66
v_mov_b32 v5, 0
s_mov_b64 exec, 1
buffer_store_dword v4, v5, s[80:83], s67 offen sc1
s_mov_b64 exec, -1
F_W16:
s_and_b32 s45, s50, 7
s_lshl_b32 s45, s45, 2
s_lshr_b32 s45, s52, s45
s_and_b32 s45, s45, 15
s_bfe_u32 s43, s50, 0x20003
s_mul_i32 s47, s45, s60
s_add_u32 s47, s47, s62
s_mul_i32 s45, s45, 3
s_add_u32 s45, s45, s43
s_mul_i32 s53, s45, 81920
s_lshl_b32 s49, s45, 15
s_mov_b32 s39, s53
s_mov_b32 s58, s49
s_add_u32 s59, s49, 4096
s_add_u32 m0, s40, 0
s_nop 0
buffer_load_dwordx4 v162, s[12:15], s39 offen offset:0 sc1 lds
buffer_load_dwordx4 v162, s[12:15], s39 offen offset:1024 sc1 lds
buffer_load_dwordx4 v162, s[12:15], s39 offen offset:2048 sc1 lds
buffer_load_dwordx4 v162, s[12:15], s39 offen offset:3072 sc1 lds
s_add_u32 m0, s40, 4096
s_nop 0
buffer_load_dwordx4 v163, s[12:15], s39 offen offset:0 sc1 lds
s_add_u32 s39, s39, 20480
s_add_u32 m0, s40, 20480
s_nop 0
buffer_load_dwordx4 v162, s[12:15], s39 offen offset:0 sc1 lds
buffer_load_dwordx4 v162, s[12:15], s39 offen offset:1024 sc1 lds
buffer_load_dwordx4 v162, s[12:15], s39 offen offset:2048 sc1 lds
buffer_load_dwordx4 v162, s[12:15], s39 offen offset:3072 sc1 lds
s_add_u32 m0, s40, 24576
s_nop 0
buffer_load_dwordx4 v163, s[12:15], s39 offen offset:0 sc1 lds
s_add_u32 s39, s39, 20480
s_add_u32 m0, s40, 40960
s_nop 0
buffer_load_dwordx4 v162, s[12:15], s39 offen offset:0 sc1 lds
buffer_load_dwordx4 v162, s[12:15], s39 offen offset:1024 sc1 lds
buffer_load_dwordx4 v162, s[12:15], s39 offen offset:2048 sc1 lds
s_cmp_eq_u32 s54, 3
s_cbranch_scc1 F_T0B
F_T0:
s_mov_b32 s67, 0
F_S17:
buffer_load_dword v166, v165, s[80:83], s47 offen sc1
s_waitcnt vmcnt(0)
v_subrev_u32 v166, s84, v166
v_subrev_u32 v166, 3, v166
v_cmp_lt_u32 vcc, 1, v166
s_add_u32 s67, s67, 1
s_cmp_gt_u32 s67, 262144
s_cbranch_scc1 F_T0B
s_cbranch_vccnz F_S17
s_branch F_T0B
F_T0B:
s_lshr_b64 s[50:51], s[50:51], 5
s_and_b32 s45, s50, 7
s_lshl_b32 s45, s45, 2
s_lshr_b32 s45, s52, s45
s_and_b32 s45, s45, 15
s_bfe_u32 s43, s50, 0x20003
s_mul_i32 s47, s45, s60
s_add_u32 s47, s47, s62
s_mul_i32 s45, s45, 3
s_add_u32 s45, s45, s43
s_mul_i32 s53, s45, 81920
s_lshl_b32 s49, s45, 15
buffer_load_dword v166, v165, s[80:83], s47 offen sc1
buffer_load_dwordx4 v[16:19], v253, s[16:19], s58 offen offset:0 sc1
buffer_load_dwordx4 v[20:23], v253, s[16:19], s58 offen offset:1024 sc1
buffer_load_dwordx4 v[24:27], v253, s[16:19], s59 offen offset:0 sc1
buffer_load_dwordx4 v[28:31], v253, s[16:19], s59 offen offset:1024 sc1
s_add_u32 s58, s58, 8192
s_add_u32 s59, s59, 8192
buffer_load_dwordx4 v[32:35], v253, s[16:19], s58 offen offset:0 sc1
buffer_load_dwordx4 v[36:39], v253, s[16:19], s58 offen offset:1024 sc1
buffer_load_dwordx4 v[40:43], v253, s[16:19], s59 offen offset:0 sc1
buffer_load_dwordx4 v[44:47], v253, s[16:19], s59 offen offset:1024 sc1
s_add_u32 s58, s58, 8192
s_add_u32 s59, s59, 8192
buffer_load_dwordx4 v[48:51], v253, s[16:19], s58 offen offset:0 sc1
buffer_load_dwordx4 v[52:55], v253, s[16:19], s58 offen offset:1024 sc1
buffer_load_dwordx4 v[56:59], v253, s[16:19], s59 offen offset:0 sc1
buffer_load_dwordx4 v[60:63], v253, s[16:19], s59 offen offset:1024 sc1
s_add_u32 s58, s58, 8192
s_add_u32 s59, s59, 8192
s_waitcnt vmcnt(8)
s_barrier
ds_read_b128 v[96:99], v160 offset:0
ds_read_b128 v[100:103], v160 offset:10240
ds_read_b128 v[104:107], v160 offset:1024
ds_read_b128 v[108:111], v160 offset:11264
ds_read_b128 v[112:115], v160 offset:2048
ds_read_b128 v[116:119], v160 offset:12288
s_mov_b32 s57, 0
s_waitcnt lgkmcnt(4)
.p2align 6
F_TLS:
v_mfma_f32_16x16x32_bf16 a[0:3], v[96:99], v[16:19], a[0:3]
ds_read_b128 v[120:123], v160 offset:3072
v_mfma_f32_16x16x32_bf16 a[0:3], v[100:103], v[24:27], a[0:3]
ds_read_b128 v[124:127], v160 offset:13312
s_waitcnt lgkmcnt(4)
v_mfma_f32_16x16x32_bf16 a[4:7], v[96:99], v[20:23], a[4:7]
buffer_load_dwordx4 v162, s[12:15], s39 offen offset:3072 sc1 lds
v_mfma_f32_16x16x32_bf16 a[4:7], v[100:103], v[28:31], a[4:7]
v_mfma_f32_16x16x32_bf16 a[12:15], v[104:107], v[20:23], a[12:15]
ds_read_b128 v[96:99], v160 offset:4096
s_add_u32 m0, s40, 45056
v_mfma_f32_16x16x32_bf16 a[12:15], v[108:111], v[28:31], a[12:15]
ds_read_b128 v[100:103], v160 offset:14336
s_waitcnt lgkmcnt(4)
v_mfma_f32_16x16x32_bf16 a[8:11], v[104:107], v[16:19], a[8:11]
buffer_load_dwordx4 v[64:67], v253, s[16:19], s58 offen offset:0 sc1
v_mfma_f32_16x16x32_bf16 a[8:11], v[108:111], v[24:27], a[8:11]
v_mfma_f32_16x16x32_bf16 a[16:19], v[112:115], v[16:19], a[16:19]
ds_read_b128 v[104:107], v160 offset:5120
v_mfma_f32_16x16x32_bf16 a[16:19], v[116:119], v[24:27], a[16:19]
ds_read_b128 v[108:111], v160 offset:15360
s_waitcnt lgkmcnt(4)
v_mfma_f32_16x16x32_bf16 a[20:23], v[112:115], v[20:23], a[20:23]
v_mfma_f32_16x16x32_bf16 a[20:23], v[116:119], v[28:31], a[20:23]
buffer_load_dwordx4 v163, s[12:15], s39 offen offset:0 sc1 lds
v_mfma_f32_16x16x32_bf16 a[28:31], v[120:123], v[20:23], a[28:31]
ds_read_b128 v[112:115], v160 offset:6144
s_add_u32 s39, s39, 20480
v_mfma_f32_16x16x32_bf16 a[28:31], v[124:127], v[28:31], a[28:31]
ds_read_b128 v[116:119], v160 offset:16384
s_waitcnt lgkmcnt(4)
v_mfma_f32_16x16x32_bf16 a[24:27], v[120:123], v[16:19], a[24:27]
v_mfma_f32_16x16x32_bf16 a[24:27], v[124:127], v[24:27], a[24:27]
buffer_load_dwordx4 v[68:71], v253, s[16:19], s58 offen offset:1024 sc1
v_mfma_f32_16x16x32_bf16 a[32:35], v[96:99], v[16:19], a[32:35]
ds_read_b128 v[120:123], v160 offset:7168
v_mfma_f32_16x16x32_bf16 a[32:35], v[100:103], v[24:27], a[32:35]
ds_read_b128 v[124:127], v160 offset:17408
s_waitcnt lgkmcnt(4)
v_mfma_f32_16x16x32_bf16 a[36:39], v[96:99], v[20:23], a[36:39]
v_mfma_f32_16x16x32_bf16 a[36:39], v[100:103], v[28:31], a[36:39]
buffer_load_dwordx4 v[72:75], v253, s[16:19], s59 offen offset:0 sc1
v_mfma_f32_16x16x32_bf16 a[44:47], v[104:107], v[20:23], a[44:47]
ds_read_b128 v[96:99], v160 offset:8192
v_mfma_f32_16x16x32_bf16 a[44:47], v[108:111], v[28:31], a[44:47]
ds_read_b128 v[100:103], v160 offset:18432
s_waitcnt lgkmcnt(4)
v_mfma_f32_16x16x32_bf16 a[40:43], v[104:107], v[16:19], a[40:43]
v_mfma_f32_16x16x32_bf16 a[40:43], v[108:111], v[24:27], a[40:43]
buffer_load_dwordx4 v[76:79], v253, s[16:19], s59 offen offset:1024 sc1
v_mfma_f32_16x16x32_bf16 a[48:51], v[112:115], v[16:19], a[48:51]
ds_read_b128 v[104:107], v160 offset:9216
s_mov_b32 s58, s49
v_mfma_f32_16x16x32_bf16 a[48:51], v[116:119], v[24:27], a[48:51]
ds_read_b128 v[108:111], v160 offset:19456
s_waitcnt lgkmcnt(4)
v_mfma_f32_16x16x32_bf16 a[52:55], v[112:115], v[20:23], a[52:55]
s_cmp_eq_u32 s57, 0
v_mfma_f32_16x16x32_bf16 a[52:55], v[116:119], v[28:31], a[52:55]
s_cbranch_scc1 F_US0
s_waitcnt vmcnt(12)
F_UB0:
s_barrier
v_mfma_f32_16x16x32_bf16 a[60:63], v[120:123], v[20:23], a[60:63]
ds_read_b128 v[112:115], v160 offset:20480
s_add_u32 m0, s40, 61440
v_mfma_f32_16x16x32_bf16 a[60:63], v[124:127], v[28:31], a[60:63]
ds_read_b128 v[116:119], v160 offset:30720
s_waitcnt lgkmcnt(4)
v_mfma_f32_16x16x32_bf16 a[56:59], v[120:123], v[16:19], a[56:59]
buffer_load_dwordx4 v162, s[12:15], s39 offen offset:0 sc1 lds
v_mfma_f32_16x16x32_bf16 a[56:59], v[124:127], v[24:27], a[56:59]
v_subrev_u32 v166, s84, v166
v_subrev_u32 v166, 3, v166
v_mfma_f32_16x16x32_bf16 a[64:67], v[96:99], v[16:19], a[64:67]
ds_read_b128 v[120:123], v160 offset:21504
s_add_u32 s59, s49, 4096
v_mfma_f32_16x16x32_bf16 a[64:67], v[100:103], v[24:27], a[64:67]
ds_read_b128 v[124:127], v160 offset:31744
s_waitcnt lgkmcnt(4)
v_mfma_f32_16x16x32_bf16 a[68:71], v[96:99], v[20:23], a[68:71]
buffer_load_dwordx4 v162, s[12:15], s39 offen offset:1024 sc1 lds
v_mfma_f32_16x16x32_bf16 a[68:71], v[100:103], v[28:31], a[68:71]
v_cmp_lt_u32 vcc, 1, v166
v_mfma_f32_16x16x32_bf16 a[76:79], v[104:107], v[20:23], a[76:79]
ds_read_b128 v[96:99], v160 offset:22528
v_mfma_f32_16x16x32_bf16 a[76:79], v[108:111], v[28:31], a[76:79]
ds_read_b128 v[100:103], v160 offset:32768
s_waitcnt lgkmcnt(4)
v_mfma_f32_16x16x32_bf16 a[72:75], v[104:107], v[16:19], a[72:75]
buffer_load_dwordx4 v162, s[12:15], s39 offen offset:2048 sc1 lds
v_mfma_f32_16x16x32_bf16 a[72:75], v[108:111], v[24:27], a[72:75]
s_cbranch_vccnz F_TSP
F_TSB:
v_mfma_f32_16x16x32_bf16 a[0:3], v[112:115], v[32:35], a[0:3]
ds_read_b128 v[104:107], v160 offset:23552
v_mfma_f32_16x16x32_bf16 a[0:3], v[116:119], v[40:43], a[0:3]
ds_read_b128 v[108:111], v160 offset:33792
s_waitcnt lgkmcnt(4)
v_mfma_f32_16x16x32_bf16 a[4:7], v[112:115], v[36:39], a[4:7]
buffer_load_dwordx4 v162, s[12:15], s39 offen offset:3072 sc1 lds
v_mfma_f32_16x16x32_bf16 a[4:7], v[116:119], v[44:47], a[4:7]
v_mfma_f32_16x16x32_bf16 a[12:15], v[120:123], v[36:39], a[12:15]
ds_read_b128 v[112:115], v160 offset:24576
s_add_u32 m0, s40, 65536
v_mfma_f32_16x16x32_bf16 a[12:15], v[124:127], v[44:47], a[12:15]
ds_read_b128 v[116:119], v160 offset:34816
s_waitcnt lgkmcnt(4)
v_mfma_f32_16x16x32_bf16 a[8:11], v[120:123], v[32:35], a[8:11]
buffer_load_dwordx4 v[16:19], v253, s[16:19], s58 offen offset:0 sc1
v_mfma_f32_16x16x32_bf16 a[8:11], v[124:127], v[40:43], a[8:11]
v_mfma_f32_16x16x32_bf16 a[16:19], v[96:99], v[32:35], a[16:19]
ds_read_b128 v[120:123], v160 offset:25600
v_mfma_f32_16x16x32_bf16 a[16:19], v[100:103], v[40:43], a[16:19]
ds_read_b128 v[124:127], v160 offset:35840
s_waitcnt lgkmcnt(4)
v_mfma_f32_16x16x32_bf16 a[20:23], v[96:99], v[36:39], a[20:23]
v_mfma_f32_16x16x32_bf16 a[20:23], v[100:103], v[44:47], a[20:23]
buffer_load_dwordx4 v163, s[12:15], s39 offen offset:0 sc1 lds
v_mfma_f32_16x16x32_bf16 a[28:31], v[104:107], v[36:39], a[28:31]
ds_read_b128 v[96:99], v160 offset:26624
s_mov_b32 s39, s53
v_mfma_f32_16x16x32_bf16 a[28:31], v[108:111], v[44:47], a[28:31]
ds_read_b128 v[100:103], v160 offset:36864
s_waitcnt lgkmcnt(4)
v_mfma_f32_16x16x32_bf16 a[24:27], v[104:107], v[32:35], a[24:27]
v_mfma_f32_16x16x32_bf16 a[24:27], v[108:111], v[40:43], a[24:27]
buffer_load_dwordx4 v[20:23], v253, s[16:19], s58 offen offset:1024 sc1
v_mfma_f32_16x16x32_bf16 a[32:35], v[112:115], v[32:35], a[32:35]
ds_read_b128 v[104:107], v160 offset:27648
v_mfma_f32_16x16x32_bf16 a[32:35], v[116:119], v[40:43], a[32:35]
ds_read_b128 v[108:111], v160 offset:37888
s_waitcnt lgkmcnt(4)
v_mfma_f32_16x16x32_bf16 a[36:39], v[112:115], v[36:39], a[36:39]
v_mfma_f32_16x16x32_bf16 a[36:39], v[116:119], v[44:47], a[36:39]
buffer_load_dwordx4 v[24:27], v253, s[16:19], s59 offen offset:0 sc1
v_mfma_f32_16x16x32_bf16 a[44:47], v[120:123], v[36:39], a[44:47]
ds_read_b128 v[112:115], v160 offset:28672
v_mfma_f32_16x16x32_bf16 a[44:47], v[124:127], v[44:47], a[44:47]
ds_read_b128 v[116:119], v160 offset:38912
s_waitcnt lgkmcnt(4)
v_mfma_f32_16x16x32_bf16 a[40:43], v[120:123], v[32:35], a[40:43]
v_mfma_f32_16x16x32_bf16 a[40:43], v[124:127], v[40:43], a[40:43]
buffer_load_dwordx4 v[28:31], v253, s[16:19], s59 offen offset:1024 sc1
v_mfma_f32_16x16x32_bf16 a[48:51], v[96:99], v[32:35], a[48:51]
ds_read_b128 v[120:123], v160 offset:29696
s_add_u32 s58, s58, 8192
v_mfma_f32_16x16x32_bf16 a[48:51], v[100:103], v[40:43], a[48:51]
ds_read_b128 v[124:127], v160 offset:39936
s_waitcnt lgkmcnt(4)
v_mfma_f32_16x16x32_bf16 a[52:55], v[96:99], v[36:39], a[52:55]
v_mfma_f32_16x16x32_bf16 a[52:55], v[100:103], v[44:47], a[52:55]
s_waitcnt vmcnt(12)
s_barrier
v_mfma_f32_16x16x32_bf16 a[60:63], v[104:107], v[36:39], a[60:63]
ds_read_b128 v[96:99], v160 offset:40960
s_add_u32 m0, s40, 0
v_mfma_f32_16x16x32_bf16 a[60:63], v[108:111], v[44:47], a[60:63]
ds_read_b128 v[100:103], v160 offset:51200
s_waitcnt lgkmcnt(4)
v_mfma_f32_16x16x32_bf16 a[56:59], v[104:107], v[32:35], a[56:59]
buffer_load_dwordx4 v162, s[12:15], s39 offen offset:0 sc1 lds
v_mfma_f32_16x16x32_bf16 a[56:59], v[108:111], v[40:43], a[56:59]
v_mfma_f32_16x16x32_bf16 a[64:67], v[112:115], v[32:35], a[64:67]
ds_read_b128 v[104:107], v160 offset:41984
s_add_u32 s59, s59, 8192
v_mfma_f32_16x16x32_bf16 a[64:67], v[116:119], v[40:43], a[64:67]
ds_read_b128 v[108:111], v160 offset:52224
s_waitcnt lgkmcnt(4)
v_mfma_f32_16x16x32_bf16 a[68:71], v[112:115], v[36:39], a[68:71]
buffer_load_dwordx4 v162, s[12:15], s39 offen offset:1024 sc1 lds
v_mfma_f32_16x16x32_bf16 a[68:71], v[116:119], v[44:47], a[68:71]
v_mfma_f32_16x16x32_bf16 a[76:79], v[120:123], v[36:39], a[76:79]
ds_read_b128 v[112:115], v160 offset:43008
v_mfma_f32_16x16x32_bf16 a[76:79], v[124:127], v[44:47], a[76:79]
ds_read_b128 v[116:119], v160 offset:53248
s_waitcnt lgkmcnt(4)
v_mfma_f32_16x16x32_bf16 a[72:75], v[120:123], v[32:35], a[72:75]
buffer_load_dwordx4 v162, s[12:15], s39 offen offset:2048 sc1 lds
v_mfma_f32_16x16x32_bf16 a[72:75], v[124:127], v[40:43], a[72:75]
v_mfma_f32_16x16x32_bf16 a[0:3], v[96:99], v[48:51], a[0:3]
ds_read_b128 v[120:123], v160 offset:44032
s_lshr_b64 s[50:51], s[50:51], 5
v_mfma_f32_16x16x32_bf16 a[0:3], v[100:103], v[56:59], a[0:3]
ds_read_b128 v[124:127], v160 offset:54272
s_waitcnt lgkmcnt(4)
v_mfma_f32_16x16x32_bf16 a[4:7], v[96:99], v[52:55], a[4:7]
buffer_load_dwordx4 v162, s[12:15], s39 offen offset:3072 sc1 lds
v_mfma_f32_16x16x32_bf16 a[4:7], v[100:103], v[60:63], a[4:7]
s_and_b32 s45, s50, 7
s_lshl_b32 s45, s45, 2
v_mfma_f32_16x16x32_bf16 a[12:15], v[104:107], v[52:55], a[12:15]
ds_read_b128 v[96:99], v160 offset:45056
s_add_u32 m0, s40, 4096
v_mfma_f32_16x16x32_bf16 a[12:15], v[108:111], v[60:63], a[12:15]
ds_read_b128 v[100:103], v160 offset:55296
s_waitcnt lgkmcnt(4)
v_mfma_f32_16x16x32_bf16 a[8:11], v[104:107], v[48:51], a[8:11]
buffer_load_dwordx4 v[32:35], v253, s[16:19], s58 offen offset:0 sc1
v_mfma_f32_16x16x32_bf16 a[8:11], v[108:111], v[56:59], a[8:11]
s_lshr_b32 s45, s52, s45
s_and_b32 s45, s45, 15
v_mfma_f32_16x16x32_bf16 a[16:19], v[112:115], v[48:51], a[16:19]
ds_read_b128 v[104:107], v160 offset:46080
s_bfe_u32 s43, s50, 0x20003
v_mfma_f32_16x16x32_bf16 a[16:19], v[116:119], v[56:59], a[16:19]
ds_read_b128 v[108:111], v160 offset:56320
s_waitcnt lgkmcnt(4)
v_mfma_f32_16x16x32_bf16 a[20:23], v[112:115], v[52:55], a[20:23]
s_mul_i32 s47, s45, s60
s_add_u32 s47, s47, s62
v_mfma_f32_16x16x32_bf16 a[20:23], v[116:119], v[60:63], a[20:23]
buffer_load_dwordx4 v163, s[12:15], s39 offen offset:0 sc1 lds
v_mfma_f32_16x16x32_bf16 a[28:31], v[120:123], v[52:55], a[28:31]
ds_read_b128 v[112:115], v160 offset:47104
s_add_u32 s39, s39, 20480
v_mfma_f32_16x16x32_bf16 a[28:31], v[124:127], v[60:63], a[28:31]
ds_read_b128 v[116:119], v160 offset:57344
s_waitcnt lgkmcnt(4)
v_mfma_f32_16x16x32_bf16 a[24:27], v[120:123], v[48:51], a[24:27]
s_mul_i32 s45, s45, 3
s_add_u32 s45, s45, s43
v_mfma_f32_16x16x32_bf16 a[24:27], v[124:127], v[56:59], a[24:27]
buffer_load_dwordx4 v[36:39], v253, s[16:19], s58 offen offset:1024 sc1
v_mfma_f32_16x16x32_bf16 a[32:35], v[96:99], v[48:51], a[32:35]
ds_read_b128 v[120:123], v160 offset:48128
s_mul_i32 s53, s45, 81920
v_mfma_f32_16x16x32_bf16 a[32:35], v[100:103], v[56:59], a[32:35]
ds_read_b128 v[124:127], v160 offset:58368
s_waitcnt lgkmcnt(4)
v_mfma_f32_16x16x32_bf16 a[36:39], v[96:99], v[52:55], a[36:39]
s_lshl_b32 s49, s45, 15
v_mfma_f32_16x16x32_bf16 a[36:39], v[100:103], v[60:63], a[36:39]
buffer_load_dwordx4 v[40:43], v253, s[16:19], s59 offen offset:0 sc1
v_mfma_f32_16x16x32_bf16 a[44:47], v[104:107], v[52:55], a[44:47]
ds_read_b128 v[96:99], v160 offset:49152
v_mfma_f32_16x16x32_bf16 a[44:47], v[108:111], v[60:63], a[44:47]
ds_read_b128 v[100:103], v160 offset:59392
s_waitcnt lgkmcnt(4)
v_mfma_f32_16x16x32_bf16 a[40:43], v[104:107], v[48:51], a[40:43]
v_mfma_f32_16x16x32_bf16 a[40:43], v[108:111], v[56:59], a[40:43]
buffer_load_dwordx4 v[44:47], v253, s[16:19], s59 offen offset:1024 sc1
v_mfma_f32_16x16x32_bf16 a[48:51], v[112:115], v[48:51], a[48:51]
ds_read_b128 v[104:107], v160 offset:50176
s_add_u32 s58, s58, 8192
v_mfma_f32_16x16x32_bf16 a[48:51], v[116:119], v[56:59], a[48:51]
ds_read_b128 v[108:111], v160 offset:60416
s_waitcnt lgkmcnt(4)
v_mfma_f32_16x16x32_bf16 a[52:55], v[112:115], v[52:55], a[52:55]
buffer_load_dword v166, v165, s[80:83], s47 offen sc1
v_mfma_f32_16x16x32_bf16 a[52:55], v[116:119], v[60:63], a[52:55]
s_waitcnt vmcnt(13)
s_barrier
v_mfma_f32_16x16x32_bf16 a[60:63], v[120:123], v[52:55], a[60:63]
ds_read_b128 v[112:115], v161 offset:0
s_add_u32 m0, s40, 20480
v_mfma_f32_16x16x32_bf16 a[60:63], v[124:127], v[60:63], a[60:63]
ds_read_b128 v[116:119], v161 offset:10240
s_waitcnt lgkmcnt(4)
v_mfma_f32_16x16x32_bf16 a[56:59], v[120:123], v[48:51], a[56:59]
buffer_load_dwordx4 v162, s[12:15], s39 offen offset:0 sc1 lds
v_mfma_f32_16x16x32_bf16 a[56:59], v[124:127], v[56:59], a[56:59]
v_mfma_f32_16x16x32_bf16 a[64:67], v[96:99], v[48:51], a[64:67]
ds_read_b128 v[120:123], v161 offset:1024
s_add_u32 s59, s59, 8192
v_mfma_f32_16x16x32_bf16 a[64:67], v[100:103], v[56:59], a[64:67]
ds_read_b128 v[124:127], v161 offset:11264
s_waitcnt lgkmcnt(4)
v_mfma_f32_16x16x32_bf16 a[68:71], v[96:99], v[52:55], a[68:71]
buffer_load_dwordx4 v162, s[12:15], s39 offen offset:1024 sc1 lds
v_mfma_f32_16x16x32_bf16 a[68:71], v[100:103], v[60:63], a[68:71]
v_mfma_f32_16x16x32_bf16 a[76:79], v[104:107], v[52:55], a[76:79]
ds_read_b128 v[96:99], v161 offset:2048
v_mfma_f32_16x16x32_bf16 a[76:79], v[108:111], v[60:63], a[76:79]
ds_read_b128 v[100:103], v161 offset:12288
s_waitcnt lgkmcnt(4)
v_mfma_f32_16x16x32_bf16 a[72:75], v[104:107], v[48:51], a[72:75]
buffer_load_dwordx4 v162, s[12:15], s39 offen offset:2048 sc1 lds
v_mfma_f32_16x16x32_bf16 a[72:75], v[108:111], v[56:59], a[72:75]
v_mfma_f32_16x16x32_bf16 a[0:3], v[112:115], v[64:67], a[0:3]
ds_read_b128 v[104:107], v161 offset:3072
v_mfma_f32_16x16x32_bf16 a[0:3], v[116:119], v[72:75], a[0:3]
ds_read_b128 v[108:111], v161 offset:13312
s_waitcnt lgkmcnt(4)
v_mfma_f32_16x16x32_bf16 a[4:7], v[112:115], v[68:71], a[4:7]
buffer_load_dwordx4 v162, s[12:15], s39 offen offset:3072 sc1 lds
v_mfma_f32_16x16x32_bf16 a[4:7], v[116:119], v[76:79], a[4:7]
v_mfma_f32_16x16x32_bf16 a[12:15], v[120:123], v[68:71], a[12:15]
ds_read_b128 v[112:115], v161 offset:4096
s_add_u32 m0, s40, 24576
v_mfma_f32_16x16x32_bf16 a[12:15], v[124:127], v[76:79], a[12:15]
ds_read_b128 v[116:119], v161 offset:14336
s_waitcnt lgkmcnt(4)
v_mfma_f32_16x16x32_bf16 a[8:11], v[120:123], v[64:67], a[8:11]
buffer_load_dwordx4 v[48:51], v253, s[16:19], s58 offen offset:0 sc1
v_mfma_f32_16x16x32_bf16 a[8:11], v[124:127], v[72:75], a[8:11]
v_mfma_f32_16x16x32_bf16 a[16:19], v[96:99], v[64:67], a[16:19]
ds_read_b128 v[120:123], v161 offset:5120
v_mfma_f32_16x16x32_bf16 a[16:19], v[100:103], v[72:75], a[16:19]
ds_read_b128 v[124:127], v161 offset:15360
s_waitcnt lgkmcnt(4)
v_mfma_f32_16x16x32_bf16 a[20:23], v[96:99], v[68:71], a[20:23]
v_mfma_f32_16x16x32_bf16 a[20:23], v[100:103], v[76:79], a[20:23]
buffer_load_dwordx4 v163, s[12:15], s39 offen offset:0 sc1 lds
v_mfma_f32_16x16x32_bf16 a[28:31], v[104:107], v[68:71], a[28:31]
ds_read_b128 v[96:99], v161 offset:6144
s_add_u32 s39, s39, 20480
v_mfma_f32_16x16x32_bf16 a[28:31], v[108:111], v[76:79], a[28:31]
ds_read_b128 v[100:103], v161 offset:16384
s_waitcnt lgkmcnt(4)
v_mfma_f32_16x16x32_bf16 a[24:27], v[104:107], v[64:67], a[24:27]
v_mfma_f32_16x16x32_bf16 a[24:27], v[108:111], v[72:75], a[24:27]
buffer_load_dwordx4 v[52:55], v253, s[16:19], s58 offen offset:1024 sc1
v_mfma_f32_16x16x32_bf16 a[32:35], v[112:115], v[64:67], a[32:35]
ds_read_b128 v[104:107], v161 offset:7168
v_mfma_f32_16x16x32_bf16 a[32:35], v[116:119], v[72:75], a[32:35]
ds_read_b128 v[108:111], v161 offset:17408
s_waitcnt lgkmcnt(4)
v_mfma_f32_16x16x32_bf16 a[36:39], v[112:115], v[68:71], a[36:39]
v_mfma_f32_16x16x32_bf16 a[36:39], v[116:119], v[76:79], a[36:39]
buffer_load_dwordx4 v[56:59], v253, s[16:19], s59 offen offset:0 sc1
v_mfma_f32_16x16x32_bf16 a[44:47], v[120:123], v[68:71], a[44:47]
ds_read_b128 v[112:115], v161 offset:8192
v_mfma_f32_16x16x32_bf16 a[44:47], v[124:127], v[76:79], a[44:47]
ds_read_b128 v[116:119], v161 offset:18432
s_waitcnt lgkmcnt(4)
v_mfma_f32_16x16x32_bf16 a[40:43], v[120:123], v[64:67], a[40:43]
v_mfma_f32_16x16x32_bf16 a[40:43], v[124:127], v[72:75], a[40:43]
buffer_load_dwordx4 v[60:63], v253, s[16:19], s59 offen offset:1024 sc1
v_mfma_f32_16x16x32_bf16 a[48:51], v[96:99], v[64:67], a[48:51]
ds_read_b128 v[120:123], v161 offset:9216
s_add_u32 s58, s58, 8192
v_mfma_f32_16x16x32_bf16 a[48:51], v[100:103], v[72:75], a[48:51]
ds_read_b128 v[124:127], v161 offset:19456
s_waitcnt lgkmcnt(4)
v_mfma_f32_16x16x32_bf16 a[52:55], v[96:99], v[68:71], a[52:55]
v_mfma_f32_16x16x32_bf16 a[52:55], v[100:103], v[76:79], a[52:55]
s_waitcnt vmcnt(13)
s_barrier
v_mfma_f32_16x16x32_bf16 a[60:63], v[104:107], v[68:71], a[60:63]
ds_read_b128 v[96:99], v160 offset:0
s_add_u32 m0, s40, 40960
v_mfma_f32_16x16x32_bf16 a[60:63], v[108:111], v[76:79], a[60:63]
ds_read_b128 v[100:103], v160 offset:10240
s_waitcnt lgkmcnt(4)
v_mfma_f32_16x16x32_bf16 a[56:59], v[104:107], v[64:67], a[56:59]
buffer_load_dwordx4 v162, s[12:15], s39 offen offset:0 sc1 lds
v_mfma_f32_16x16x32_bf16 a[56:59], v[108:111], v[72:75], a[56:59]
v_mfma_f32_16x16x32_bf16 a[64:67], v[112:115], v[64:67], a[64:67]
ds_read_b128 v[104:107], v160 offset:1024
s_add_u32 s59, s59, 8192
v_mfma_f32_16x16x32_bf16 a[64:67], v[116:119], v[72:75], a[64:67]
ds_read_b128 v[108:111], v160 offset:11264
s_waitcnt lgkmcnt(4)
v_mfma_f32_16x16x32_bf16 a[68:71], v[112:115], v[68:71], a[68:71]
buffer_load_dwordx4 v162, s[12:15], s39 offen offset:1024 sc1 lds
v_mfma_f32_16x16x32_bf16 a[68:71], v[116:119], v[76:79], a[68:71]
v_mfma_f32_16x16x32_bf16 a[76:79], v[120:123], v[68:71], a[76:79]
ds_read_b128 v[112:115], v160 offset:2048
v_mfma_f32_16x16x32_bf16 a[76:79], v[124:127], v[76:79], a[76:79]
ds_read_b128 v[116:119], v160 offset:12288
s_waitcnt lgkmcnt(4)
v_mfma_f32_16x16x32_bf16 a[72:75], v[120:123], v[64:67], a[72:75]
buffer_load_dwordx4 v162, s[12:15], s39 offen offset:2048 sc1 lds
v_mfma_f32_16x16x32_bf16 a[72:75], v[124:127], v[72:75], a[72:75]
s_add_u32 s57, s57, 1
s_cmp_lt_u32 s57, s46
s_cbranch_scc1 F_TLS
v_mfma_f32_16x16x32_bf16 a[0:3], v[96:99], v[16:19], a[0:3]
ds_read_b128 v[120:123], v160 offset:3072
v_mfma_f32_16x16x32_bf16 a[0:3], v[100:103], v[24:27], a[0:3]
ds_read_b128 v[124:127], v160 offset:13312
s_waitcnt lgkmcnt(4)
v_mfma_f32_16x16x32_bf16 a[4:7], v[96:99], v[20:23], a[4:7]
buffer_load_dwordx4 v162, s[12:15], s39 offen offset:3072 sc1 lds
v_mfma_f32_16x16x32_bf16 a[4:7], v[100:103], v[28:31], a[4:7]
v_mfma_f32_16x16x32_bf16 a[12:15], v[104:107], v[20:23], a[12:15]
ds_read_b128 v[96:99], v160 offset:4096
s_add_u32 m0, s40, 45056
v_mfma_f32_16x16x32_bf16 a[12:15], v[108:111], v[28:31], a[12:15]
ds_read_b128 v[100:103], v160 offset:14336
s_waitcnt lgkmcnt(4)
v_mfma_f32_16x16x32_bf16 a[8:11], v[104:107], v[16:19], a[8:11]
buffer_load_dwordx4 v[64:67], v253, s[16:19], s58 offen offset:0 sc1
v_mfma_f32_16x16x32_bf16 a[8:11], v[108:111], v[24:27], a[8:11]
v_mfma_f32_16x16x32_bf16 a[16:19], v[112:115], v[16:19], a[16:19]
ds_read_b128 v[104:107], v160 offset:5120
v_mfma_f32_16x16x32_bf16 a[16:19], v[116:119], v[24:27], a[16:19]
ds_read_b128 v[108:111], v160 offset:15360
s_waitcnt lgkmcnt(4)
v_mfma_f32_16x16x32_bf16 a[20:23], v[112:115], v[20:23], a[20:23]
v_mfma_f32_16x16x32_bf16 a[20:23], v[116:119], v[28:31], a[20:23]
buffer_load_dwordx4 v163, s[12:15], s39 offen offset:0 sc1 lds
v_mfma_f32_16x16x32_bf16 a[28:31], v[120:123], v[20:23], a[28:31]
ds_read_b128 v[112:115], v160 offset:6144
s_add_u32 s39, s39, 20480
v_mfma_f32_16x16x32_bf16 a[28:31], v[124:127], v[28:31], a[28:31]
ds_read_b128 v[116:119], v160 offset:16384
s_waitcnt lgkmcnt(4)
v_mfma_f32_16x16x32_bf16 a[24:27], v[120:123], v[16:19], a[24:27]
v_mfma_f32_16x16x32_bf16 a[24:27], v[124:127], v[24:27], a[24:27]
buffer_load_dwordx4 v[68:71], v253, s[16:19], s58 offen offset:1024 sc1
v_mfma_f32_16x16x32_bf16 a[32:35], v[96:99], v[16:19], a[32:35]
ds_read_b128 v[120:123], v160 offset:7168
v_mfma_f32_16x16x32_bf16 a[32:35], v[100:103], v[24:27], a[32:35]
ds_read_b128 v[124:127], v160 offset:17408
s_waitcnt lgkmcnt(4)
v_mfma_f32_16x16x32_bf16 a[36:39], v[96:99], v[20:23], a[36:39]
v_mfma_f32_16x16x32_bf16 a[36:39], v[100:103], v[28:31], a[36:39]
buffer_load_dwordx4 v[72:75], v253, s[16:19], s59 offen offset:0 sc1
v_mfma_f32_16x16x32_bf16 a[44:47], v[104:107], v[20:23], a[44:47]
ds_read_b128 v[96:99], v160 offset:8192
v_mfma_f32_16x16x32_bf16 a[44:47], v[108:111], v[28:31], a[44:47]
ds_read_b128 v[100:103], v160 offset:18432
s_waitcnt lgkmcnt(4)
v_mfma_f32_16x16x32_bf16 a[40:43], v[104:107], v[16:19], a[40:43]
v_mfma_f32_16x16x32_bf16 a[40:43], v[108:111], v[24:27], a[40:43]
buffer_load_dwordx4 v[76:79], v253, s[16:19], s59 offen offset:1024 sc1
v_mfma_f32_16x16x32_bf16 a[48:51], v[112:115], v[16:19], a[48:51]
ds_read_b128 v[104:107], v160 offset:9216
s_add_u32 s58, s58, 8192
v_mfma_f32_16x16x32_bf16 a[48:51], v[116:119], v[24:27], a[48:51]
ds_read_b128 v[108:111], v160 offset:19456
s_waitcnt lgkmcnt(4)
v_mfma_f32_16x16x32_bf16 a[52:55], v[112:115], v[20:23], a[52:55]
v_mfma_f32_16x16x32_bf16 a[52:55], v[116:119], v[28:31], a[52:55]
s_waitcnt vmcnt(12)
s_barrier
v_mfma_f32_16x16x32_bf16 a[60:63], v[120:123], v[20:23], a[60:63]
ds_read_b128 v[112:115], v160 offset:20480
s_add_u32 m0, s40, 61440
v_mfma_f32_16x16x32_bf16 a[60:63], v[124:127], v[28:31], a[60:63]
ds_read_b128 v[116:119], v160 offset:30720
s_waitcnt lgkmcnt(4)
v_mfma_f32_16x16x32_bf16 a[56:59], v[120:123], v[16:19], a[56:59]
buffer_load_dwordx4 v162, s[12:15], s39 offen offset:0 sc1 lds
v_mfma_f32_16x16x32_bf16 a[56:59], v[124:127], v[24:27], a[56:59]
v_mfma_f32_16x16x32_bf16 a[64:67], v[96:99], v[16:19], a[64:67]
ds_read_b128 v[120:123], v160 offset:21504
s_add_u32 s59, s59, 8192
v_mfma_f32_16x16x32_bf16 a[64:67], v[100:103], v[24:27], a[64:67]
ds_read_b128 v[124:127], v160 offset:31744
s_waitcnt lgkmcnt(4)
v_mfma_f32_16x16x32_bf16 a[68:71], v[96:99], v[20:23], a[68:71]
buffer_load_dwordx4 v162, s[12:15], s39 offen offset:1024 sc1 lds
v_mfma_f32_16x16x32_bf16 a[68:71], v[100:103], v[28:31], a[68:71]
v_mfma_f32_16x16x32_bf16 a[76:79], v[104:107], v[20:23], a[76:79]
ds_read_b128 v[96:99], v160 offset:22528
v_mfma_f32_16x16x32_bf16 a[76:79], v[108:111], v[28:31], a[76:79]
ds_read_b128 v[100:103], v160 offset:32768
s_waitcnt lgkmcnt(4)
v_mfma_f32_16x16x32_bf16 a[72:75], v[104:107], v[16:19], a[72:75]
buffer_load_dwordx4 v162, s[12:15], s39 offen offset:2048 sc1 lds
buffer_load_dwordx4 v162, s[12:15], s39 offen offset:3072 sc1 lds
v_mfma_f32_16x16x32_bf16 a[72:75], v[108:111], v[24:27], a[72:75]
s_add_u32 m0, s40, 65536
s_nop 0
buffer_load_dwordx4 v163, s[12:15], s39 offen offset:0 sc1 lds
v_mfma_f32_16x16x32_bf16 a[0:3], v[112:115], v[32:35], a[0:3]
ds_read_b128 v[104:107], v160 offset:23552
v_mfma_f32_16x16x32_bf16 a[0:3], v[116:119], v[40:43], a[0:3]
ds_read_b128 v[108:111], v160 offset:33792
s_waitcnt lgkmcnt(4)
v_mfma_f32_16x16x32_bf16 a[4:7], v[112:115], v[36:39], a[4:7]
v_mfma_f32_16x16x32_bf16 a[4:7], v[116:119], v[44:47], a[4:7]
v_mfma_f32_16x16x32_bf16 a[12:15], v[120:123], v[36:39], a[12:15]
ds_read_b128 v[112:115], v160 offset:24576
v_mfma_f32_16x16x32_bf16 a[12:15], v[124:127], v[44:47], a[12:15]
ds_read_b128 v[116:119], v160 offset:34816
s_waitcnt lgkmcnt(4)
v_mfma_f32_16x16x32_bf16 a[8:11], v[120:123], v[32:35], a[8:11]
v_mfma_f32_16x16x32_bf16 a[8:11], v[124:127], v[40:43], a[8:11]
v_mfma_f32_16x16x32_bf16 a[16:19], v[96:99], v[32:35], a[16:19]
ds_read_b128 v[120:123], v160 offset:25600
v_mfma_f32_16x16x32_bf16 a[16:19], v[100:103], v[40:43], a[16:19]
ds_read_b128 v[124:127], v160 offset:35840
s_waitcnt lgkmcnt(4)
v_mfma_f32_16x16x32_bf16 a[20:23], v[96:99], v[36:39], a[20:23]
v_mfma_f32_16x16x32_bf16 a[20:23], v[100:103], v[44:47], a[20:23]
v_mfma_f32_16x16x32_bf16 a[28:31], v[104:107], v[36:39], a[28:31]
ds_read_b128 v[96:99], v160 offset:26624
v_mfma_f32_16x16x32_bf16 a[28:31], v[108:111], v[44:47], a[28:31]
ds_read_b128 v[100:103], v160 offset:36864
s_waitcnt lgkmcnt(4)
v_mfma_f32_16x16x32_bf16 a[24:27], v[104:107], v[32:35], a[24:27]
v_mfma_f32_16x16x32_bf16 a[24:27], v[108:111], v[40:43], a[24:27]
v_mfma_f32_16x16x32_bf16 a[32:35], v[112:115], v[32:35], a[32:35]
ds_read_b128 v[104:107], v160 offset:27648
v_mfma_f32_16x16x32_bf16 a[32:35], v[116:119], v[40:43], a[32:35]
ds_read_b128 v[108:111], v160 offset:37888
s_waitcnt lgkmcnt(4)
v_mfma_f32_16x16x32_bf16 a[36:39], v[112:115], v[36:39], a[36:39]
v_mfma_f32_16x16x32_bf16 a[36:39], v[116:119], v[44:47], a[36:39]
v_mfma_f32_16x16x32_bf16 a[44:47], v[120:123], v[36:39], a[44:47]
ds_read_b128 v[112:115], v160 offset:28672
v_mfma_f32_16x16x32_bf16 a[44:47], v[124:127], v[44:47], a[44:47]
ds_read_b128 v[116:119], v160 offset:38912
s_waitcnt lgkmcnt(4)
v_mfma_f32_16x16x32_bf16 a[40:43], v[120:123], v[32:35], a[40:43]
v_mfma_f32_16x16x32_bf16 a[40:43], v[124:127], v[40:43], a[40:43]
v_mfma_f32_16x16x32_bf16 a[48:51], v[96:99], v[32:35], a[48:51]
ds_read_b128 v[120:123], v160 offset:29696
v_mfma_f32_16x16x32_bf16 a[48:51], v[100:103], v[40:43], a[48:51]
ds_read_b128 v[124:127], v160 offset:39936
s_waitcnt lgkmcnt(4)
v_mfma_f32_16x16x32_bf16 a[52:55], v[96:99], v[36:39], a[52:55]
v_mfma_f32_16x16x32_bf16 a[52:55], v[100:103], v[44:47], a[52:55]
v_mfma_f32_16x16x32_bf16 a[60:63], v[104:107], v[36:39], a[60:63]
v_mfma_f32_16x16x32_bf16 a[60:63], v[108:111], v[44:47], a[60:63]
s_waitcnt lgkmcnt(0)
v_mfma_f32_16x16x32_bf16 a[56:59], v[104:107], v[32:35], a[56:59]
v_mfma_f32_16x16x32_bf16 a[56:59], v[108:111], v[40:43], a[56:59]
v_mfma_f32_16x16x32_bf16 a[64:67], v[112:115], v[32:35], a[64:67]
v_mfma_f32_16x16x32_bf16 a[64:67], v[116:119], v[40:43], a[64:67]
s_waitcnt lgkmcnt(0)
v_mfma_f32_16x16x32_bf16 a[68:71], v[112:115], v[36:39], a[68:71]
v_mfma_f32_16x16x32_bf16 a[68:71], v[116:119], v[44:47], a[68:71]
v_mfma_f32_16x16x32_bf16 a[76:79], v[120:123], v[36:39], a[76:79]
v_mfma_f32_16x16x32_bf16 a[76:79], v[124:127], v[44:47], a[76:79]
s_waitcnt lgkmcnt(0)
v_mfma_f32_16x16x32_bf16 a[72:75], v[120:123], v[32:35], a[72:75]
v_mfma_f32_16x16x32_bf16 a[72:75], v[124:127], v[40:43], a[72:75]
s_waitcnt vmcnt(0)
s_barrier
ds_read_b128 v[96:99], v160 offset:40960
ds_read_b128 v[100:103], v160 offset:51200
ds_read_b128 v[104:107], v161 offset:0
ds_read_b128 v[108:111], v161 offset:10240
ds_read_b128 v[112:115], v160 offset:41984
ds_read_b128 v[116:119], v160 offset:52224
ds_read_b128 v[120:123], v161 offset:1024
ds_read_b128 v[124:127], v161 offset:11264
s_lshl_b32 s41, s36, 2
s_add_u32 s41, s41, s54
s_mul_i32 s41, s41, 20480
s_cmp_eq_u32 s36, s54
s_cselect_b32 s41, 0x10000000, s41
s_waitcnt lgkmcnt(4)
v_mfma_f32_16x16x32_bf16 a[0:3], v[96:99], v[48:51], a[0:3]
ds_read_b128 v[128:131], v160 offset:43008
v_mfma_f32_16x16x32_bf16 a[0:3], v[100:103], v[56:59], a[0:3]
ds_read_b128 v[132:135], v160 offset:53248
v_mfma_f32_16x16x32_bf16 a[0:3], v[104:107], v[64:67], a[0:3]
ds_read_b128 v[136:139], v161 offset:2048
v_mfma_f32_16x16x32_bf16 a[0:3], v[108:111], v[72:75], a[0:3]
ds_read_b128 v[140:143], v161 offset:12288
s_waitcnt lgkmcnt(4)
v_mfma_f32_16x16x32_bf16 a[4:7], v[108:111], v[76:79], a[4:7]
v_mfma_f32_16x16x32_bf16 a[4:7], v[104:107], v[68:71], a[4:7]
v_mfma_f32_16x16x32_bf16 a[4:7], v[100:103], v[60:63], a[4:7]
v_mfma_f32_16x16x32_bf16 a[4:7], v[96:99], v[52:55], a[4:7]
v_mfma_f32_16x16x32_bf16 a[8:11], v[112:115], v[48:51], a[8:11]
ds_read_b128 v[144:147], v160 offset:44032
v_mfma_f32_16x16x32_bf16 a[8:11], v[116:119], v[56:59], a[8:11]
ds_read_b128 v[148:151], v160 offset:54272
s_add_u32 s42, s41, 0
v_mfma_f32_16x16x32_bf16 a[8:11], v[120:123], v[64:67], a[8:11]
ds_read_b128 v[152:155], v161 offset:3072
s_add_u32 s43, s41, 10240
v_mfma_f32_16x16x32_bf16 a[8:11], v[124:127], v[72:75], a[8:11]
ds_read_b128 v[156:159], v161 offset:13312
s_waitcnt lgkmcnt(4)
v_mfma_f32_16x16x32_bf16 a[12:15], v[124:127], v[76:79], a[12:15]
buffer_store_dwordx4 a[0:3], v253, s[20:23], s42 offen sc1
v_mfma_f32_16x16x32_bf16 a[12:15], v[120:123], v[68:71], a[12:15]
v_mfma_f32_16x16x32_bf16 a[12:15], v[116:119], v[60:63], a[12:15]
buffer_store_dwordx4 a[4:7], v253, s[20:23], s43 offen sc1
v_mfma_f32_16x16x32_bf16 a[12:15], v[112:115], v[52:55], a[12:15]
v_mfma_f32_16x16x32_bf16 a[16:19], v[128:131], v[48:51], a[16:19]
ds_read_b128 v[96:99], v160 offset:45056
v_mfma_f32_16x16x32_bf16 a[16:19], v[132:135], v[56:59], a[16:19]
ds_read_b128 v[100:103], v160 offset:55296
s_add_u32 s42, s41, 1024
v_mfma_f32_16x16x32_bf16 a[16:19], v[136:139], v[64:67], a[16:19]
ds_read_b128 v[104:107], v161 offset:4096
s_add_u32 s43, s41, 11264
v_mfma_f32_16x16x32_bf16 a[16:19], v[140:143], v[72:75], a[16:19]
ds_read_b128 v[108:111], v161 offset:14336
s_waitcnt lgkmcnt(4)
v_mfma_f32_16x16x32_bf16 a[20:23], v[140:143], v[76:79], a[20:23]
buffer_store_dwordx4 a[8:11], v253, s[20:23], s42 offen sc1
v_mfma_f32_16x16x32_bf16 a[20:23], v[136:139], v[68:71], a[20:23]
v_mfma_f32_16x16x32_bf16 a[20:23], v[132:135], v[60:63], a[20:23]
buffer_store_dwordx4 a[12:15], v253, s[20:23], s43 offen sc1
v_mfma_f32_16x16x32_bf16 a[20:23], v[128:131], v[52:55], a[20:23]
v_mfma_f32_16x16x32_bf16 a[24:27], v[144:147], v[48:51], a[24:27]
ds_read_b128 v[112:115], v160 offset:46080
v_mfma_f32_16x16x32_bf16 a[24:27], v[148:151], v[56:59], a[24:27]
ds_read_b128 v[116:119], v160 offset:56320
s_add_u32 s42, s41, 2048
v_mfma_f32_16x16x32_bf16 a[24:27], v[152:155], v[64:67], a[24:27]
ds_read_b128 v[120:123], v161 offset:5120
s_add_u32 s43, s41, 12288
v_mfma_f32_16x16x32_bf16 a[24:27], v[156:159], v[72:75], a[24:27]
ds_read_b128 v[124:127], v161 offset:15360
s_waitcnt lgkmcnt(4)
v_mfma_f32_16x16x32_bf16 a[28:31], v[156:159], v[76:79], a[28:31]
buffer_store_dwordx4 a[16:19], v253, s[20:23], s42 offen sc1
v_mfma_f32_16x16x32_bf16 a[28:31], v[152:155], v[68:71], a[28:31]
v_mfma_f32_16x16x32_bf16 a[28:31], v[148:151], v[60:63], a[28:31]
buffer_store_dwordx4 a[20:23], v253, s[20:23], s43 offen sc1
v_mfma_f32_16x16x32_bf16 a[28:31], v[144:147], v[52:55], a[28:31]
v_mfma_f32_16x16x32_bf16 a[32:35], v[96:99], v[48:51], a[32:35]
ds_read_b128 v[128:131], v160 offset:47104
v_mfma_f32_16x16x32_bf16 a[32:35], v[100:103], v[56:59], a[32:35]
ds_read_b128 v[132:135], v160 offset:57344
s_add_u32 s42, s41, 3072
v_mfma_f32_16x16x32_bf16 a[32:35], v[104:107], v[64:67], a[32:35]
ds_read_b128 v[136:139], v161 offset:6144
s_add_u32 s43, s41, 13312
v_mfma_f32_16x16x32_bf16 a[32:35], v[108:111], v[72:75], a[32:35]
ds_read_b128 v[140:143], v161 offset:16384
s_waitcnt lgkmcnt(4)
v_mfma_f32_16x16x32_bf16 a[36:39], v[108:111], v[76:79], a[36:39]
buffer_store_dwordx4 a[24:27], v253, s[20:23], s42 offen sc1
v_mfma_f32_16x16x32_bf16 a[36:39], v[104:107], v[68:71], a[36:39]
v_mfma_f32_16x16x32_bf16 a[36:39], v[100:103], v[60:63], a[36:39]
buffer_store_dwordx4 a[28:31], v253, s[20:23], s43 offen sc1
v_mfma_f32_16x16x32_bf16 a[36:39], v[96:99], v[52:55], a[36:39]
v_mfma_f32_16x16x32_bf16 a[40:43], v[112:115], v[48:51], a[40:43]
ds_read_b128 v[144:147], v160 offset:48128
v_mfma_f32_16x16x32_bf16 a[40:43], v[116:119], v[56:59], a[40:43]
ds_read_b128 v[148:151], v160 offset:58368
s_add_u32 s42, s41, 4096
v_mfma_f32_16x16x32_bf16 a[40:43], v[120:123], v[64:67], a[40:43]
ds_read_b128 v[152:155], v161 offset:7168
s_add_u32 s43, s41, 14336
v_mfma_f32_16x16x32_bf16 a[40:43], v[124:127], v[72:75], a[40:43]
ds_read_b128 v[156:159], v161 offset:17408
s_waitcnt lgkmcnt(4)
v_mfma_f32_16x16x32_bf16 a[44:47], v[124:127], v[76:79], a[44:47]
buffer_store_dwordx4 a[32:35], v253, s[20:23], s42 offen sc1
v_mfma_f32_16x16x32_bf16 a[44:47], v[120:123], v[68:71], a[44:47]
v_mfma_f32_16x16x32_bf16 a[44:47], v[116:119], v[60:63], a[44:47]
buffer_store_dwordx4 a[36:39], v253, s[20:23], s43 offen sc1
v_mfma_f32_16x16x32_bf16 a[44:47], v[112:115], v[52:55], a[44:47]
v_mfma_f32_16x16x32_bf16 a[48:51], v[128:131], v[48:51], a[48:51]
ds_read_b128 v[96:99], v160 offset:49152
v_mfma_f32_16x16x32_bf16 a[48:51], v[132:135], v[56:59], a[48:51]
ds_read_b128 v[100:103], v160 offset:59392
s_add_u32 s42, s41, 5120
v_mfma_f32_16x16x32_bf16 a[48:51], v[136:139], v[64:67], a[48:51]
ds_read_b128 v[104:107], v161 offset:8192
s_add_u32 s43, s41, 15360
v_mfma_f32_16x16x32_bf16 a[48:51], v[140:143], v[72:75], a[48:51]
ds_read_b128 v[108:111], v161 offset:18432
s_waitcnt lgkmcnt(4)
v_mfma_f32_16x16x32_bf16 a[52:55], v[140:143], v[76:79], a[52:55]
buffer_store_dwordx4 a[40:43], v253, s[20:23], s42 offen sc1
v_mfma_f32_16x16x32_bf16 a[52:55], v[136:139], v[68:71], a[52:55]
v_mfma_f32_16x16x32_bf16 a[52:55], v[132:135], v[60:63], a[52:55]
buffer_store_dwordx4 a[44:47], v253, s[20:23], s43 offen sc1
v_mfma_f32_16x16x32_bf16 a[52:55], v[128:131], v[52:55], a[52:55]
v_mfma_f32_16x16x32_bf16 a[56:59], v[144:147], v[48:51], a[56:59]
ds_read_b128 v[112:115], v160 offset:50176
v_mfma_f32_16x16x32_bf16 a[56:59], v[148:151], v[56:59], a[56:59]
ds_read_b128 v[116:119], v160 offset:60416
s_add_u32 s42, s41, 6144
v_mfma_f32_16x16x32_bf16 a[56:59], v[152:155], v[64:67], a[56:59]
ds_read_b128 v[120:123], v161 offset:9216
s_add_u32 s43, s41, 16384
v_mfma_f32_16x16x32_bf16 a[56:59], v[156:159], v[72:75], a[56:59]
ds_read_b128 v[124:127], v161 offset:19456
s_waitcnt lgkmcnt(4)
v_mfma_f32_16x16x32_bf16 a[60:63], v[156:159], v[76:79], a[60:63]
buffer_store_dwordx4 a[48:51], v253, s[20:23], s42 offen sc1
v_mfma_f32_16x16x32_bf16 a[60:63], v[152:155], v[68:71], a[60:63]
v_mfma_f32_16x16x32_bf16 a[60:63], v[148:151], v[60:63], a[60:63]
buffer_store_dwordx4 a[52:55], v253, s[20:23], s43 offen sc1
v_mfma_f32_16x16x32_bf16 a[60:63], v[144:147], v[52:55], a[60:63]
v_mfma_f32_16x16x32_bf16 a[64:67], v[96:99], v[48:51], a[64:67]
v_mfma_f32_16x16x32_bf16 a[64:67], v[100:103], v[56:59], a[64:67]
s_add_u32 s42, s41, 7168
v_mfma_f32_16x16x32_bf16 a[64:67], v[104:107], v[64:67], a[64:67]
s_add_u32 s43, s41, 17408
v_mfma_f32_16x16x32_bf16 a[64:67], v[108:111], v[72:75], a[64:67]
s_waitcnt lgkmcnt(0)
v_mfma_f32_16x16x32_bf16 a[68:71], v[108:111], v[76:79], a[68:71]
buffer_store_dwordx4 a[56:59], v253, s[20:23], s42 offen sc1
v_mfma_f32_16x16x32_bf16 a[68:71], v[104:107], v[68:71], a[68:71]
v_mfma_f32_16x16x32_bf16 a[68:71], v[100:103], v[60:63], a[68:71]
buffer_store_dwordx4 a[60:63], v253, s[20:23], s43 offen sc1
v_mfma_f32_16x16x32_bf16 a[68:71], v[96:99], v[52:55], a[68:71]
v_mfma_f32_16x16x32_bf16 a[72:75], v[112:115], v[48:51], a[72:75]
v_mfma_f32_16x16x32_bf16 a[72:75], v[116:119], v[56:59], a[72:75]
s_add_u32 s42, s41, 8192
v_mfma_f32_16x16x32_bf16 a[72:75], v[120:123], v[64:67], a[72:75]
s_add_u32 s43, s41, 18432
v_mfma_f32_16x16x32_bf16 a[72:75], v[124:127], v[72:75], a[72:75]
v_mfma_f32_16x16x32_bf16 a[76:79], v[124:127], v[76:79], a[76:79]
buffer_store_dwordx4 a[64:67], v253, s[20:23], s42 offen sc1
v_mfma_f32_16x16x32_bf16 a[76:79], v[120:123], v[68:71], a[76:79]
v_mfma_f32_16x16x32_bf16 a[76:79], v[116:119], v[60:63], a[76:79]
buffer_store_dwordx4 a[68:71], v253, s[20:23], s43 offen sc1
v_mfma_f32_16x16x32_bf16 a[76:79], v[112:115], v[52:55], a[76:79]
s_add_u32 s42, s41, 9216
s_add_u32 s43, s41, 19456
s_nop 5
buffer_store_dwordx4 a[72:75], v253, s[20:23], s42 offen sc1
buffer_store_dwordx4 a[76:79], v253, s[20:23], s43 offen sc1
s_cmp_lg_u32 s36, s54
s_cbranch_scc1 F_O18
v_add_u32 v4, 81920, v253
ds_write_b128 v4, a[0:3] offset:0
ds_write_b128 v4, a[8:11] offset:1024
ds_write_b128 v4, a[16:19] offset:2048
ds_write_b128 v4, a[24:27] offset:3072
ds_write_b128 v4, a[32:35] offset:4096
ds_write_b128 v4, a[40:43] offset:5120
ds_write_b128 v4, a[48:51] offset:6144
ds_write_b128 v4, a[56:59] offset:7168
ds_write_b128 v4, a[64:67] offset:8192
ds_write_b128 v4, a[72:75] offset:9216
ds_write_b128 v4, a[4:7] offset:10240
ds_write_b128 v4, a[12:15] offset:11264
ds_write_b128 v4, a[20:23] offset:12288
ds_write_b128 v4, a[28:31] offset:13312
ds_write_b128 v4, a[36:39] offset:14336
ds_write_b128 v4, a[44:47] offset:15360
ds_write_b128 v4, a[52:55] offset:16384
ds_write_b128 v4, a[60:63] offset:17408
ds_write_b128 v4, a[68:71] offset:18432
ds_write_b128 v4, a[76:79] offset:19456
F_O18:
F_TE:
v_and_b32 v3, 15, v0
v_mul_u32_u24 v3, 1280, v3
v_lshrrev_b32 v4, 4, v0
v_lshl_add_u32 v3, v4, 3, v3
s_waitcnt vmcnt(0) lgkmcnt(0)
s_barrier
s_cmp_lg_u32 s36, 0
s_cbranch_scc1 F_W19
s_add_u32 s66, s84, 4
s_lshl_b32 s67, s85, 5
s_add_u32 s67, s67, s37
s_lshl_b32 s67, s67, 2
v_mov_b32 v4, s66
v_mov_b32 v5, 0
s_mov_b64 exec, 1
buffer_store_dword v4, v5, s[80:83], s67 offen sc1
s_mov_b64 exec, -1
F_W19:
buffer_load_dwordx2 v[232:233], v3, s[24:27], 0 offen offset:0
buffer_load_dwordx2 v[234:235], v3, s[24:27], 0 offen offset:32
buffer_load_dwordx2 v[236:237], v3, s[24:27], 0 offen offset:64
buffer_load_dwordx2 v[238:239], v3, s[24:27], 0 offen offset:96
buffer_load_dwordx2 v[240:241], v3, s[24:27], 0 offen offset:128
s_and_b32 s42, s36, 1
s_mul_i32 s42, s42, 10240
s_lshr_b32 s43, s36, 1
s_mul_i32 s43, s43, 5120
s_add_u32 s42, s42, s43
s_add_u32 s43, s42, 81920
v_add_u32 v5, s43, v253
ds_read_b128 v[176:179], v5 offset:0
ds_read_b128 v[180:183], v5 offset:1024
ds_read_b128 v[184:187], v5 offset:2048
ds_read_b128 v[188:191], v5 offset:3072
ds_read_b128 v[192:195], v5 offset:4096
s_mul_i32 s41, s54, 81920
s_add_u32 s50, s41, s42
s_add_u32 s51, s50, 20480
s_add_u32 s52, s50, 40960
s_add_u32 s53, s50, 61440
s_cmp_eq_u32 s54, 0
s_cselect_b32 s50, 0x10000000, s50
s_cmp_eq_u32 s54, 1
s_cselect_b32 s51, 0x10000000, s51
s_cmp_eq_u32 s54, 2
s_cselect_b32 s52, 0x10000000, s52
s_cmp_eq_u32 s54, 3
s_cselect_b32 s53, 0x10000000, s53
s_cmp_eq_u32 s54, 3
s_cselect_b32 s56, 0, 1.0
s_cselect_b32 s57, 1.0, 0
v_add_u32 v5, 4096, v253
s_mov_b32 s38, 0xbfb8aa3b
s_cmp_lg_u32 s36, 0
s_cbranch_scc1 F_W22
v_lshlrev_b32 v2, 2, v0
s_mov_b32 exec_lo, s44
s_mov_b32 exec_hi, 0
s_add_u32 s66, s84, 4
s_mov_b32 s67, 0
F_P20:
buffer_load_dword v4, v2, s[80:83], s48 offen sc1
s_waitcnt vmcnt(0)
v_subrev_u32 v4, s66, v4
v_cmp_lt_u32 vcc, 0, v4
s_add_u32 s67, s67, 1
s_cmp_gt_u32 s67, 262144
s_cbranch_scc1 F_D21
s_cbranch_vccnz F_P20
F_D21:
s_mov_b64 exec, -1
F_W22:
s_barrier
buffer_load_dwordx4 v[16:19], v253, s[20:23], s50 offen offset:0 sc1
buffer_load_dwordx4 v[20:23], v253, s[20:23], s51 offen offset:0 sc1
buffer_load_dwordx4 v[24:27], v253, s[20:23], s52 offen offset:0 sc1
buffer_load_dwordx4 v[28:31], v253, s[20:23], s53 offen offset:0 sc1
buffer_load_dwordx4 v[32:35], v253, s[20:23], s50 offen offset:1024 sc1
buffer_load_dwordx4 v[36:39], v253, s[20:23], s51 offen offset:1024 sc1
buffer_load_dwordx4 v[40:43], v253, s[20:23], s52 offen offset:1024 sc1
buffer_load_dwordx4 v[44:47], v253, s[20:23], s53 offen offset:1024 sc1
s_waitcnt lgkmcnt(0)
buffer_load_dwordx4 v[48:51], v253, s[20:23], s50 offen offset:2048 sc1
buffer_load_dwordx4 v[52:55], v253, s[20:23], s51 offen offset:2048 sc1
buffer_load_dwordx4 v[56:59], v253, s[20:23], s52 offen offset:2048 sc1
buffer_load_dwordx4 v[60:63], v253, s[20:23], s53 offen offset:2048 sc1
s_waitcnt vmcnt(8)
v_add_f32 v16, v16, v20
v_add_f32 v17, v17, v21
v_add_f32 v18, v18, v22
v_add_f32 v19, v19, v23
v_fmac_f32 v28, s57, v176
v_fmac_f32 v29, s57, v177
v_fmac_f32 v30, s57, v178
v_fmac_f32 v31, s57, v179
v_add_f32 v16, v16, v24
v_add_f32 v17, v17, v25
v_add_f32 v18, v18, v26
v_add_f32 v19, v19, v27
v_fmac_f32 v16, s56, v176
v_fmac_f32 v17, s56, v177
v_fmac_f32 v18, s56, v178
v_fmac_f32 v19, s56, v179
v_cvt_pk_bf16_f32 v114, v28, v29
v_cvt_pk_bf16_f32 v115, v30, v31
v_cvt_pk_bf16_f32 v112, v16, v17
v_cvt_pk_bf16_f32 v113, v18, v19
v_lshlrev_b32 v28, 16, v114
v_and_b32 v29, 0xffff0000, v114
v_lshlrev_b32 v16, 16, v112
v_and_b32 v17, 0xffff0000, v112
v_lshlrev_b32 v30, 16, v115
v_and_b32 v31, 0xffff0000, v115
v_lshlrev_b32 v18, 16, v113
v_and_b32 v19, 0xffff0000, v113
v_mul_f32 v116, s38, v28
v_mul_f32 v117, s38, v29
v_mul_f32 v118, s38, v30
v_mul_f32 v119, s38, v31
v_exp_f32 v116, v116
v_exp_f32 v117, v117
v_exp_f32 v118, v118
v_exp_f32 v119, v119
v_add_f32 v116, 1.0, v116
v_add_f32 v117, 1.0, v117
v_add_f32 v118, 1.0, v118
v_add_f32 v119, 1.0, v119
v_rcp_f32 v116, v116
v_rcp_f32 v117, v117
v_rcp_f32 v118, v118
v_rcp_f32 v119, v119
v_mul_f32 v28, v28, v116
v_mul_f32 v29, v29, v117
v_mul_f32 v30, v30, v118
v_mul_f32 v31, v31, v119
v_cvt_pk_bf16_f32 v114, v28, v29
v_cvt_pk_bf16_f32 v115, v30, v31
v_lshlrev_b32 v28, 16, v114
v_and_b32 v29, 0xffff0000, v114
v_lshlrev_b32 v30, 16, v115
v_and_b32 v31, 0xffff0000, v115
v_mul_f32 v16, v16, v28
v_mul_f32 v17, v17, v29
v_mul_f32 v18, v18, v30
v_mul_f32 v19, v19, v31
v_cvt_pk_bf16_f32 v112, v16, v17
v_cvt_pk_bf16_f32 v113, v18, v19
v_lshlrev_b32 v16, 16, v112
v_and_b32 v17, 0xffff0000, v112
v_lshlrev_b32 v28, 16, v232
v_and_b32 v29, 0xffff0000, v232
v_lshlrev_b32 v18, 16, v113
v_and_b32 v19, 0xffff0000, v113
v_lshlrev_b32 v30, 16, v233
v_and_b32 v31, 0xffff0000, v233
v_add_f32 v16, v16, v28
v_add_f32 v17, v17, v29
v_add_f32 v18, v18, v30
v_add_f32 v19, v19, v31
v_cvt_pk_bf16_f32 v120, v16, v17
v_cvt_pk_bf16_f32 v121, v18, v19
buffer_store_dwordx2 v[120:121], v3, s[28:31], 0 offen offset:0
buffer_load_dwordx4 v[64:67], v253, s[20:23], s50 offen offset:3072 sc1
buffer_load_dwordx4 v[68:71], v253, s[20:23], s51 offen offset:3072 sc1
buffer_load_dwordx4 v[72:75], v253, s[20:23], s52 offen offset:3072 sc1
buffer_load_dwordx4 v[76:79], v253, s[20:23], s53 offen offset:3072 sc1
s_waitcnt vmcnt(9)
v_add_f32 v32, v32, v36
v_add_f32 v33, v33, v37
v_add_f32 v34, v34, v38
v_add_f32 v35, v35, v39
v_fmac_f32 v44, s57, v180
v_fmac_f32 v45, s57, v181
v_fmac_f32 v46, s57, v182
v_fmac_f32 v47, s57, v183
v_add_f32 v32, v32, v40
v_add_f32 v33, v33, v41
v_add_f32 v34, v34, v42
v_add_f32 v35, v35, v43
v_fmac_f32 v32, s56, v180
v_fmac_f32 v33, s56, v181
v_fmac_f32 v34, s56, v182
v_fmac_f32 v35, s56, v183
v_cvt_pk_bf16_f32 v126, v44, v45
v_cvt_pk_bf16_f32 v127, v46, v47
v_cvt_pk_bf16_f32 v124, v32, v33
v_cvt_pk_bf16_f32 v125, v34, v35
v_lshlrev_b32 v44, 16, v126
v_and_b32 v45, 0xffff0000, v126
v_lshlrev_b32 v32, 16, v124
v_and_b32 v33, 0xffff0000, v124
v_lshlrev_b32 v46, 16, v127
v_and_b32 v47, 0xffff0000, v127
v_lshlrev_b32 v34, 16, v125
v_and_b32 v35, 0xffff0000, v125
v_mul_f32 v128, s38, v44
v_mul_f32 v129, s38, v45
v_mul_f32 v130, s38, v46
v_mul_f32 v131, s38, v47
v_exp_f32 v128, v128
v_exp_f32 v129, v129
v_exp_f32 v130, v130
v_exp_f32 v131, v131
v_add_f32 v128, 1.0, v128
v_add_f32 v129, 1.0, v129
v_add_f32 v130, 1.0, v130
v_add_f32 v131, 1.0, v131
v_rcp_f32 v128, v128
v_rcp_f32 v129, v129
v_rcp_f32 v130, v130
v_rcp_f32 v131, v131
v_mul_f32 v44, v44, v128
v_mul_f32 v45, v45, v129
v_mul_f32 v46, v46, v130
v_mul_f32 v47, v47, v131
v_cvt_pk_bf16_f32 v126, v44, v45
v_cvt_pk_bf16_f32 v127, v46, v47
v_lshlrev_b32 v44, 16, v126
v_and_b32 v45, 0xffff0000, v126
v_lshlrev_b32 v46, 16, v127
v_and_b32 v47, 0xffff0000, v127
v_mul_f32 v32, v32, v44
v_mul_f32 v33, v33, v45
v_mul_f32 v34, v34, v46
v_mul_f32 v35, v35, v47
v_cvt_pk_bf16_f32 v124, v32, v33
v_cvt_pk_bf16_f32 v125, v34, v35
v_lshlrev_b32 v32, 16, v124
v_and_b32 v33, 0xffff0000, v124
v_lshlrev_b32 v44, 16, v234
v_and_b32 v45, 0xffff0000, v234
v_lshlrev_b32 v34, 16, v125
v_and_b32 v35, 0xffff0000, v125
v_lshlrev_b32 v46, 16, v235
v_and_b32 v47, 0xffff0000, v235
v_add_f32 v32, v32, v44
v_add_f32 v33, v33, v45
v_add_f32 v34, v34, v46
v_add_f32 v35, v35, v47
v_cvt_pk_bf16_f32 v132, v32, v33
v_cvt_pk_bf16_f32 v133, v34, v35
buffer_store_dwordx2 v[132:133], v3, s[28:31], 0 offen offset:32
buffer_load_dwordx4 v[80:83], v5, s[20:23], s50 offen offset:0 sc1
buffer_load_dwordx4 v[84:87], v5, s[20:23], s51 offen offset:0 sc1
buffer_load_dwordx4 v[88:91], v5, s[20:23], s52 offen offset:0 sc1
buffer_load_dwordx4 v[92:95], v5, s[20:23], s53 offen offset:0 sc1
s_waitcnt vmcnt(10)
v_add_f32 v48, v48, v52
v_add_f32 v49, v49, v53
v_add_f32 v50, v50, v54
v_add_f32 v51, v51, v55
v_fmac_f32 v60, s57, v184
v_fmac_f32 v61, s57, v185
v_fmac_f32 v62, s57, v186
v_fmac_f32 v63, s57, v187
v_add_f32 v48, v48, v56
v_add_f32 v49, v49, v57
v_add_f32 v50, v50, v58
v_add_f32 v51, v51, v59
v_fmac_f32 v48, s56, v184
v_fmac_f32 v49, s56, v185
v_fmac_f32 v50, s56, v186
v_fmac_f32 v51, s56, v187
v_cvt_pk_bf16_f32 v138, v60, v61
v_cvt_pk_bf16_f32 v139, v62, v63
v_cvt_pk_bf16_f32 v136, v48, v49
v_cvt_pk_bf16_f32 v137, v50, v51
v_lshlrev_b32 v60, 16, v138
v_and_b32 v61, 0xffff0000, v138
v_lshlrev_b32 v48, 16, v136
v_and_b32 v49, 0xffff0000, v136
v_lshlrev_b32 v62, 16, v139
v_and_b32 v63, 0xffff0000, v139
v_lshlrev_b32 v50, 16, v137
v_and_b32 v51, 0xffff0000, v137
v_mul_f32 v140, s38, v60
v_mul_f32 v141, s38, v61
v_mul_f32 v142, s38, v62
v_mul_f32 v143, s38, v63
v_exp_f32 v140, v140
v_exp_f32 v141, v141
v_exp_f32 v142, v142
v_exp_f32 v143, v143
v_add_f32 v140, 1.0, v140
v_add_f32 v141, 1.0, v141
v_add_f32 v142, 1.0, v142
v_add_f32 v143, 1.0, v143
v_rcp_f32 v140, v140
v_rcp_f32 v141, v141
v_rcp_f32 v142, v142
v_rcp_f32 v143, v143
v_mul_f32 v60, v60, v140
v_mul_f32 v61, v61, v141
v_mul_f32 v62, v62, v142
v_mul_f32 v63, v63, v143
v_cvt_pk_bf16_f32 v138, v60, v61
v_cvt_pk_bf16_f32 v139, v62, v63
v_lshlrev_b32 v60, 16, v138
v_and_b32 v61, 0xffff0000, v138
v_lshlrev_b32 v62, 16, v139
v_and_b32 v63, 0xffff0000, v139
v_mul_f32 v48, v48, v60
v_mul_f32 v49, v49, v61
v_mul_f32 v50, v50, v62
v_mul_f32 v51, v51, v63
v_cvt_pk_bf16_f32 v136, v48, v49
v_cvt_pk_bf16_f32 v137, v50, v51
v_lshlrev_b32 v48, 16, v136
v_and_b32 v49, 0xffff0000, v136
v_lshlrev_b32 v60, 16, v236
v_and_b32 v61, 0xffff0000, v236
v_lshlrev_b32 v50, 16, v137
v_and_b32 v51, 0xffff0000, v137
v_lshlrev_b32 v62, 16, v237
v_and_b32 v63, 0xffff0000, v237
v_add_f32 v48, v48, v60
v_add_f32 v49, v49, v61
v_add_f32 v50, v50, v62
v_add_f32 v51, v51, v63
v_cvt_pk_bf16_f32 v144, v48, v49
v_cvt_pk_bf16_f32 v145, v50, v51
buffer_store_dwordx2 v[144:145], v3, s[28:31], 0 offen offset:64
s_waitcnt vmcnt(6)
v_add_f32 v64, v64, v68
v_add_f32 v65, v65, v69
v_add_f32 v66, v66, v70
v_add_f32 v67, v67, v71
v_fmac_f32 v76, s57, v188
v_fmac_f32 v77, s57, v189
v_fmac_f32 v78, s57, v190
v_fmac_f32 v79, s57, v191
v_add_f32 v64, v64, v72
v_add_f32 v65, v65, v73
v_add_f32 v66, v66, v74
v_add_f32 v67, v67, v75
v_fmac_f32 v64, s56, v188
v_fmac_f32 v65, s56, v189
v_fmac_f32 v66, s56, v190
v_fmac_f32 v67, s56, v191
v_cvt_pk_bf16_f32 v150, v76, v77
v_cvt_pk_bf16_f32 v151, v78, v79
v_cvt_pk_bf16_f32 v148, v64, v65
v_cvt_pk_bf16_f32 v149, v66, v67
v_lshlrev_b32 v76, 16, v150
v_and_b32 v77, 0xffff0000, v150
v_lshlrev_b32 v64, 16, v148
v_and_b32 v65, 0xffff0000, v148
v_lshlrev_b32 v78, 16, v151
v_and_b32 v79, 0xffff0000, v151
v_lshlrev_b32 v66, 16, v149
v_and_b32 v67, 0xffff0000, v149
v_mul_f32 v152, s38, v76
v_mul_f32 v153, s38, v77
v_mul_f32 v154, s38, v78
v_mul_f32 v155, s38, v79
v_exp_f32 v152, v152
v_exp_f32 v153, v153
v_exp_f32 v154, v154
v_exp_f32 v155, v155
v_add_f32 v152, 1.0, v152
v_add_f32 v153, 1.0, v153
v_add_f32 v154, 1.0, v154
v_add_f32 v155, 1.0, v155
v_rcp_f32 v152, v152
v_rcp_f32 v153, v153
v_rcp_f32 v154, v154
v_rcp_f32 v155, v155
v_mul_f32 v76, v76, v152
v_mul_f32 v77, v77, v153
v_mul_f32 v78, v78, v154
v_mul_f32 v79, v79, v155
v_cvt_pk_bf16_f32 v150, v76, v77
v_cvt_pk_bf16_f32 v151, v78, v79
v_lshlrev_b32 v76, 16, v150
v_and_b32 v77, 0xffff0000, v150
v_lshlrev_b32 v78, 16, v151
v_and_b32 v79, 0xffff0000, v151
v_mul_f32 v64, v64, v76
v_mul_f32 v65, v65, v77
v_mul_f32 v66, v66, v78
v_mul_f32 v67, v67, v79
v_cvt_pk_bf16_f32 v148, v64, v65
v_cvt_pk_bf16_f32 v149, v66, v67
v_lshlrev_b32 v64, 16, v148
v_and_b32 v65, 0xffff0000, v148
v_lshlrev_b32 v76, 16, v238
v_and_b32 v77, 0xffff0000, v238
v_lshlrev_b32 v66, 16, v149
v_and_b32 v67, 0xffff0000, v149
v_lshlrev_b32 v78, 16, v239
v_and_b32 v79, 0xffff0000, v239
v_add_f32 v64, v64, v76
v_add_f32 v65, v65, v77
v_add_f32 v66, v66, v78
v_add_f32 v67, v67, v79
v_cvt_pk_bf16_f32 v156, v64, v65
v_cvt_pk_bf16_f32 v157, v66, v67
buffer_store_dwordx2 v[156:157], v3, s[28:31], 0 offen offset:96
s_waitcnt vmcnt(2)
v_add_f32 v80, v80, v84
v_add_f32 v81, v81, v85
v_add_f32 v82, v82, v86
v_add_f32 v83, v83, v87
v_fmac_f32 v92, s57, v192
v_fmac_f32 v93, s57, v193
v_fmac_f32 v94, s57, v194
v_fmac_f32 v95, s57, v195
v_add_f32 v80, v80, v88
v_add_f32 v81, v81, v89
v_add_f32 v82, v82, v90
v_add_f32 v83, v83, v91
v_fmac_f32 v80, s56, v192
v_fmac_f32 v81, s56, v193
v_fmac_f32 v82, s56, v194
v_fmac_f32 v83, s56, v195
v_cvt_pk_bf16_f32 v162, v92, v93
v_cvt_pk_bf16_f32 v163, v94, v95
v_cvt_pk_bf16_f32 v160, v80, v81
v_cvt_pk_bf16_f32 v161, v82, v83
v_lshlrev_b32 v92, 16, v162
v_and_b32 v93, 0xffff0000, v162
v_lshlrev_b32 v80, 16, v160
v_and_b32 v81, 0xffff0000, v160
v_lshlrev_b32 v94, 16, v163
v_and_b32 v95, 0xffff0000, v163
v_lshlrev_b32 v82, 16, v161
v_and_b32 v83, 0xffff0000, v161
v_mul_f32 v164, s38, v92
v_mul_f32 v165, s38, v93
v_mul_f32 v166, s38, v94
v_mul_f32 v167, s38, v95
v_exp_f32 v164, v164
v_exp_f32 v165, v165
v_exp_f32 v166, v166
v_exp_f32 v167, v167
v_add_f32 v164, 1.0, v164
v_add_f32 v165, 1.0, v165
v_add_f32 v166, 1.0, v166
v_add_f32 v167, 1.0, v167
v_rcp_f32 v164, v164
v_rcp_f32 v165, v165
v_rcp_f32 v166, v166
v_rcp_f32 v167, v167
v_mul_f32 v92, v92, v164
v_mul_f32 v93, v93, v165
v_mul_f32 v94, v94, v166
v_mul_f32 v95, v95, v167
v_cvt_pk_bf16_f32 v162, v92, v93
v_cvt_pk_bf16_f32 v163, v94, v95
v_lshlrev_b32 v92, 16, v162
v_and_b32 v93, 0xffff0000, v162
v_lshlrev_b32 v94, 16, v163
v_and_b32 v95, 0xffff0000, v163
v_mul_f32 v80, v80, v92
v_mul_f32 v81, v81, v93
v_mul_f32 v82, v82, v94
v_mul_f32 v83, v83, v95
v_cvt_pk_bf16_f32 v160, v80, v81
v_cvt_pk_bf16_f32 v161, v82, v83
v_lshlrev_b32 v80, 16, v160
v_and_b32 v81, 0xffff0000, v160
v_lshlrev_b32 v92, 16, v240
v_and_b32 v93, 0xffff0000, v240
v_lshlrev_b32 v82, 16, v161
v_and_b32 v83, 0xffff0000, v161
v_lshlrev_b32 v94, 16, v241
v_and_b32 v95, 0xffff0000, v241
v_add_f32 v80, v80, v92
v_add_f32 v81, v81, v93
v_add_f32 v82, v82, v94
v_add_f32 v83, v83, v95
v_cvt_pk_bf16_f32 v168, v80, v81
v_cvt_pk_bf16_f32 v169, v82, v83
buffer_store_dwordx2 v[168:169], v3, s[28:31], 0 offen offset:128
F_END:
s_endpgm
F_TR0:
s_call_b64 s[64:65], F_SLOW0
s_branch F_BK0
F_TR1:
s_call_b64 s[64:65], F_SLOW1
s_branch F_BK1
F_TR2:
s_call_b64 s[64:65], F_SLOW2
s_branch F_BK2
F_TR3:
s_call_b64 s[64:65], F_SLOW3
s_branch F_BK3
F_TR4:
s_call_b64 s[64:65], F_SLOW0
s_branch F_BK4
F_TR5:
s_call_b64 s[64:65], F_SLOW1
s_branch F_BK5
F_TR6:
s_call_b64 s[64:65], F_SLOW2
s_branch F_BK6
F_TR7:
s_call_b64 s[64:65], F_SLOW3
s_branch F_BK7
F_QS1:
s_waitcnt vmcnt(14)
s_branch F_QB1
F_US0:
s_waitcnt vmcnt(10)
s_branch F_UB0
F_TSP:
s_mov_b32 s67, 0
F_S23:
buffer_load_dword v166, v165, s[80:83], s47 offen sc1
s_waitcnt vmcnt(0)
v_subrev_u32 v166, s84, v166
v_subrev_u32 v166, 3, v166
v_cmp_lt_u32 vcc, 1, v166
s_add_u32 s67, s67, 1
s_cmp_gt_u32 s67, 262144
s_cbranch_scc1 F_TSB
s_cbranch_vccnz F_S23
s_branch F_TSB
F_PFE:
F_SLOW0:
s_nop 7
s_nop 7
v_max3_f32 v2, v64, v65, v66
v_max3_f32 v2, v2, v67, v96
v_max3_f32 v2, v2, v97, v98
v_max_f32 v2, v2, v99
v_max3_f32 v3, v68, v69, v70
v_max3_f32 v3, v3, v71, v100
v_max3_f32 v3, v3, v101, v102
v_max_f32 v3, v3, v103
v_max3_f32 v4, v72, v73, v74
v_max3_f32 v4, v4, v75, v104
v_max3_f32 v4, v4, v105, v106
v_max_f32 v4, v4, v107
v_max3_f32 v5, v76, v77, v78
v_max3_f32 v5, v5, v79, v108
v_max3_f32 v5, v5, v109, v110
v_max_f32 v5, v5, v111
v_mov_b32 v6, v2
v_mov_b32 v7, v3
v_mov_b32 v8, v4
v_mov_b32 v9, v5
s_nop 1
v_permlane16_swap_b32 v2, v6
v_permlane16_swap_b32 v3, v7
v_permlane16_swap_b32 v4, v8
v_permlane16_swap_b32 v5, v9
v_max_f32 v2, v2, v6
v_max_f32 v3, v3, v7
v_max_f32 v4, v4, v8
v_max_f32 v5, v5, v9
v_mov_b32 v6, v2
v_mov_b32 v7, v3
v_mov_b32 v8, v4
v_mov_b32 v9, v5
s_nop 1
v_permlane32_swap_b32 v2, v6
v_permlane32_swap_b32 v3, v7
v_permlane32_swap_b32 v4, v8
v_permlane32_swap_b32 v5, v9
v_max_f32 v2, v2, v6
v_max_f32 v3, v3, v7
v_max_f32 v4, v4, v8
v_max_f32 v5, v5, v9
v_max_f32 v2, 0, v2
v_ceil_f32 v2, v2
v_sub_f32 v6, 0, v2
v_cvt_i32_f32 v6, v6
v_max_f32 v3, 0, v3
v_ceil_f32 v3, v3
v_sub_f32 v7, 0, v3
v_cvt_i32_f32 v7, v7
v_max_f32 v4, 0, v4
v_ceil_f32 v4, v4
v_sub_f32 v8, 0, v4
v_cvt_i32_f32 v8, v8
v_max_f32 v5, 0, v5
v_ceil_f32 v5, v5
v_sub_f32 v9, 0, v5
v_cvt_i32_f32 v9, v9
v_ldexp_f32 v236, v236, v6
v_sub_f32 v48, v48, v2
v_sub_f32 v49, v49, v2
v_sub_f32 v50, v50, v2
v_sub_f32 v51, v51, v2
v_sub_f32 v64, v64, v2
v_sub_f32 v65, v65, v2
v_sub_f32 v66, v66, v2
v_sub_f32 v67, v67, v2
v_sub_f32 v96, v96, v2
v_sub_f32 v97, v97, v2
v_sub_f32 v98, v98, v2
v_sub_f32 v99, v99, v2
v_sub_f32 v80, v80, v2
v_sub_f32 v81, v81, v2
v_sub_f32 v82, v82, v2
v_sub_f32 v83, v83, v2
v_ldexp_f32 v237, v237, v7
v_sub_f32 v52, v52, v3
v_sub_f32 v53, v53, v3
v_sub_f32 v54, v54, v3
v_sub_f32 v55, v55, v3
v_sub_f32 v68, v68, v3
v_sub_f32 v69, v69, v3
v_sub_f32 v70, v70, v3
v_sub_f32 v71, v71, v3
v_sub_f32 v100, v100, v3
v_sub_f32 v101, v101, v3
v_sub_f32 v102, v102, v3
v_sub_f32 v103, v103, v3
v_sub_f32 v84, v84, v3
v_sub_f32 v85, v85, v3
v_sub_f32 v86, v86, v3
v_sub_f32 v87, v87, v3
v_ldexp_f32 v238, v238, v8
v_sub_f32 v56, v56, v4
v_sub_f32 v57, v57, v4
v_sub_f32 v58, v58, v4
v_sub_f32 v59, v59, v4
v_sub_f32 v72, v72, v4
v_sub_f32 v73, v73, v4
v_sub_f32 v74, v74, v4
v_sub_f32 v75, v75, v4
v_sub_f32 v104, v104, v4
v_sub_f32 v105, v105, v4
v_sub_f32 v106, v106, v4
v_sub_f32 v107, v107, v4
v_sub_f32 v88, v88, v4
v_sub_f32 v89, v89, v4
v_sub_f32 v90, v90, v4
v_sub_f32 v91, v91, v4
v_ldexp_f32 v239, v239, v9
v_sub_f32 v60, v60, v5
v_sub_f32 v61, v61, v5
v_sub_f32 v62, v62, v5
v_sub_f32 v63, v63, v5
v_sub_f32 v76, v76, v5
v_sub_f32 v77, v77, v5
v_sub_f32 v78, v78, v5
v_sub_f32 v79, v79, v5
v_sub_f32 v108, v108, v5
v_sub_f32 v109, v109, v5
v_sub_f32 v110, v110, v5
v_sub_f32 v111, v111, v5
v_sub_f32 v92, v92, v5
v_sub_f32 v93, v93, v5
v_sub_f32 v94, v94, v5
v_sub_f32 v95, v95, v5
v_lshlrev_b32 v10, 16, v160
v_and_b32 v11, 0xffff0000, v160
v_ldexp_f32 v10, v10, v6
v_ldexp_f32 v11, v11, v6
v_cvt_pk_bf16_f32 v160, v10, v11
v_lshlrev_b32 v10, 16, v161
v_and_b32 v11, 0xffff0000, v161
v_ldexp_f32 v10, v10, v6
v_ldexp_f32 v11, v11, v6
v_cvt_pk_bf16_f32 v161, v10, v11
v_lshlrev_b32 v10, 16, v162
v_and_b32 v11, 0xffff0000, v162
v_ldexp_f32 v10, v10, v6
v_ldexp_f32 v11, v11, v6
v_cvt_pk_bf16_f32 v162, v10, v11
v_lshlrev_b32 v10, 16, v163
v_and_b32 v11, 0xffff0000, v163
v_ldexp_f32 v10, v10, v6
v_ldexp_f32 v11, v11, v6
v_cvt_pk_bf16_f32 v163, v10, v11
v_lshlrev_b32 v10, 16, v164
v_and_b32 v11, 0xffff0000, v164
v_ldexp_f32 v10, v10, v7
v_ldexp_f32 v11, v11, v7
v_cvt_pk_bf16_f32 v164, v10, v11
v_lshlrev_b32 v10, 16, v165
v_and_b32 v11, 0xffff0000, v165
v_ldexp_f32 v10, v10, v7
v_ldexp_f32 v11, v11, v7
v_cvt_pk_bf16_f32 v165, v10, v11
v_lshlrev_b32 v10, 16, v166
v_and_b32 v11, 0xffff0000, v166
v_ldexp_f32 v10, v10, v7
v_ldexp_f32 v11, v11, v7
v_cvt_pk_bf16_f32 v166, v10, v11
v_lshlrev_b32 v10, 16, v167
v_and_b32 v11, 0xffff0000, v167
v_ldexp_f32 v10, v10, v7
v_ldexp_f32 v11, v11, v7
v_cvt_pk_bf16_f32 v167, v10, v11
v_lshlrev_b32 v10, 16, v168
v_and_b32 v11, 0xffff0000, v168
v_ldexp_f32 v10, v10, v8
v_ldexp_f32 v11, v11, v8
v_cvt_pk_bf16_f32 v168, v10, v11
v_lshlrev_b32 v10, 16, v169
v_and_b32 v11, 0xffff0000, v169
v_ldexp_f32 v10, v10, v8
v_ldexp_f32 v11, v11, v8
v_cvt_pk_bf16_f32 v169, v10, v11
v_lshlrev_b32 v10, 16, v170
v_and_b32 v11, 0xffff0000, v170
v_ldexp_f32 v10, v10, v8
v_ldexp_f32 v11, v11, v8
v_cvt_pk_bf16_f32 v170, v10, v11
v_lshlrev_b32 v10, 16, v171
v_and_b32 v11, 0xffff0000, v171
v_ldexp_f32 v10, v10, v8
v_ldexp_f32 v11, v11, v8
v_cvt_pk_bf16_f32 v171, v10, v11
v_lshlrev_b32 v10, 16, v172
v_and_b32 v11, 0xffff0000, v172
v_ldexp_f32 v10, v10, v9
v_ldexp_f32 v11, v11, v9
v_cvt_pk_bf16_f32 v172, v10, v11
v_lshlrev_b32 v10, 16, v173
v_and_b32 v11, 0xffff0000, v173
v_ldexp_f32 v10, v10, v9
v_ldexp_f32 v11, v11, v9
v_cvt_pk_bf16_f32 v173, v10, v11
v_lshlrev_b32 v10, 16, v174
v_and_b32 v11, 0xffff0000, v174
v_ldexp_f32 v10, v10, v9
v_ldexp_f32 v11, v11, v9
v_cvt_pk_bf16_f32 v174, v10, v11
v_lshlrev_b32 v10, 16, v175
v_and_b32 v11, 0xffff0000, v175
v_ldexp_f32 v10, v10, v9
v_ldexp_f32 v11, v11, v9
v_cvt_pk_bf16_f32 v175, v10, v11
v_lshlrev_b32 v10, 16, v144
v_and_b32 v11, 0xffff0000, v144
v_ldexp_f32 v10, v10, v6
v_ldexp_f32 v11, v11, v6
v_cvt_pk_bf16_f32 v144, v10, v11
v_lshlrev_b32 v10, 16, v145
v_and_b32 v11, 0xffff0000, v145
v_ldexp_f32 v10, v10, v6
v_ldexp_f32 v11, v11, v6
v_cvt_pk_bf16_f32 v145, v10, v11
v_lshlrev_b32 v10, 16, v146
v_and_b32 v11, 0xffff0000, v146
v_ldexp_f32 v10, v10, v6
v_ldexp_f32 v11, v11, v6
v_cvt_pk_bf16_f32 v146, v10, v11
v_lshlrev_b32 v10, 16, v147
v_and_b32 v11, 0xffff0000, v147
v_ldexp_f32 v10, v10, v6
v_ldexp_f32 v11, v11, v6
v_cvt_pk_bf16_f32 v147, v10, v11
v_lshlrev_b32 v10, 16, v148
v_and_b32 v11, 0xffff0000, v148
v_ldexp_f32 v10, v10, v7
v_ldexp_f32 v11, v11, v7
v_cvt_pk_bf16_f32 v148, v10, v11
v_lshlrev_b32 v10, 16, v149
v_and_b32 v11, 0xffff0000, v149
v_ldexp_f32 v10, v10, v7
v_ldexp_f32 v11, v11, v7
v_cvt_pk_bf16_f32 v149, v10, v11
v_lshlrev_b32 v10, 16, v150
v_and_b32 v11, 0xffff0000, v150
v_ldexp_f32 v10, v10, v7
v_ldexp_f32 v11, v11, v7
v_cvt_pk_bf16_f32 v150, v10, v11
v_lshlrev_b32 v10, 16, v151
v_and_b32 v11, 0xffff0000, v151
v_ldexp_f32 v10, v10, v7
v_ldexp_f32 v11, v11, v7
v_cvt_pk_bf16_f32 v151, v10, v11
v_lshlrev_b32 v10, 16, v152
v_and_b32 v11, 0xffff0000, v152
v_ldexp_f32 v10, v10, v8
v_ldexp_f32 v11, v11, v8
v_cvt_pk_bf16_f32 v152, v10, v11
v_lshlrev_b32 v10, 16, v153
v_and_b32 v11, 0xffff0000, v153
v_ldexp_f32 v10, v10, v8
v_ldexp_f32 v11, v11, v8
v_cvt_pk_bf16_f32 v153, v10, v11
v_lshlrev_b32 v10, 16, v154
v_and_b32 v11, 0xffff0000, v154
v_ldexp_f32 v10, v10, v8
v_ldexp_f32 v11, v11, v8
v_cvt_pk_bf16_f32 v154, v10, v11
v_lshlrev_b32 v10, 16, v155
v_and_b32 v11, 0xffff0000, v155
v_ldexp_f32 v10, v10, v8
v_ldexp_f32 v11, v11, v8
v_cvt_pk_bf16_f32 v155, v10, v11
v_lshlrev_b32 v10, 16, v156
v_and_b32 v11, 0xffff0000, v156
v_ldexp_f32 v10, v10, v9
v_ldexp_f32 v11, v11, v9
v_cvt_pk_bf16_f32 v156, v10, v11
v_lshlrev_b32 v10, 16, v157
v_and_b32 v11, 0xffff0000, v157
v_ldexp_f32 v10, v10, v9
v_ldexp_f32 v11, v11, v9
v_cvt_pk_bf16_f32 v157, v10, v11
v_lshlrev_b32 v10, 16, v158
v_and_b32 v11, 0xffff0000, v158
v_ldexp_f32 v10, v10, v9
v_ldexp_f32 v11, v11, v9
v_cvt_pk_bf16_f32 v158, v10, v11
v_lshlrev_b32 v10, 16, v159
v_and_b32 v11, 0xffff0000, v159
v_ldexp_f32 v10, v10, v9
v_ldexp_f32 v11, v11, v9
v_cvt_pk_bf16_f32 v159, v10, v11
v_accvgpr_read_b32 v10, a0
v_accvgpr_read_b32 v11, a1
v_ldexp_f32 v10, v10, v6
v_ldexp_f32 v11, v11, v6
v_accvgpr_write_b32 a0, v10
v_accvgpr_write_b32 a1, v11
v_accvgpr_read_b32 v10, a2
v_accvgpr_read_b32 v11, a3
v_ldexp_f32 v10, v10, v6
v_ldexp_f32 v11, v11, v6
v_accvgpr_write_b32 a2, v10
v_accvgpr_write_b32 a3, v11
v_accvgpr_read_b32 v10, a4
v_accvgpr_read_b32 v11, a5
v_ldexp_f32 v10, v10, v7
v_ldexp_f32 v11, v11, v7
v_accvgpr_write_b32 a4, v10
v_accvgpr_write_b32 a5, v11
v_accvgpr_read_b32 v10, a6
v_accvgpr_read_b32 v11, a7
v_ldexp_f32 v10, v10, v7
v_ldexp_f32 v11, v11, v7
v_accvgpr_write_b32 a6, v10
v_accvgpr_write_b32 a7, v11
v_accvgpr_read_b32 v10, a8
v_accvgpr_read_b32 v11, a9
v_ldexp_f32 v10, v10, v8
v_ldexp_f32 v11, v11, v8
v_accvgpr_write_b32 a8, v10
v_accvgpr_write_b32 a9, v11
v_accvgpr_read_b32 v10, a10
v_accvgpr_read_b32 v11, a11
v_ldexp_f32 v10, v10, v8
v_ldexp_f32 v11, v11, v8
v_accvgpr_write_b32 a10, v10
v_accvgpr_write_b32 a11, v11
v_accvgpr_read_b32 v10, a12
v_accvgpr_read_b32 v11, a13
v_ldexp_f32 v10, v10, v9
v_ldexp_f32 v11, v11, v9
v_accvgpr_write_b32 a12, v10
v_accvgpr_write_b32 a13, v11
v_accvgpr_read_b32 v10, a14
v_accvgpr_read_b32 v11, a15
v_ldexp_f32 v10, v10, v9
v_ldexp_f32 v11, v11, v9
v_accvgpr_write_b32 a14, v10
v_accvgpr_write_b32 a15, v11
v_accvgpr_read_b32 v10, a16
v_accvgpr_read_b32 v11, a17
v_ldexp_f32 v10, v10, v6
v_ldexp_f32 v11, v11, v6
v_accvgpr_write_b32 a16, v10
v_accvgpr_write_b32 a17, v11
v_accvgpr_read_b32 v10, a18
v_accvgpr_read_b32 v11, a19
v_ldexp_f32 v10, v10, v6
v_ldexp_f32 v11, v11, v6
v_accvgpr_write_b32 a18, v10
v_accvgpr_write_b32 a19, v11
v_accvgpr_read_b32 v10, a20
v_accvgpr_read_b32 v11, a21
v_ldexp_f32 v10, v10, v7
v_ldexp_f32 v11, v11, v7
v_accvgpr_write_b32 a20, v10
v_accvgpr_write_b32 a21, v11
v_accvgpr_read_b32 v10, a22
v_accvgpr_read_b32 v11, a23
v_ldexp_f32 v10, v10, v7
v_ldexp_f32 v11, v11, v7
v_accvgpr_write_b32 a22, v10
v_accvgpr_write_b32 a23, v11
v_accvgpr_read_b32 v10, a24
v_accvgpr_read_b32 v11, a25
v_ldexp_f32 v10, v10, v8
v_ldexp_f32 v11, v11, v8
v_accvgpr_write_b32 a24, v10
v_accvgpr_write_b32 a25, v11
v_accvgpr_read_b32 v10, a26
v_accvgpr_read_b32 v11, a27
v_ldexp_f32 v10, v10, v8
v_ldexp_f32 v11, v11, v8
v_accvgpr_write_b32 a26, v10
v_accvgpr_write_b32 a27, v11
v_accvgpr_read_b32 v10, a28
v_accvgpr_read_b32 v11, a29
v_ldexp_f32 v10, v10, v9
v_ldexp_f32 v11, v11, v9
v_accvgpr_write_b32 a28, v10
v_accvgpr_write_b32 a29, v11
v_accvgpr_read_b32 v10, a30
v_accvgpr_read_b32 v11, a31
v_ldexp_f32 v10, v10, v9
v_ldexp_f32 v11, v11, v9
v_accvgpr_write_b32 a30, v10
v_accvgpr_write_b32 a31, v11
v_accvgpr_read_b32 v10, a32
v_accvgpr_read_b32 v11, a33
v_ldexp_f32 v10, v10, v6
v_ldexp_f32 v11, v11, v6
v_accvgpr_write_b32 a32, v10
v_accvgpr_write_b32 a33, v11
v_accvgpr_read_b32 v10, a34
v_accvgpr_read_b32 v11, a35
v_ldexp_f32 v10, v10, v6
v_ldexp_f32 v11, v11, v6
v_accvgpr_write_b32 a34, v10
v_accvgpr_write_b32 a35, v11
v_accvgpr_read_b32 v10, a36
v_accvgpr_read_b32 v11, a37
v_ldexp_f32 v10, v10, v7
v_ldexp_f32 v11, v11, v7
v_accvgpr_write_b32 a36, v10
v_accvgpr_write_b32 a37, v11
v_accvgpr_read_b32 v10, a38
v_accvgpr_read_b32 v11, a39
v_ldexp_f32 v10, v10, v7
v_ldexp_f32 v11, v11, v7
v_accvgpr_write_b32 a38, v10
v_accvgpr_write_b32 a39, v11
v_accvgpr_read_b32 v10, a40
v_accvgpr_read_b32 v11, a41
v_ldexp_f32 v10, v10, v8
v_ldexp_f32 v11, v11, v8
v_accvgpr_write_b32 a40, v10
v_accvgpr_write_b32 a41, v11
v_accvgpr_read_b32 v10, a42
v_accvgpr_read_b32 v11, a43
v_ldexp_f32 v10, v10, v8
v_ldexp_f32 v11, v11, v8
v_accvgpr_write_b32 a42, v10
v_accvgpr_write_b32 a43, v11
v_accvgpr_read_b32 v10, a44
v_accvgpr_read_b32 v11, a45
v_ldexp_f32 v10, v10, v9
v_ldexp_f32 v11, v11, v9
v_accvgpr_write_b32 a44, v10
v_accvgpr_write_b32 a45, v11
v_accvgpr_read_b32 v10, a46
v_accvgpr_read_b32 v11, a47
v_ldexp_f32 v10, v10, v9
v_ldexp_f32 v11, v11, v9
v_accvgpr_write_b32 a46, v10
v_accvgpr_write_b32 a47, v11
v_accvgpr_read_b32 v10, a48
v_accvgpr_read_b32 v11, a49
v_ldexp_f32 v10, v10, v6
v_ldexp_f32 v11, v11, v6
v_accvgpr_write_b32 a48, v10
v_accvgpr_write_b32 a49, v11
v_accvgpr_read_b32 v10, a50
v_accvgpr_read_b32 v11, a51
v_ldexp_f32 v10, v10, v6
v_ldexp_f32 v11, v11, v6
v_accvgpr_write_b32 a50, v10
v_accvgpr_write_b32 a51, v11
v_accvgpr_read_b32 v10, a52
v_accvgpr_read_b32 v11, a53
v_ldexp_f32 v10, v10, v7
v_ldexp_f32 v11, v11, v7
v_accvgpr_write_b32 a52, v10
v_accvgpr_write_b32 a53, v11
v_accvgpr_read_b32 v10, a54
v_accvgpr_read_b32 v11, a55
v_ldexp_f32 v10, v10, v7
v_ldexp_f32 v11, v11, v7
v_accvgpr_write_b32 a54, v10
v_accvgpr_write_b32 a55, v11
v_accvgpr_read_b32 v10, a56
v_accvgpr_read_b32 v11, a57
v_ldexp_f32 v10, v10, v8
v_ldexp_f32 v11, v11, v8
v_accvgpr_write_b32 a56, v10
v_accvgpr_write_b32 a57, v11
v_accvgpr_read_b32 v10, a58
v_accvgpr_read_b32 v11, a59
v_ldexp_f32 v10, v10, v8
v_ldexp_f32 v11, v11, v8
v_accvgpr_write_b32 a58, v10
v_accvgpr_write_b32 a59, v11
v_accvgpr_read_b32 v10, a60
v_accvgpr_read_b32 v11, a61
v_ldexp_f32 v10, v10, v9
v_ldexp_f32 v11, v11, v9
v_accvgpr_write_b32 a60, v10
v_accvgpr_write_b32 a61, v11
v_accvgpr_read_b32 v10, a62
v_accvgpr_read_b32 v11, a63
v_ldexp_f32 v10, v10, v9
v_ldexp_f32 v11, v11, v9
v_accvgpr_write_b32 a62, v10
v_accvgpr_write_b32 a63, v11
v_accvgpr_read_b32 v10, a64
v_accvgpr_read_b32 v11, a65
v_ldexp_f32 v10, v10, v6
v_ldexp_f32 v11, v11, v6
v_accvgpr_write_b32 a64, v10
v_accvgpr_write_b32 a65, v11
v_accvgpr_read_b32 v10, a66
v_accvgpr_read_b32 v11, a67
v_ldexp_f32 v10, v10, v6
v_ldexp_f32 v11, v11, v6
v_accvgpr_write_b32 a66, v10
v_accvgpr_write_b32 a67, v11
v_accvgpr_read_b32 v10, a68
v_accvgpr_read_b32 v11, a69
v_ldexp_f32 v10, v10, v7
v_ldexp_f32 v11, v11, v7
v_accvgpr_write_b32 a68, v10
v_accvgpr_write_b32 a69, v11
v_accvgpr_read_b32 v10, a70
v_accvgpr_read_b32 v11, a71
v_ldexp_f32 v10, v10, v7
v_ldexp_f32 v11, v11, v7
v_accvgpr_write_b32 a70, v10
v_accvgpr_write_b32 a71, v11
v_accvgpr_read_b32 v10, a72
v_accvgpr_read_b32 v11, a73
v_ldexp_f32 v10, v10, v8
v_ldexp_f32 v11, v11, v8
v_accvgpr_write_b32 a72, v10
v_accvgpr_write_b32 a73, v11
v_accvgpr_read_b32 v10, a74
v_accvgpr_read_b32 v11, a75
v_ldexp_f32 v10, v10, v8
v_ldexp_f32 v11, v11, v8
v_accvgpr_write_b32 a74, v10
v_accvgpr_write_b32 a75, v11
v_accvgpr_read_b32 v10, a76
v_accvgpr_read_b32 v11, a77
v_ldexp_f32 v10, v10, v9
v_ldexp_f32 v11, v11, v9
v_accvgpr_write_b32 a76, v10
v_accvgpr_write_b32 a77, v11
v_accvgpr_read_b32 v10, a78
v_accvgpr_read_b32 v11, a79
v_ldexp_f32 v10, v10, v9
v_ldexp_f32 v11, v11, v9
v_accvgpr_write_b32 a78, v10
v_accvgpr_write_b32 a79, v11
v_accvgpr_read_b32 v10, a80
v_accvgpr_read_b32 v11, a81
v_ldexp_f32 v10, v10, v6
v_ldexp_f32 v11, v11, v6
v_accvgpr_write_b32 a80, v10
v_accvgpr_write_b32 a81, v11
v_accvgpr_read_b32 v10, a82
v_accvgpr_read_b32 v11, a83
v_ldexp_f32 v10, v10, v6
v_ldexp_f32 v11, v11, v6
v_accvgpr_write_b32 a82, v10
v_accvgpr_write_b32 a83, v11
v_accvgpr_read_b32 v10, a84
v_accvgpr_read_b32 v11, a85
v_ldexp_f32 v10, v10, v7
v_ldexp_f32 v11, v11, v7
v_accvgpr_write_b32 a84, v10
v_accvgpr_write_b32 a85, v11
v_accvgpr_read_b32 v10, a86
v_accvgpr_read_b32 v11, a87
v_ldexp_f32 v10, v10, v7
v_ldexp_f32 v11, v11, v7
v_accvgpr_write_b32 a86, v10
v_accvgpr_write_b32 a87, v11
v_accvgpr_read_b32 v10, a88
v_accvgpr_read_b32 v11, a89
v_ldexp_f32 v10, v10, v8
v_ldexp_f32 v11, v11, v8
v_accvgpr_write_b32 a88, v10
v_accvgpr_write_b32 a89, v11
v_accvgpr_read_b32 v10, a90
v_accvgpr_read_b32 v11, a91
v_ldexp_f32 v10, v10, v8
v_ldexp_f32 v11, v11, v8
v_accvgpr_write_b32 a90, v10
v_accvgpr_write_b32 a91, v11
v_accvgpr_read_b32 v10, a92
v_accvgpr_read_b32 v11, a93
v_ldexp_f32 v10, v10, v9
v_ldexp_f32 v11, v11, v9
v_accvgpr_write_b32 a92, v10
v_accvgpr_write_b32 a93, v11
v_accvgpr_read_b32 v10, a94
v_accvgpr_read_b32 v11, a95
v_ldexp_f32 v10, v10, v9
v_ldexp_f32 v11, v11, v9
v_accvgpr_write_b32 a94, v10
v_accvgpr_write_b32 a95, v11
v_accvgpr_read_b32 v10, a96
v_accvgpr_read_b32 v11, a97
v_ldexp_f32 v10, v10, v6
v_ldexp_f32 v11, v11, v6
v_accvgpr_write_b32 a96, v10
v_accvgpr_write_b32 a97, v11
v_accvgpr_read_b32 v10, a98
v_accvgpr_read_b32 v11, a99
v_ldexp_f32 v10, v10, v6
v_ldexp_f32 v11, v11, v6
v_accvgpr_write_b32 a98, v10
v_accvgpr_write_b32 a99, v11
v_accvgpr_read_b32 v10, a100
v_accvgpr_read_b32 v11, a101
v_ldexp_f32 v10, v10, v7
v_ldexp_f32 v11, v11, v7
v_accvgpr_write_b32 a100, v10
v_accvgpr_write_b32 a101, v11
v_accvgpr_read_b32 v10, a102
v_accvgpr_read_b32 v11, a103
v_ldexp_f32 v10, v10, v7
v_ldexp_f32 v11, v11, v7
v_accvgpr_write_b32 a102, v10
v_accvgpr_write_b32 a103, v11
v_accvgpr_read_b32 v10, a104
v_accvgpr_read_b32 v11, a105
v_ldexp_f32 v10, v10, v8
v_ldexp_f32 v11, v11, v8
v_accvgpr_write_b32 a104, v10
v_accvgpr_write_b32 a105, v11
v_accvgpr_read_b32 v10, a106
v_accvgpr_read_b32 v11, a107
v_ldexp_f32 v10, v10, v8
v_ldexp_f32 v11, v11, v8
v_accvgpr_write_b32 a106, v10
v_accvgpr_write_b32 a107, v11
v_accvgpr_read_b32 v10, a108
v_accvgpr_read_b32 v11, a109
v_ldexp_f32 v10, v10, v9
v_ldexp_f32 v11, v11, v9
v_accvgpr_write_b32 a108, v10
v_accvgpr_write_b32 a109, v11
v_accvgpr_read_b32 v10, a110
v_accvgpr_read_b32 v11, a111
v_ldexp_f32 v10, v10, v9
v_ldexp_f32 v11, v11, v9
v_accvgpr_write_b32 a110, v10
v_accvgpr_write_b32 a111, v11
v_accvgpr_read_b32 v10, a112
v_accvgpr_read_b32 v11, a113
v_ldexp_f32 v10, v10, v6
v_ldexp_f32 v11, v11, v6
v_accvgpr_write_b32 a112, v10
v_accvgpr_write_b32 a113, v11
v_accvgpr_read_b32 v10, a114
v_accvgpr_read_b32 v11, a115
v_ldexp_f32 v10, v10, v6
v_ldexp_f32 v11, v11, v6
v_accvgpr_write_b32 a114, v10
v_accvgpr_write_b32 a115, v11
v_accvgpr_read_b32 v10, a116
v_accvgpr_read_b32 v11, a117
v_ldexp_f32 v10, v10, v7
v_ldexp_f32 v11, v11, v7
v_accvgpr_write_b32 a116, v10
v_accvgpr_write_b32 a117, v11
v_accvgpr_read_b32 v10, a118
v_accvgpr_read_b32 v11, a119
v_ldexp_f32 v10, v10, v7
v_ldexp_f32 v11, v11, v7
v_accvgpr_write_b32 a118, v10
v_accvgpr_write_b32 a119, v11
v_accvgpr_read_b32 v10, a120
v_accvgpr_read_b32 v11, a121
v_ldexp_f32 v10, v10, v8
v_ldexp_f32 v11, v11, v8
v_accvgpr_write_b32 a120, v10
v_accvgpr_write_b32 a121, v11
v_accvgpr_read_b32 v10, a122
v_accvgpr_read_b32 v11, a123
v_ldexp_f32 v10, v10, v8
v_ldexp_f32 v11, v11, v8
v_accvgpr_write_b32 a122, v10
v_accvgpr_write_b32 a123, v11
v_accvgpr_read_b32 v10, a124
v_accvgpr_read_b32 v11, a125
v_ldexp_f32 v10, v10, v9
v_ldexp_f32 v11, v11, v9
v_accvgpr_write_b32 a124, v10
v_accvgpr_write_b32 a125, v11
v_accvgpr_read_b32 v10, a126
v_accvgpr_read_b32 v11, a127
v_ldexp_f32 v10, v10, v9
v_ldexp_f32 v11, v11, v9
v_accvgpr_write_b32 a126, v10
v_accvgpr_write_b32 a127, v11
v_accvgpr_read_b32 v10, a128
v_accvgpr_read_b32 v11, a129
v_ldexp_f32 v10, v10, v6
v_ldexp_f32 v11, v11, v6
v_accvgpr_write_b32 a128, v10
v_accvgpr_write_b32 a129, v11
v_accvgpr_read_b32 v10, a130
v_accvgpr_read_b32 v11, a131
v_ldexp_f32 v10, v10, v6
v_ldexp_f32 v11, v11, v6
v_accvgpr_write_b32 a130, v10
v_accvgpr_write_b32 a131, v11
v_accvgpr_read_b32 v10, a132
v_accvgpr_read_b32 v11, a133
v_ldexp_f32 v10, v10, v7
v_ldexp_f32 v11, v11, v7
v_accvgpr_write_b32 a132, v10
v_accvgpr_write_b32 a133, v11
v_accvgpr_read_b32 v10, a134
v_accvgpr_read_b32 v11, a135
v_ldexp_f32 v10, v10, v7
v_ldexp_f32 v11, v11, v7
v_accvgpr_write_b32 a134, v10
v_accvgpr_write_b32 a135, v11
v_accvgpr_read_b32 v10, a136
v_accvgpr_read_b32 v11, a137
v_ldexp_f32 v10, v10, v8
v_ldexp_f32 v11, v11, v8
v_accvgpr_write_b32 a136, v10
v_accvgpr_write_b32 a137, v11
v_accvgpr_read_b32 v10, a138
v_accvgpr_read_b32 v11, a139
v_ldexp_f32 v10, v10, v8
v_ldexp_f32 v11, v11, v8
v_accvgpr_write_b32 a138, v10
v_accvgpr_write_b32 a139, v11
v_accvgpr_read_b32 v10, a140
v_accvgpr_read_b32 v11, a141
v_ldexp_f32 v10, v10, v9
v_ldexp_f32 v11, v11, v9
v_accvgpr_write_b32 a140, v10
v_accvgpr_write_b32 a141, v11
v_accvgpr_read_b32 v10, a142
v_accvgpr_read_b32 v11, a143
v_ldexp_f32 v10, v10, v9
v_ldexp_f32 v11, v11, v9
v_accvgpr_write_b32 a142, v10
v_accvgpr_write_b32 a143, v11
v_accvgpr_read_b32 v10, a144
v_accvgpr_read_b32 v11, a145
v_ldexp_f32 v10, v10, v6
v_ldexp_f32 v11, v11, v6
v_accvgpr_write_b32 a144, v10
v_accvgpr_write_b32 a145, v11
v_accvgpr_read_b32 v10, a146
v_accvgpr_read_b32 v11, a147
v_ldexp_f32 v10, v10, v6
v_ldexp_f32 v11, v11, v6
v_accvgpr_write_b32 a146, v10
v_accvgpr_write_b32 a147, v11
v_accvgpr_read_b32 v10, a148
v_accvgpr_read_b32 v11, a149
v_ldexp_f32 v10, v10, v7
v_ldexp_f32 v11, v11, v7
v_accvgpr_write_b32 a148, v10
v_accvgpr_write_b32 a149, v11
v_accvgpr_read_b32 v10, a150
v_accvgpr_read_b32 v11, a151
v_ldexp_f32 v10, v10, v7
v_ldexp_f32 v11, v11, v7
v_accvgpr_write_b32 a150, v10
v_accvgpr_write_b32 a151, v11
v_accvgpr_read_b32 v10, a152
v_accvgpr_read_b32 v11, a153
v_ldexp_f32 v10, v10, v8
v_ldexp_f32 v11, v11, v8
v_accvgpr_write_b32 a152, v10
v_accvgpr_write_b32 a153, v11
v_accvgpr_read_b32 v10, a154
v_accvgpr_read_b32 v11, a155
v_ldexp_f32 v10, v10, v8
v_ldexp_f32 v11, v11, v8
v_accvgpr_write_b32 a154, v10
v_accvgpr_write_b32 a155, v11
v_accvgpr_read_b32 v10, a156
v_accvgpr_read_b32 v11, a157
v_ldexp_f32 v10, v10, v9
v_ldexp_f32 v11, v11, v9
v_accvgpr_write_b32 a156, v10
v_accvgpr_write_b32 a157, v11
v_accvgpr_read_b32 v10, a158
v_accvgpr_read_b32 v11, a159
v_ldexp_f32 v10, v10, v9
v_ldexp_f32 v11, v11, v9
v_accvgpr_write_b32 a158, v10
v_accvgpr_write_b32 a159, v11
v_accvgpr_read_b32 v10, a160
v_accvgpr_read_b32 v11, a161
v_ldexp_f32 v10, v10, v6
v_ldexp_f32 v11, v11, v6
v_accvgpr_write_b32 a160, v10
v_accvgpr_write_b32 a161, v11
v_accvgpr_read_b32 v10, a162
v_accvgpr_read_b32 v11, a163
v_ldexp_f32 v10, v10, v6
v_ldexp_f32 v11, v11, v6
v_accvgpr_write_b32 a162, v10
v_accvgpr_write_b32 a163, v11
v_accvgpr_read_b32 v10, a164
v_accvgpr_read_b32 v11, a165
v_ldexp_f32 v10, v10, v7
v_ldexp_f32 v11, v11, v7
v_accvgpr_write_b32 a164, v10
v_accvgpr_write_b32 a165, v11
v_accvgpr_read_b32 v10, a166
v_accvgpr_read_b32 v11, a167
v_ldexp_f32 v10, v10, v7
v_ldexp_f32 v11, v11, v7
v_accvgpr_write_b32 a166, v10
v_accvgpr_write_b32 a167, v11
v_accvgpr_read_b32 v10, a168
v_accvgpr_read_b32 v11, a169
v_ldexp_f32 v10, v10, v8
v_ldexp_f32 v11, v11, v8
v_accvgpr_write_b32 a168, v10
v_accvgpr_write_b32 a169, v11
v_accvgpr_read_b32 v10, a170
v_accvgpr_read_b32 v11, a171
v_ldexp_f32 v10, v10, v8
v_ldexp_f32 v11, v11, v8
v_accvgpr_write_b32 a170, v10
v_accvgpr_write_b32 a171, v11
v_accvgpr_read_b32 v10, a172
v_accvgpr_read_b32 v11, a173
v_ldexp_f32 v10, v10, v9
v_ldexp_f32 v11, v11, v9
v_accvgpr_write_b32 a172, v10
v_accvgpr_write_b32 a173, v11
v_accvgpr_read_b32 v10, a174
v_accvgpr_read_b32 v11, a175
v_ldexp_f32 v10, v10, v9
v_ldexp_f32 v11, v11, v9
v_accvgpr_write_b32 a174, v10
v_accvgpr_write_b32 a175, v11
v_accvgpr_read_b32 v10, a176
v_accvgpr_read_b32 v11, a177
v_ldexp_f32 v10, v10, v6
v_ldexp_f32 v11, v11, v6
v_accvgpr_write_b32 a176, v10
v_accvgpr_write_b32 a177, v11
v_accvgpr_read_b32 v10, a178
v_accvgpr_read_b32 v11, a179
v_ldexp_f32 v10, v10, v6
v_ldexp_f32 v11, v11, v6
v_accvgpr_write_b32 a178, v10
v_accvgpr_write_b32 a179, v11
v_accvgpr_read_b32 v10, a180
v_accvgpr_read_b32 v11, a181
v_ldexp_f32 v10, v10, v7
v_ldexp_f32 v11, v11, v7
v_accvgpr_write_b32 a180, v10
v_accvgpr_write_b32 a181, v11
v_accvgpr_read_b32 v10, a182
v_accvgpr_read_b32 v11, a183
v_ldexp_f32 v10, v10, v7
v_ldexp_f32 v11, v11, v7
v_accvgpr_write_b32 a182, v10
v_accvgpr_write_b32 a183, v11
v_accvgpr_read_b32 v10, a184
v_accvgpr_read_b32 v11, a185
v_ldexp_f32 v10, v10, v8
v_ldexp_f32 v11, v11, v8
v_accvgpr_write_b32 a184, v10
v_accvgpr_write_b32 a185, v11
v_accvgpr_read_b32 v10, a186
v_accvgpr_read_b32 v11, a187
v_ldexp_f32 v10, v10, v8
v_ldexp_f32 v11, v11, v8
v_accvgpr_write_b32 a186, v10
v_accvgpr_write_b32 a187, v11
v_accvgpr_read_b32 v10, a188
v_accvgpr_read_b32 v11, a189
v_ldexp_f32 v10, v10, v9
v_ldexp_f32 v11, v11, v9
v_accvgpr_write_b32 a188, v10
v_accvgpr_write_b32 a189, v11
v_accvgpr_read_b32 v10, a190
v_accvgpr_read_b32 v11, a191
v_ldexp_f32 v10, v10, v9
v_ldexp_f32 v11, v11, v9
v_accvgpr_write_b32 a190, v10
v_accvgpr_write_b32 a191, v11
v_exp_f32 v224, v64
v_exp_f32 v225, v65
v_exp_f32 v226, v66
v_exp_f32 v227, v67
v_exp_f32 v228, v68
v_exp_f32 v229, v69
v_exp_f32 v230, v70
v_exp_f32 v231, v71
v_add_f32 v232, v224, v225
v_cvt_pk_bf16_f32 v112, v224, v225
v_add_f32 v232, v232, v226
v_add_f32 v232, v232, v227
v_cvt_pk_bf16_f32 v113, v226, v227
v_add_f32 v233, v228, v229
v_cvt_pk_bf16_f32 v116, v228, v229
v_add_f32 v233, v233, v230
v_add_f32 v233, v233, v231
v_cvt_pk_bf16_f32 v117, v230, v231
v_exp_f32 v224, v72
v_exp_f32 v225, v73
v_exp_f32 v226, v74
v_exp_f32 v227, v75
v_exp_f32 v228, v76
v_exp_f32 v229, v77
v_exp_f32 v230, v78
v_exp_f32 v231, v79
v_add_f32 v234, v224, v225
v_cvt_pk_bf16_f32 v120, v224, v225
v_add_f32 v234, v234, v226
v_add_f32 v234, v234, v227
v_cvt_pk_bf16_f32 v121, v226, v227
v_add_f32 v235, v228, v229
v_cvt_pk_bf16_f32 v124, v228, v229
v_add_f32 v235, v235, v230
v_add_f32 v235, v235, v231
v_cvt_pk_bf16_f32 v125, v230, v231
v_exp_f32 v224, v96
v_exp_f32 v225, v97
v_exp_f32 v226, v98
v_exp_f32 v227, v99
v_exp_f32 v228, v100
v_exp_f32 v229, v101
v_exp_f32 v230, v102
v_exp_f32 v231, v103
v_add_f32 v232, v232, v224
v_add_f32 v232, v232, v225
v_cvt_pk_bf16_f32 v114, v224, v225
v_add_f32 v232, v232, v226
v_add_f32 v232, v232, v227
v_cvt_pk_bf16_f32 v115, v226, v227
v_add_f32 v233, v233, v228
v_add_f32 v233, v233, v229
v_cvt_pk_bf16_f32 v118, v228, v229
v_add_f32 v233, v233, v230
v_add_f32 v233, v233, v231
v_cvt_pk_bf16_f32 v119, v230, v231
v_exp_f32 v224, v104
v_exp_f32 v225, v105
v_exp_f32 v226, v106
v_exp_f32 v227, v107
v_exp_f32 v228, v108
v_exp_f32 v229, v109
v_exp_f32 v230, v110
v_exp_f32 v231, v111
v_add_f32 v234, v234, v224
v_add_f32 v234, v234, v225
v_cvt_pk_bf16_f32 v122, v224, v225
v_add_f32 v234, v234, v226
v_add_f32 v234, v234, v227
v_cvt_pk_bf16_f32 v123, v226, v227
v_add_f32 v235, v235, v228
v_add_f32 v235, v235, v229
v_cvt_pk_bf16_f32 v126, v228, v229
v_add_f32 v235, v235, v230
v_add_f32 v235, v235, v231
v_cvt_pk_bf16_f32 v127, v230, v231
s_nop 1
s_setpc_b64 s[64:65]
F_SLOW1:
s_nop 7
s_nop 7
v_max3_f32 v2, v80, v81, v82
v_max3_f32 v2, v2, v83, v96
v_max3_f32 v2, v2, v97, v98
v_max_f32 v2, v2, v99
v_max3_f32 v3, v84, v85, v86
v_max3_f32 v3, v3, v87, v100
v_max3_f32 v3, v3, v101, v102
v_max_f32 v3, v3, v103
v_max3_f32 v4, v88, v89, v90
v_max3_f32 v4, v4, v91, v104
v_max3_f32 v4, v4, v105, v106
v_max_f32 v4, v4, v107
v_max3_f32 v5, v92, v93, v94
v_max3_f32 v5, v5, v95, v108
v_max3_f32 v5, v5, v109, v110
v_max_f32 v5, v5, v111
v_mov_b32 v6, v2
v_mov_b32 v7, v3
v_mov_b32 v8, v4
v_mov_b32 v9, v5
s_nop 1
v_permlane16_swap_b32 v2, v6
v_permlane16_swap_b32 v3, v7
v_permlane16_swap_b32 v4, v8
v_permlane16_swap_b32 v5, v9
v_max_f32 v2, v2, v6
v_max_f32 v3, v3, v7
v_max_f32 v4, v4, v8
v_max_f32 v5, v5, v9
v_mov_b32 v6, v2
v_mov_b32 v7, v3
v_mov_b32 v8, v4
v_mov_b32 v9, v5
s_nop 1
v_permlane32_swap_b32 v2, v6
v_permlane32_swap_b32 v3, v7
v_permlane32_swap_b32 v4, v8
v_permlane32_swap_b32 v5, v9
v_max_f32 v2, v2, v6
v_max_f32 v3, v3, v7
v_max_f32 v4, v4, v8
v_max_f32 v5, v5, v9
v_max_f32 v2, 0, v2
v_ceil_f32 v2, v2
v_sub_f32 v6, 0, v2
v_cvt_i32_f32 v6, v6
v_max_f32 v3, 0, v3
v_ceil_f32 v3, v3
v_sub_f32 v7, 0, v3
v_cvt_i32_f32 v7, v7
v_max_f32 v4, 0, v4
v_ceil_f32 v4, v4
v_sub_f32 v8, 0, v4
v_cvt_i32_f32 v8, v8
v_max_f32 v5, 0, v5
v_ceil_f32 v5, v5
v_sub_f32 v9, 0, v5
v_cvt_i32_f32 v9, v9
v_ldexp_f32 v236, v236, v6
v_sub_f32 v48, v48, v2
v_sub_f32 v49, v49, v2
v_sub_f32 v50, v50, v2
v_sub_f32 v51, v51, v2
v_sub_f32 v80, v80, v2
v_sub_f32 v81, v81, v2
v_sub_f32 v82, v82, v2
v_sub_f32 v83, v83, v2
v_sub_f32 v96, v96, v2
v_sub_f32 v97, v97, v2
v_sub_f32 v98, v98, v2
v_sub_f32 v99, v99, v2
v_sub_f32 v64, v64, v2
v_sub_f32 v65, v65, v2
v_sub_f32 v66, v66, v2
v_sub_f32 v67, v67, v2
v_ldexp_f32 v237, v237, v7
v_sub_f32 v52, v52, v3
v_sub_f32 v53, v53, v3
v_sub_f32 v54, v54, v3
v_sub_f32 v55, v55, v3
v_sub_f32 v84, v84, v3
v_sub_f32 v85, v85, v3
v_sub_f32 v86, v86, v3
v_sub_f32 v87, v87, v3
v_sub_f32 v100, v100, v3
v_sub_f32 v101, v101, v3
v_sub_f32 v102, v102, v3
v_sub_f32 v103, v103, v3
v_sub_f32 v68, v68, v3
v_sub_f32 v69, v69, v3
v_sub_f32 v70, v70, v3
v_sub_f32 v71, v71, v3
v_ldexp_f32 v238, v238, v8
v_sub_f32 v56, v56, v4
v_sub_f32 v57, v57, v4
v_sub_f32 v58, v58, v4
v_sub_f32 v59, v59, v4
v_sub_f32 v88, v88, v4
v_sub_f32 v89, v89, v4
v_sub_f32 v90, v90, v4
v_sub_f32 v91, v91, v4
v_sub_f32 v104, v104, v4
v_sub_f32 v105, v105, v4
v_sub_f32 v106, v106, v4
v_sub_f32 v107, v107, v4
v_sub_f32 v72, v72, v4
v_sub_f32 v73, v73, v4
v_sub_f32 v74, v74, v4
v_sub_f32 v75, v75, v4
v_ldexp_f32 v239, v239, v9
v_sub_f32 v60, v60, v5
v_sub_f32 v61, v61, v5
v_sub_f32 v62, v62, v5
v_sub_f32 v63, v63, v5
v_sub_f32 v92, v92, v5
v_sub_f32 v93, v93, v5
v_sub_f32 v94, v94, v5
v_sub_f32 v95, v95, v5
v_sub_f32 v108, v108, v5
v_sub_f32 v109, v109, v5
v_sub_f32 v110, v110, v5
v_sub_f32 v111, v111, v5
v_sub_f32 v76, v76, v5
v_sub_f32 v77, v77, v5
v_sub_f32 v78, v78, v5
v_sub_f32 v79, v79, v5
v_lshlrev_b32 v10, 16, v112
v_and_b32 v11, 0xffff0000, v112
v_ldexp_f32 v10, v10, v6
v_ldexp_f32 v11, v11, v6
v_cvt_pk_bf16_f32 v112, v10, v11
v_lshlrev_b32 v10, 16, v113
v_and_b32 v11, 0xffff0000, v113
v_ldexp_f32 v10, v10, v6
v_ldexp_f32 v11, v11, v6
v_cvt_pk_bf16_f32 v113, v10, v11
v_lshlrev_b32 v10, 16, v114
v_and_b32 v11, 0xffff0000, v114
v_ldexp_f32 v10, v10, v6
v_ldexp_f32 v11, v11, v6
v_cvt_pk_bf16_f32 v114, v10, v11
v_lshlrev_b32 v10, 16, v115
v_and_b32 v11, 0xffff0000, v115
v_ldexp_f32 v10, v10, v6
v_ldexp_f32 v11, v11, v6
v_cvt_pk_bf16_f32 v115, v10, v11
v_lshlrev_b32 v10, 16, v116
v_and_b32 v11, 0xffff0000, v116
v_ldexp_f32 v10, v10, v7
v_ldexp_f32 v11, v11, v7
v_cvt_pk_bf16_f32 v116, v10, v11
v_lshlrev_b32 v10, 16, v117
v_and_b32 v11, 0xffff0000, v117
v_ldexp_f32 v10, v10, v7
v_ldexp_f32 v11, v11, v7
v_cvt_pk_bf16_f32 v117, v10, v11
v_lshlrev_b32 v10, 16, v118
v_and_b32 v11, 0xffff0000, v118
v_ldexp_f32 v10, v10, v7
v_ldexp_f32 v11, v11, v7
v_cvt_pk_bf16_f32 v118, v10, v11
v_lshlrev_b32 v10, 16, v119
v_and_b32 v11, 0xffff0000, v119
v_ldexp_f32 v10, v10, v7
v_ldexp_f32 v11, v11, v7
v_cvt_pk_bf16_f32 v119, v10, v11
v_lshlrev_b32 v10, 16, v120
v_and_b32 v11, 0xffff0000, v120
v_ldexp_f32 v10, v10, v8
v_ldexp_f32 v11, v11, v8
v_cvt_pk_bf16_f32 v120, v10, v11
v_lshlrev_b32 v10, 16, v121
v_and_b32 v11, 0xffff0000, v121
v_ldexp_f32 v10, v10, v8
v_ldexp_f32 v11, v11, v8
v_cvt_pk_bf16_f32 v121, v10, v11
v_lshlrev_b32 v10, 16, v122
v_and_b32 v11, 0xffff0000, v122
v_ldexp_f32 v10, v10, v8
v_ldexp_f32 v11, v11, v8
v_cvt_pk_bf16_f32 v122, v10, v11
v_lshlrev_b32 v10, 16, v123
v_and_b32 v11, 0xffff0000, v123
v_ldexp_f32 v10, v10, v8
v_ldexp_f32 v11, v11, v8
v_cvt_pk_bf16_f32 v123, v10, v11
v_lshlrev_b32 v10, 16, v124
v_and_b32 v11, 0xffff0000, v124
v_ldexp_f32 v10, v10, v9
v_ldexp_f32 v11, v11, v9
v_cvt_pk_bf16_f32 v124, v10, v11
v_lshlrev_b32 v10, 16, v125
v_and_b32 v11, 0xffff0000, v125
v_ldexp_f32 v10, v10, v9
v_ldexp_f32 v11, v11, v9
v_cvt_pk_bf16_f32 v125, v10, v11
v_lshlrev_b32 v10, 16, v126
v_and_b32 v11, 0xffff0000, v126
v_ldexp_f32 v10, v10, v9
v_ldexp_f32 v11, v11, v9
v_cvt_pk_bf16_f32 v126, v10, v11
v_lshlrev_b32 v10, 16, v127
v_and_b32 v11, 0xffff0000, v127
v_ldexp_f32 v10, v10, v9
v_ldexp_f32 v11, v11, v9
v_cvt_pk_bf16_f32 v127, v10, v11
v_accvgpr_read_b32 v10, a0
v_accvgpr_read_b32 v11, a1
v_ldexp_f32 v10, v10, v6
v_ldexp_f32 v11, v11, v6
v_accvgpr_write_b32 a0, v10
v_accvgpr_write_b32 a1, v11
v_accvgpr_read_b32 v10, a2
v_accvgpr_read_b32 v11, a3
v_ldexp_f32 v10, v10, v6
v_ldexp_f32 v11, v11, v6
v_accvgpr_write_b32 a2, v10
v_accvgpr_write_b32 a3, v11
v_accvgpr_read_b32 v10, a4
v_accvgpr_read_b32 v11, a5
v_ldexp_f32 v10, v10, v7
v_ldexp_f32 v11, v11, v7
v_accvgpr_write_b32 a4, v10
v_accvgpr_write_b32 a5, v11
v_accvgpr_read_b32 v10, a6
v_accvgpr_read_b32 v11, a7
v_ldexp_f32 v10, v10, v7
v_ldexp_f32 v11, v11, v7
v_accvgpr_write_b32 a6, v10
v_accvgpr_write_b32 a7, v11
v_accvgpr_read_b32 v10, a8
v_accvgpr_read_b32 v11, a9
v_ldexp_f32 v10, v10, v8
v_ldexp_f32 v11, v11, v8
v_accvgpr_write_b32 a8, v10
v_accvgpr_write_b32 a9, v11
v_accvgpr_read_b32 v10, a10
v_accvgpr_read_b32 v11, a11
v_ldexp_f32 v10, v10, v8
v_ldexp_f32 v11, v11, v8
v_accvgpr_write_b32 a10, v10
v_accvgpr_write_b32 a11, v11
v_accvgpr_read_b32 v10, a12
v_accvgpr_read_b32 v11, a13
v_ldexp_f32 v10, v10, v9
v_ldexp_f32 v11, v11, v9
v_accvgpr_write_b32 a12, v10
v_accvgpr_write_b32 a13, v11
v_accvgpr_read_b32 v10, a14
v_accvgpr_read_b32 v11, a15
v_ldexp_f32 v10, v10, v9
v_ldexp_f32 v11, v11, v9
v_accvgpr_write_b32 a14, v10
v_accvgpr_write_b32 a15, v11
v_accvgpr_read_b32 v10, a16
v_accvgpr_read_b32 v11, a17
v_ldexp_f32 v10, v10, v6
v_ldexp_f32 v11, v11, v6
v_accvgpr_write_b32 a16, v10
v_accvgpr_write_b32 a17, v11
v_accvgpr_read_b32 v10, a18
v_accvgpr_read_b32 v11, a19
v_ldexp_f32 v10, v10, v6
v_ldexp_f32 v11, v11, v6
v_accvgpr_write_b32 a18, v10
v_accvgpr_write_b32 a19, v11
v_accvgpr_read_b32 v10, a20
v_accvgpr_read_b32 v11, a21
v_ldexp_f32 v10, v10, v7
v_ldexp_f32 v11, v11, v7
v_accvgpr_write_b32 a20, v10
v_accvgpr_write_b32 a21, v11
v_accvgpr_read_b32 v10, a22
v_accvgpr_read_b32 v11, a23
v_ldexp_f32 v10, v10, v7
v_ldexp_f32 v11, v11, v7
v_accvgpr_write_b32 a22, v10
v_accvgpr_write_b32 a23, v11
v_accvgpr_read_b32 v10, a24
v_accvgpr_read_b32 v11, a25
v_ldexp_f32 v10, v10, v8
v_ldexp_f32 v11, v11, v8
v_accvgpr_write_b32 a24, v10
v_accvgpr_write_b32 a25, v11
v_accvgpr_read_b32 v10, a26
v_accvgpr_read_b32 v11, a27
v_ldexp_f32 v10, v10, v8
v_ldexp_f32 v11, v11, v8
v_accvgpr_write_b32 a26, v10
v_accvgpr_write_b32 a27, v11
v_accvgpr_read_b32 v10, a28
v_accvgpr_read_b32 v11, a29
v_ldexp_f32 v10, v10, v9
v_ldexp_f32 v11, v11, v9
v_accvgpr_write_b32 a28, v10
v_accvgpr_write_b32 a29, v11
v_accvgpr_read_b32 v10, a30
v_accvgpr_read_b32 v11, a31
v_ldexp_f32 v10, v10, v9
v_ldexp_f32 v11, v11, v9
v_accvgpr_write_b32 a30, v10
v_accvgpr_write_b32 a31, v11
v_accvgpr_read_b32 v10, a32
v_accvgpr_read_b32 v11, a33
v_ldexp_f32 v10, v10, v6
v_ldexp_f32 v11, v11, v6
v_accvgpr_write_b32 a32, v10
v_accvgpr_write_b32 a33, v11
v_accvgpr_read_b32 v10, a34
v_accvgpr_read_b32 v11, a35
v_ldexp_f32 v10, v10, v6
v_ldexp_f32 v11, v11, v6
v_accvgpr_write_b32 a34, v10
v_accvgpr_write_b32 a35, v11
v_accvgpr_read_b32 v10, a36
v_accvgpr_read_b32 v11, a37
v_ldexp_f32 v10, v10, v7
v_ldexp_f32 v11, v11, v7
v_accvgpr_write_b32 a36, v10
v_accvgpr_write_b32 a37, v11
v_accvgpr_read_b32 v10, a38
v_accvgpr_read_b32 v11, a39
v_ldexp_f32 v10, v10, v7
v_ldexp_f32 v11, v11, v7
v_accvgpr_write_b32 a38, v10
v_accvgpr_write_b32 a39, v11
v_accvgpr_read_b32 v10, a40
v_accvgpr_read_b32 v11, a41
v_ldexp_f32 v10, v10, v8
v_ldexp_f32 v11, v11, v8
v_accvgpr_write_b32 a40, v10
v_accvgpr_write_b32 a41, v11
v_accvgpr_read_b32 v10, a42
v_accvgpr_read_b32 v11, a43
v_ldexp_f32 v10, v10, v8
v_ldexp_f32 v11, v11, v8
v_accvgpr_write_b32 a42, v10
v_accvgpr_write_b32 a43, v11
v_accvgpr_read_b32 v10, a44
v_accvgpr_read_b32 v11, a45
v_ldexp_f32 v10, v10, v9
v_ldexp_f32 v11, v11, v9
v_accvgpr_write_b32 a44, v10
v_accvgpr_write_b32 a45, v11
v_accvgpr_read_b32 v10, a46
v_accvgpr_read_b32 v11, a47
v_ldexp_f32 v10, v10, v9
v_ldexp_f32 v11, v11, v9
v_accvgpr_write_b32 a46, v10
v_accvgpr_write_b32 a47, v11
v_accvgpr_read_b32 v10, a48
v_accvgpr_read_b32 v11, a49
v_ldexp_f32 v10, v10, v6
v_ldexp_f32 v11, v11, v6
v_accvgpr_write_b32 a48, v10
v_accvgpr_write_b32 a49, v11
v_accvgpr_read_b32 v10, a50
v_accvgpr_read_b32 v11, a51
v_ldexp_f32 v10, v10, v6
v_ldexp_f32 v11, v11, v6
v_accvgpr_write_b32 a50, v10
v_accvgpr_write_b32 a51, v11
v_accvgpr_read_b32 v10, a52
v_accvgpr_read_b32 v11, a53
v_ldexp_f32 v10, v10, v7
v_ldexp_f32 v11, v11, v7
v_accvgpr_write_b32 a52, v10
v_accvgpr_write_b32 a53, v11
v_accvgpr_read_b32 v10, a54
v_accvgpr_read_b32 v11, a55
v_ldexp_f32 v10, v10, v7
v_ldexp_f32 v11, v11, v7
v_accvgpr_write_b32 a54, v10
v_accvgpr_write_b32 a55, v11
v_accvgpr_read_b32 v10, a56
v_accvgpr_read_b32 v11, a57
v_ldexp_f32 v10, v10, v8
v_ldexp_f32 v11, v11, v8
v_accvgpr_write_b32 a56, v10
v_accvgpr_write_b32 a57, v11
v_accvgpr_read_b32 v10, a58
v_accvgpr_read_b32 v11, a59
v_ldexp_f32 v10, v10, v8
v_ldexp_f32 v11, v11, v8
v_accvgpr_write_b32 a58, v10
v_accvgpr_write_b32 a59, v11
v_accvgpr_read_b32 v10, a60
v_accvgpr_read_b32 v11, a61
v_ldexp_f32 v10, v10, v9
v_ldexp_f32 v11, v11, v9
v_accvgpr_write_b32 a60, v10
v_accvgpr_write_b32 a61, v11
v_accvgpr_read_b32 v10, a62
v_accvgpr_read_b32 v11, a63
v_ldexp_f32 v10, v10, v9
v_ldexp_f32 v11, v11, v9
v_accvgpr_write_b32 a62, v10
v_accvgpr_write_b32 a63, v11
v_accvgpr_read_b32 v10, a64
v_accvgpr_read_b32 v11, a65
v_ldexp_f32 v10, v10, v6
v_ldexp_f32 v11, v11, v6
v_accvgpr_write_b32 a64, v10
v_accvgpr_write_b32 a65, v11
v_accvgpr_read_b32 v10, a66
v_accvgpr_read_b32 v11, a67
v_ldexp_f32 v10, v10, v6
v_ldexp_f32 v11, v11, v6
v_accvgpr_write_b32 a66, v10
v_accvgpr_write_b32 a67, v11
v_accvgpr_read_b32 v10, a68
v_accvgpr_read_b32 v11, a69
v_ldexp_f32 v10, v10, v7
v_ldexp_f32 v11, v11, v7
v_accvgpr_write_b32 a68, v10
v_accvgpr_write_b32 a69, v11
v_accvgpr_read_b32 v10, a70
v_accvgpr_read_b32 v11, a71
v_ldexp_f32 v10, v10, v7
v_ldexp_f32 v11, v11, v7
v_accvgpr_write_b32 a70, v10
v_accvgpr_write_b32 a71, v11
v_accvgpr_read_b32 v10, a72
v_accvgpr_read_b32 v11, a73
v_ldexp_f32 v10, v10, v8
v_ldexp_f32 v11, v11, v8
v_accvgpr_write_b32 a72, v10
v_accvgpr_write_b32 a73, v11
v_accvgpr_read_b32 v10, a74
v_accvgpr_read_b32 v11, a75
v_ldexp_f32 v10, v10, v8
v_ldexp_f32 v11, v11, v8
v_accvgpr_write_b32 a74, v10
v_accvgpr_write_b32 a75, v11
v_accvgpr_read_b32 v10, a76
v_accvgpr_read_b32 v11, a77
v_ldexp_f32 v10, v10, v9
v_ldexp_f32 v11, v11, v9
v_accvgpr_write_b32 a76, v10
v_accvgpr_write_b32 a77, v11
v_accvgpr_read_b32 v10, a78
v_accvgpr_read_b32 v11, a79
v_ldexp_f32 v10, v10, v9
v_ldexp_f32 v11, v11, v9
v_accvgpr_write_b32 a78, v10
v_accvgpr_write_b32 a79, v11
v_accvgpr_read_b32 v10, a80
v_accvgpr_read_b32 v11, a81
v_ldexp_f32 v10, v10, v6
v_ldexp_f32 v11, v11, v6
v_accvgpr_write_b32 a80, v10
v_accvgpr_write_b32 a81, v11
v_accvgpr_read_b32 v10, a82
v_accvgpr_read_b32 v11, a83
v_ldexp_f32 v10, v10, v6
v_ldexp_f32 v11, v11, v6
v_accvgpr_write_b32 a82, v10
v_accvgpr_write_b32 a83, v11
v_accvgpr_read_b32 v10, a84
v_accvgpr_read_b32 v11, a85
v_ldexp_f32 v10, v10, v7
v_ldexp_f32 v11, v11, v7
v_accvgpr_write_b32 a84, v10
v_accvgpr_write_b32 a85, v11
v_accvgpr_read_b32 v10, a86
v_accvgpr_read_b32 v11, a87
v_ldexp_f32 v10, v10, v7
v_ldexp_f32 v11, v11, v7
v_accvgpr_write_b32 a86, v10
v_accvgpr_write_b32 a87, v11
v_accvgpr_read_b32 v10, a88
v_accvgpr_read_b32 v11, a89
v_ldexp_f32 v10, v10, v8
v_ldexp_f32 v11, v11, v8
v_accvgpr_write_b32 a88, v10
v_accvgpr_write_b32 a89, v11
v_accvgpr_read_b32 v10, a90
v_accvgpr_read_b32 v11, a91
v_ldexp_f32 v10, v10, v8
v_ldexp_f32 v11, v11, v8
v_accvgpr_write_b32 a90, v10
v_accvgpr_write_b32 a91, v11
v_accvgpr_read_b32 v10, a92
v_accvgpr_read_b32 v11, a93
v_ldexp_f32 v10, v10, v9
v_ldexp_f32 v11, v11, v9
v_accvgpr_write_b32 a92, v10
v_accvgpr_write_b32 a93, v11
v_accvgpr_read_b32 v10, a94
v_accvgpr_read_b32 v11, a95
v_ldexp_f32 v10, v10, v9
v_ldexp_f32 v11, v11, v9
v_accvgpr_write_b32 a94, v10
v_accvgpr_write_b32 a95, v11
v_accvgpr_read_b32 v10, a96
v_accvgpr_read_b32 v11, a97
v_ldexp_f32 v10, v10, v6
v_ldexp_f32 v11, v11, v6
v_accvgpr_write_b32 a96, v10
v_accvgpr_write_b32 a97, v11
v_accvgpr_read_b32 v10, a98
v_accvgpr_read_b32 v11, a99
v_ldexp_f32 v10, v10, v6
v_ldexp_f32 v11, v11, v6
v_accvgpr_write_b32 a98, v10
v_accvgpr_write_b32 a99, v11
v_accvgpr_read_b32 v10, a100
v_accvgpr_read_b32 v11, a101
v_ldexp_f32 v10, v10, v7
v_ldexp_f32 v11, v11, v7
v_accvgpr_write_b32 a100, v10
v_accvgpr_write_b32 a101, v11
v_accvgpr_read_b32 v10, a102
v_accvgpr_read_b32 v11, a103
v_ldexp_f32 v10, v10, v7
v_ldexp_f32 v11, v11, v7
v_accvgpr_write_b32 a102, v10
v_accvgpr_write_b32 a103, v11
v_accvgpr_read_b32 v10, a104
v_accvgpr_read_b32 v11, a105
v_ldexp_f32 v10, v10, v8
v_ldexp_f32 v11, v11, v8
v_accvgpr_write_b32 a104, v10
v_accvgpr_write_b32 a105, v11
v_accvgpr_read_b32 v10, a106
v_accvgpr_read_b32 v11, a107
v_ldexp_f32 v10, v10, v8
v_ldexp_f32 v11, v11, v8
v_accvgpr_write_b32 a106, v10
v_accvgpr_write_b32 a107, v11
v_accvgpr_read_b32 v10, a108
v_accvgpr_read_b32 v11, a109
v_ldexp_f32 v10, v10, v9
v_ldexp_f32 v11, v11, v9
v_accvgpr_write_b32 a108, v10
v_accvgpr_write_b32 a109, v11
v_accvgpr_read_b32 v10, a110
v_accvgpr_read_b32 v11, a111
v_ldexp_f32 v10, v10, v9
v_ldexp_f32 v11, v11, v9
v_accvgpr_write_b32 a110, v10
v_accvgpr_write_b32 a111, v11
v_accvgpr_read_b32 v10, a112
v_accvgpr_read_b32 v11, a113
v_ldexp_f32 v10, v10, v6
v_ldexp_f32 v11, v11, v6
v_accvgpr_write_b32 a112, v10
v_accvgpr_write_b32 a113, v11
v_accvgpr_read_b32 v10, a114
v_accvgpr_read_b32 v11, a115
v_ldexp_f32 v10, v10, v6
v_ldexp_f32 v11, v11, v6
v_accvgpr_write_b32 a114, v10
v_accvgpr_write_b32 a115, v11
v_accvgpr_read_b32 v10, a116
v_accvgpr_read_b32 v11, a117
v_ldexp_f32 v10, v10, v7
v_ldexp_f32 v11, v11, v7
v_accvgpr_write_b32 a116, v10
v_accvgpr_write_b32 a117, v11
v_accvgpr_read_b32 v10, a118
v_accvgpr_read_b32 v11, a119
v_ldexp_f32 v10, v10, v7
v_ldexp_f32 v11, v11, v7
v_accvgpr_write_b32 a118, v10
v_accvgpr_write_b32 a119, v11
v_accvgpr_read_b32 v10, a120
v_accvgpr_read_b32 v11, a121
v_ldexp_f32 v10, v10, v8
v_ldexp_f32 v11, v11, v8
v_accvgpr_write_b32 a120, v10
v_accvgpr_write_b32 a121, v11
v_accvgpr_read_b32 v10, a122
v_accvgpr_read_b32 v11, a123
v_ldexp_f32 v10, v10, v8
v_ldexp_f32 v11, v11, v8
v_accvgpr_write_b32 a122, v10
v_accvgpr_write_b32 a123, v11
v_accvgpr_read_b32 v10, a124
v_accvgpr_read_b32 v11, a125
v_ldexp_f32 v10, v10, v9
v_ldexp_f32 v11, v11, v9
v_accvgpr_write_b32 a124, v10
v_accvgpr_write_b32 a125, v11
v_accvgpr_read_b32 v10, a126
v_accvgpr_read_b32 v11, a127
v_ldexp_f32 v10, v10, v9
v_ldexp_f32 v11, v11, v9
v_accvgpr_write_b32 a126, v10
v_accvgpr_write_b32 a127, v11
v_accvgpr_read_b32 v10, a128
v_accvgpr_read_b32 v11, a129
v_ldexp_f32 v10, v10, v6
v_ldexp_f32 v11, v11, v6
v_accvgpr_write_b32 a128, v10
v_accvgpr_write_b32 a129, v11
v_accvgpr_read_b32 v10, a130
v_accvgpr_read_b32 v11, a131
v_ldexp_f32 v10, v10, v6
v_ldexp_f32 v11, v11, v6
v_accvgpr_write_b32 a130, v10
v_accvgpr_write_b32 a131, v11
v_accvgpr_read_b32 v10, a132
v_accvgpr_read_b32 v11, a133
v_ldexp_f32 v10, v10, v7
v_ldexp_f32 v11, v11, v7
v_accvgpr_write_b32 a132, v10
v_accvgpr_write_b32 a133, v11
v_accvgpr_read_b32 v10, a134
v_accvgpr_read_b32 v11, a135
v_ldexp_f32 v10, v10, v7
v_ldexp_f32 v11, v11, v7
v_accvgpr_write_b32 a134, v10
v_accvgpr_write_b32 a135, v11
v_accvgpr_read_b32 v10, a136
v_accvgpr_read_b32 v11, a137
v_ldexp_f32 v10, v10, v8
v_ldexp_f32 v11, v11, v8
v_accvgpr_write_b32 a136, v10
v_accvgpr_write_b32 a137, v11
v_accvgpr_read_b32 v10, a138
v_accvgpr_read_b32 v11, a139
v_ldexp_f32 v10, v10, v8
v_ldexp_f32 v11, v11, v8
v_accvgpr_write_b32 a138, v10
v_accvgpr_write_b32 a139, v11
v_accvgpr_read_b32 v10, a140
v_accvgpr_read_b32 v11, a141
v_ldexp_f32 v10, v10, v9
v_ldexp_f32 v11, v11, v9
v_accvgpr_write_b32 a140, v10
v_accvgpr_write_b32 a141, v11
v_accvgpr_read_b32 v10, a142
v_accvgpr_read_b32 v11, a143
v_ldexp_f32 v10, v10, v9
v_ldexp_f32 v11, v11, v9
v_accvgpr_write_b32 a142, v10
v_accvgpr_write_b32 a143, v11
v_accvgpr_read_b32 v10, a144
v_accvgpr_read_b32 v11, a145
v_ldexp_f32 v10, v10, v6
v_ldexp_f32 v11, v11, v6
v_accvgpr_write_b32 a144, v10
v_accvgpr_write_b32 a145, v11
v_accvgpr_read_b32 v10, a146
v_accvgpr_read_b32 v11, a147
v_ldexp_f32 v10, v10, v6
v_ldexp_f32 v11, v11, v6
v_accvgpr_write_b32 a146, v10
v_accvgpr_write_b32 a147, v11
v_accvgpr_read_b32 v10, a148
v_accvgpr_read_b32 v11, a149
v_ldexp_f32 v10, v10, v7
v_ldexp_f32 v11, v11, v7
v_accvgpr_write_b32 a148, v10
v_accvgpr_write_b32 a149, v11
v_accvgpr_read_b32 v10, a150
v_accvgpr_read_b32 v11, a151
v_ldexp_f32 v10, v10, v7
v_ldexp_f32 v11, v11, v7
v_accvgpr_write_b32 a150, v10
v_accvgpr_write_b32 a151, v11
v_accvgpr_read_b32 v10, a152
v_accvgpr_read_b32 v11, a153
v_ldexp_f32 v10, v10, v8
v_ldexp_f32 v11, v11, v8
v_accvgpr_write_b32 a152, v10
v_accvgpr_write_b32 a153, v11
v_accvgpr_read_b32 v10, a154
v_accvgpr_read_b32 v11, a155
v_ldexp_f32 v10, v10, v8
v_ldexp_f32 v11, v11, v8
v_accvgpr_write_b32 a154, v10
v_accvgpr_write_b32 a155, v11
v_accvgpr_read_b32 v10, a156
v_accvgpr_read_b32 v11, a157
v_ldexp_f32 v10, v10, v9
v_ldexp_f32 v11, v11, v9
v_accvgpr_write_b32 a156, v10
v_accvgpr_write_b32 a157, v11
v_accvgpr_read_b32 v10, a158
v_accvgpr_read_b32 v11, a159
v_ldexp_f32 v10, v10, v9
v_ldexp_f32 v11, v11, v9
v_accvgpr_write_b32 a158, v10
v_accvgpr_write_b32 a159, v11
v_accvgpr_read_b32 v10, a160
v_accvgpr_read_b32 v11, a161
v_ldexp_f32 v10, v10, v6
v_ldexp_f32 v11, v11, v6
v_accvgpr_write_b32 a160, v10
v_accvgpr_write_b32 a161, v11
v_accvgpr_read_b32 v10, a162
v_accvgpr_read_b32 v11, a163
v_ldexp_f32 v10, v10, v6
v_ldexp_f32 v11, v11, v6
v_accvgpr_write_b32 a162, v10
v_accvgpr_write_b32 a163, v11
v_accvgpr_read_b32 v10, a164
v_accvgpr_read_b32 v11, a165
v_ldexp_f32 v10, v10, v7
v_ldexp_f32 v11, v11, v7
v_accvgpr_write_b32 a164, v10
v_accvgpr_write_b32 a165, v11
v_accvgpr_read_b32 v10, a166
v_accvgpr_read_b32 v11, a167
v_ldexp_f32 v10, v10, v7
v_ldexp_f32 v11, v11, v7
v_accvgpr_write_b32 a166, v10
v_accvgpr_write_b32 a167, v11
v_accvgpr_read_b32 v10, a168
v_accvgpr_read_b32 v11, a169
v_ldexp_f32 v10, v10, v8
v_ldexp_f32 v11, v11, v8
v_accvgpr_write_b32 a168, v10
v_accvgpr_write_b32 a169, v11
v_accvgpr_read_b32 v10, a170
v_accvgpr_read_b32 v11, a171
v_ldexp_f32 v10, v10, v8
v_ldexp_f32 v11, v11, v8
v_accvgpr_write_b32 a170, v10
v_accvgpr_write_b32 a171, v11
v_accvgpr_read_b32 v10, a172
v_accvgpr_read_b32 v11, a173
v_ldexp_f32 v10, v10, v9
v_ldexp_f32 v11, v11, v9
v_accvgpr_write_b32 a172, v10
v_accvgpr_write_b32 a173, v11
v_accvgpr_read_b32 v10, a174
v_accvgpr_read_b32 v11, a175
v_ldexp_f32 v10, v10, v9
v_ldexp_f32 v11, v11, v9
v_accvgpr_write_b32 a174, v10
v_accvgpr_write_b32 a175, v11
v_accvgpr_read_b32 v10, a176
v_accvgpr_read_b32 v11, a177
v_ldexp_f32 v10, v10, v6
v_ldexp_f32 v11, v11, v6
v_accvgpr_write_b32 a176, v10
v_accvgpr_write_b32 a177, v11
v_accvgpr_read_b32 v10, a178
v_accvgpr_read_b32 v11, a179
v_ldexp_f32 v10, v10, v6
v_ldexp_f32 v11, v11, v6
v_accvgpr_write_b32 a178, v10
v_accvgpr_write_b32 a179, v11
v_accvgpr_read_b32 v10, a180
v_accvgpr_read_b32 v11, a181
v_ldexp_f32 v10, v10, v7
v_ldexp_f32 v11, v11, v7
v_accvgpr_write_b32 a180, v10
v_accvgpr_write_b32 a181, v11
v_accvgpr_read_b32 v10, a182
v_accvgpr_read_b32 v11, a183
v_ldexp_f32 v10, v10, v7
v_ldexp_f32 v11, v11, v7
v_accvgpr_write_b32 a182, v10
v_accvgpr_write_b32 a183, v11
v_accvgpr_read_b32 v10, a184
v_accvgpr_read_b32 v11, a185
v_ldexp_f32 v10, v10, v8
v_ldexp_f32 v11, v11, v8
v_accvgpr_write_b32 a184, v10
v_accvgpr_write_b32 a185, v11
v_accvgpr_read_b32 v10, a186
v_accvgpr_read_b32 v11, a187
v_ldexp_f32 v10, v10, v8
v_ldexp_f32 v11, v11, v8
v_accvgpr_write_b32 a186, v10
v_accvgpr_write_b32 a187, v11
v_accvgpr_read_b32 v10, a188
v_accvgpr_read_b32 v11, a189
v_ldexp_f32 v10, v10, v9
v_ldexp_f32 v11, v11, v9
v_accvgpr_write_b32 a188, v10
v_accvgpr_write_b32 a189, v11
v_accvgpr_read_b32 v10, a190
v_accvgpr_read_b32 v11, a191
v_ldexp_f32 v10, v10, v9
v_ldexp_f32 v11, v11, v9
v_accvgpr_write_b32 a190, v10
v_accvgpr_write_b32 a191, v11
v_exp_f32 v224, v80
v_exp_f32 v225, v81
v_exp_f32 v226, v82
v_exp_f32 v227, v83
v_exp_f32 v228, v84
v_exp_f32 v229, v85
v_exp_f32 v230, v86
v_exp_f32 v231, v87
v_add_f32 v232, v224, v225
v_cvt_pk_bf16_f32 v128, v224, v225
v_add_f32 v232, v232, v226
v_add_f32 v232, v232, v227
v_cvt_pk_bf16_f32 v129, v226, v227
v_add_f32 v233, v228, v229
v_cvt_pk_bf16_f32 v132, v228, v229
v_add_f32 v233, v233, v230
v_add_f32 v233, v233, v231
v_cvt_pk_bf16_f32 v133, v230, v231
v_exp_f32 v224, v88
v_exp_f32 v225, v89
v_exp_f32 v226, v90
v_exp_f32 v227, v91
v_exp_f32 v228, v92
v_exp_f32 v229, v93
v_exp_f32 v230, v94
v_exp_f32 v231, v95
v_add_f32 v234, v224, v225
v_cvt_pk_bf16_f32 v136, v224, v225
v_add_f32 v234, v234, v226
v_add_f32 v234, v234, v227
v_cvt_pk_bf16_f32 v137, v226, v227
v_add_f32 v235, v228, v229
v_cvt_pk_bf16_f32 v140, v228, v229
v_add_f32 v235, v235, v230
v_add_f32 v235, v235, v231
v_cvt_pk_bf16_f32 v141, v230, v231
v_exp_f32 v224, v96
v_exp_f32 v225, v97
v_exp_f32 v226, v98
v_exp_f32 v227, v99
v_exp_f32 v228, v100
v_exp_f32 v229, v101
v_exp_f32 v230, v102
v_exp_f32 v231, v103
v_add_f32 v232, v232, v224
v_add_f32 v232, v232, v225
v_cvt_pk_bf16_f32 v130, v224, v225
v_add_f32 v232, v232, v226
v_add_f32 v232, v232, v227
v_cvt_pk_bf16_f32 v131, v226, v227
v_add_f32 v233, v233, v228
v_add_f32 v233, v233, v229
v_cvt_pk_bf16_f32 v134, v228, v229
v_add_f32 v233, v233, v230
v_add_f32 v233, v233, v231
v_cvt_pk_bf16_f32 v135, v230, v231
v_exp_f32 v224, v104
v_exp_f32 v225, v105
v_exp_f32 v226, v106
v_exp_f32 v227, v107
v_exp_f32 v228, v108
v_exp_f32 v229, v109
v_exp_f32 v230, v110
v_exp_f32 v231, v111
v_add_f32 v234, v234, v224
v_add_f32 v234, v234, v225
v_cvt_pk_bf16_f32 v138, v224, v225
v_add_f32 v234, v234, v226
v_add_f32 v234, v234, v227
v_cvt_pk_bf16_f32 v139, v226, v227
v_add_f32 v235, v235, v228
v_add_f32 v235, v235, v229
v_cvt_pk_bf16_f32 v142, v228, v229
v_add_f32 v235, v235, v230
v_add_f32 v235, v235, v231
v_cvt_pk_bf16_f32 v143, v230, v231
s_nop 1
s_setpc_b64 s[64:65]
F_SLOW2:
s_nop 7
s_nop 7
v_max3_f32 v2, v64, v65, v66
v_max3_f32 v2, v2, v67, v96
v_max3_f32 v2, v2, v97, v98
v_max_f32 v2, v2, v99
v_max3_f32 v3, v68, v69, v70
v_max3_f32 v3, v3, v71, v100
v_max3_f32 v3, v3, v101, v102
v_max_f32 v3, v3, v103
v_max3_f32 v4, v72, v73, v74
v_max3_f32 v4, v4, v75, v104
v_max3_f32 v4, v4, v105, v106
v_max_f32 v4, v4, v107
v_max3_f32 v5, v76, v77, v78
v_max3_f32 v5, v5, v79, v108
v_max3_f32 v5, v5, v109, v110
v_max_f32 v5, v5, v111
v_mov_b32 v6, v2
v_mov_b32 v7, v3
v_mov_b32 v8, v4
v_mov_b32 v9, v5
s_nop 1
v_permlane16_swap_b32 v2, v6
v_permlane16_swap_b32 v3, v7
v_permlane16_swap_b32 v4, v8
v_permlane16_swap_b32 v5, v9
v_max_f32 v2, v2, v6
v_max_f32 v3, v3, v7
v_max_f32 v4, v4, v8
v_max_f32 v5, v5, v9
v_mov_b32 v6, v2
v_mov_b32 v7, v3
v_mov_b32 v8, v4
v_mov_b32 v9, v5
s_nop 1
v_permlane32_swap_b32 v2, v6
v_permlane32_swap_b32 v3, v7
v_permlane32_swap_b32 v4, v8
v_permlane32_swap_b32 v5, v9
v_max_f32 v2, v2, v6
v_max_f32 v3, v3, v7
v_max_f32 v4, v4, v8
v_max_f32 v5, v5, v9
v_max_f32 v2, 0, v2
v_ceil_f32 v2, v2
v_sub_f32 v6, 0, v2
v_cvt_i32_f32 v6, v6
v_max_f32 v3, 0, v3
v_ceil_f32 v3, v3
v_sub_f32 v7, 0, v3
v_cvt_i32_f32 v7, v7
v_max_f32 v4, 0, v4
v_ceil_f32 v4, v4
v_sub_f32 v8, 0, v4
v_cvt_i32_f32 v8, v8
v_max_f32 v5, 0, v5
v_ceil_f32 v5, v5
v_sub_f32 v9, 0, v5
v_cvt_i32_f32 v9, v9
v_ldexp_f32 v236, v236, v6
v_sub_f32 v48, v48, v2
v_sub_f32 v49, v49, v2
v_sub_f32 v50, v50, v2
v_sub_f32 v51, v51, v2
v_sub_f32 v64, v64, v2
v_sub_f32 v65, v65, v2
v_sub_f32 v66, v66, v2
v_sub_f32 v67, v67, v2
v_sub_f32 v96, v96, v2
v_sub_f32 v97, v97, v2
v_sub_f32 v98, v98, v2
v_sub_f32 v99, v99, v2
v_sub_f32 v80, v80, v2
v_sub_f32 v81, v81, v2
v_sub_f32 v82, v82, v2
v_sub_f32 v83, v83, v2
v_ldexp_f32 v237, v237, v7
v_sub_f32 v52, v52, v3
v_sub_f32 v53, v53, v3
v_sub_f32 v54, v54, v3
v_sub_f32 v55, v55, v3
v_sub_f32 v68, v68, v3
v_sub_f32 v69, v69, v3
v_sub_f32 v70, v70, v3
v_sub_f32 v71, v71, v3
v_sub_f32 v100, v100, v3
v_sub_f32 v101, v101, v3
v_sub_f32 v102, v102, v3
v_sub_f32 v103, v103, v3
v_sub_f32 v84, v84, v3
v_sub_f32 v85, v85, v3
v_sub_f32 v86, v86, v3
v_sub_f32 v87, v87, v3
v_ldexp_f32 v238, v238, v8
v_sub_f32 v56, v56, v4
v_sub_f32 v57, v57, v4
v_sub_f32 v58, v58, v4
v_sub_f32 v59, v59, v4
v_sub_f32 v72, v72, v4
v_sub_f32 v73, v73, v4
v_sub_f32 v74, v74, v4
v_sub_f32 v75, v75, v4
v_sub_f32 v104, v104, v4
v_sub_f32 v105, v105, v4
v_sub_f32 v106, v106, v4
v_sub_f32 v107, v107, v4
v_sub_f32 v88, v88, v4
v_sub_f32 v89, v89, v4
v_sub_f32 v90, v90, v4
v_sub_f32 v91, v91, v4
v_ldexp_f32 v239, v239, v9
v_sub_f32 v60, v60, v5
v_sub_f32 v61, v61, v5
v_sub_f32 v62, v62, v5
v_sub_f32 v63, v63, v5
v_sub_f32 v76, v76, v5
v_sub_f32 v77, v77, v5
v_sub_f32 v78, v78, v5
v_sub_f32 v79, v79, v5
v_sub_f32 v108, v108, v5
v_sub_f32 v109, v109, v5
v_sub_f32 v110, v110, v5
v_sub_f32 v111, v111, v5
v_sub_f32 v92, v92, v5
v_sub_f32 v93, v93, v5
v_sub_f32 v94, v94, v5
v_sub_f32 v95, v95, v5
v_lshlrev_b32 v10, 16, v128
v_and_b32 v11, 0xffff0000, v128
v_ldexp_f32 v10, v10, v6
v_ldexp_f32 v11, v11, v6
v_cvt_pk_bf16_f32 v128, v10, v11
v_lshlrev_b32 v10, 16, v129
v_and_b32 v11, 0xffff0000, v129
v_ldexp_f32 v10, v10, v6
v_ldexp_f32 v11, v11, v6
v_cvt_pk_bf16_f32 v129, v10, v11
v_lshlrev_b32 v10, 16, v130
v_and_b32 v11, 0xffff0000, v130
v_ldexp_f32 v10, v10, v6
v_ldexp_f32 v11, v11, v6
v_cvt_pk_bf16_f32 v130, v10, v11
v_lshlrev_b32 v10, 16, v131
v_and_b32 v11, 0xffff0000, v131
v_ldexp_f32 v10, v10, v6
v_ldexp_f32 v11, v11, v6
v_cvt_pk_bf16_f32 v131, v10, v11
v_lshlrev_b32 v10, 16, v132
v_and_b32 v11, 0xffff0000, v132
v_ldexp_f32 v10, v10, v7
v_ldexp_f32 v11, v11, v7
v_cvt_pk_bf16_f32 v132, v10, v11
v_lshlrev_b32 v10, 16, v133
v_and_b32 v11, 0xffff0000, v133
v_ldexp_f32 v10, v10, v7
v_ldexp_f32 v11, v11, v7
v_cvt_pk_bf16_f32 v133, v10, v11
v_lshlrev_b32 v10, 16, v134
v_and_b32 v11, 0xffff0000, v134
v_ldexp_f32 v10, v10, v7
v_ldexp_f32 v11, v11, v7
v_cvt_pk_bf16_f32 v134, v10, v11
v_lshlrev_b32 v10, 16, v135
v_and_b32 v11, 0xffff0000, v135
v_ldexp_f32 v10, v10, v7
v_ldexp_f32 v11, v11, v7
v_cvt_pk_bf16_f32 v135, v10, v11
v_lshlrev_b32 v10, 16, v136
v_and_b32 v11, 0xffff0000, v136
v_ldexp_f32 v10, v10, v8
v_ldexp_f32 v11, v11, v8
v_cvt_pk_bf16_f32 v136, v10, v11
v_lshlrev_b32 v10, 16, v137
v_and_b32 v11, 0xffff0000, v137
v_ldexp_f32 v10, v10, v8
v_ldexp_f32 v11, v11, v8
v_cvt_pk_bf16_f32 v137, v10, v11
v_lshlrev_b32 v10, 16, v138
v_and_b32 v11, 0xffff0000, v138
v_ldexp_f32 v10, v10, v8
v_ldexp_f32 v11, v11, v8
v_cvt_pk_bf16_f32 v138, v10, v11
v_lshlrev_b32 v10, 16, v139
v_and_b32 v11, 0xffff0000, v139
v_ldexp_f32 v10, v10, v8
v_ldexp_f32 v11, v11, v8
v_cvt_pk_bf16_f32 v139, v10, v11
v_lshlrev_b32 v10, 16, v140
v_and_b32 v11, 0xffff0000, v140
v_ldexp_f32 v10, v10, v9
v_ldexp_f32 v11, v11, v9
v_cvt_pk_bf16_f32 v140, v10, v11
v_lshlrev_b32 v10, 16, v141
v_and_b32 v11, 0xffff0000, v141
v_ldexp_f32 v10, v10, v9
v_ldexp_f32 v11, v11, v9
v_cvt_pk_bf16_f32 v141, v10, v11
v_lshlrev_b32 v10, 16, v142
v_and_b32 v11, 0xffff0000, v142
v_ldexp_f32 v10, v10, v9
v_ldexp_f32 v11, v11, v9
v_cvt_pk_bf16_f32 v142, v10, v11
v_lshlrev_b32 v10, 16, v143
v_and_b32 v11, 0xffff0000, v143
v_ldexp_f32 v10, v10, v9
v_ldexp_f32 v11, v11, v9
v_cvt_pk_bf16_f32 v143, v10, v11
v_lshlrev_b32 v10, 16, v112
v_and_b32 v11, 0xffff0000, v112
v_ldexp_f32 v10, v10, v6
v_ldexp_f32 v11, v11, v6
v_cvt_pk_bf16_f32 v112, v10, v11
v_lshlrev_b32 v10, 16, v113
v_and_b32 v11, 0xffff0000, v113
v_ldexp_f32 v10, v10, v6
v_ldexp_f32 v11, v11, v6
v_cvt_pk_bf16_f32 v113, v10, v11
v_lshlrev_b32 v10, 16, v114
v_and_b32 v11, 0xffff0000, v114
v_ldexp_f32 v10, v10, v6
v_ldexp_f32 v11, v11, v6
v_cvt_pk_bf16_f32 v114, v10, v11
v_lshlrev_b32 v10, 16, v115
v_and_b32 v11, 0xffff0000, v115
v_ldexp_f32 v10, v10, v6
v_ldexp_f32 v11, v11, v6
v_cvt_pk_bf16_f32 v115, v10, v11
v_lshlrev_b32 v10, 16, v116
v_and_b32 v11, 0xffff0000, v116
v_ldexp_f32 v10, v10, v7
v_ldexp_f32 v11, v11, v7
v_cvt_pk_bf16_f32 v116, v10, v11
v_lshlrev_b32 v10, 16, v117
v_and_b32 v11, 0xffff0000, v117
v_ldexp_f32 v10, v10, v7
v_ldexp_f32 v11, v11, v7
v_cvt_pk_bf16_f32 v117, v10, v11
v_lshlrev_b32 v10, 16, v118
v_and_b32 v11, 0xffff0000, v118
v_ldexp_f32 v10, v10, v7
v_ldexp_f32 v11, v11, v7
v_cvt_pk_bf16_f32 v118, v10, v11
v_lshlrev_b32 v10, 16, v119
v_and_b32 v11, 0xffff0000, v119
v_ldexp_f32 v10, v10, v7
v_ldexp_f32 v11, v11, v7
v_cvt_pk_bf16_f32 v119, v10, v11
v_lshlrev_b32 v10, 16, v120
v_and_b32 v11, 0xffff0000, v120
v_ldexp_f32 v10, v10, v8
v_ldexp_f32 v11, v11, v8
v_cvt_pk_bf16_f32 v120, v10, v11
v_lshlrev_b32 v10, 16, v121
v_and_b32 v11, 0xffff0000, v121
v_ldexp_f32 v10, v10, v8
v_ldexp_f32 v11, v11, v8
v_cvt_pk_bf16_f32 v121, v10, v11
v_lshlrev_b32 v10, 16, v122
v_and_b32 v11, 0xffff0000, v122
v_ldexp_f32 v10, v10, v8
v_ldexp_f32 v11, v11, v8
v_cvt_pk_bf16_f32 v122, v10, v11
v_lshlrev_b32 v10, 16, v123
v_and_b32 v11, 0xffff0000, v123
v_ldexp_f32 v10, v10, v8
v_ldexp_f32 v11, v11, v8
v_cvt_pk_bf16_f32 v123, v10, v11
v_lshlrev_b32 v10, 16, v124
v_and_b32 v11, 0xffff0000, v124
v_ldexp_f32 v10, v10, v9
v_ldexp_f32 v11, v11, v9
v_cvt_pk_bf16_f32 v124, v10, v11
v_lshlrev_b32 v10, 16, v125
v_and_b32 v11, 0xffff0000, v125
v_ldexp_f32 v10, v10, v9
v_ldexp_f32 v11, v11, v9
v_cvt_pk_bf16_f32 v125, v10, v11
v_lshlrev_b32 v10, 16, v126
v_and_b32 v11, 0xffff0000, v126
v_ldexp_f32 v10, v10, v9
v_ldexp_f32 v11, v11, v9
v_cvt_pk_bf16_f32 v126, v10, v11
v_lshlrev_b32 v10, 16, v127
v_and_b32 v11, 0xffff0000, v127
v_ldexp_f32 v10, v10, v9
v_ldexp_f32 v11, v11, v9
v_cvt_pk_bf16_f32 v127, v10, v11
v_accvgpr_read_b32 v10, a0
v_accvgpr_read_b32 v11, a1
v_ldexp_f32 v10, v10, v6
v_ldexp_f32 v11, v11, v6
v_accvgpr_write_b32 a0, v10
v_accvgpr_write_b32 a1, v11
v_accvgpr_read_b32 v10, a2
v_accvgpr_read_b32 v11, a3
v_ldexp_f32 v10, v10, v6
v_ldexp_f32 v11, v11, v6
v_accvgpr_write_b32 a2, v10
v_accvgpr_write_b32 a3, v11
v_accvgpr_read_b32 v10, a4
v_accvgpr_read_b32 v11, a5
v_ldexp_f32 v10, v10, v7
v_ldexp_f32 v11, v11, v7
v_accvgpr_write_b32 a4, v10
v_accvgpr_write_b32 a5, v11
v_accvgpr_read_b32 v10, a6
v_accvgpr_read_b32 v11, a7
v_ldexp_f32 v10, v10, v7
v_ldexp_f32 v11, v11, v7
v_accvgpr_write_b32 a6, v10
v_accvgpr_write_b32 a7, v11
v_accvgpr_read_b32 v10, a8
v_accvgpr_read_b32 v11, a9
v_ldexp_f32 v10, v10, v8
v_ldexp_f32 v11, v11, v8
v_accvgpr_write_b32 a8, v10
v_accvgpr_write_b32 a9, v11
v_accvgpr_read_b32 v10, a10
v_accvgpr_read_b32 v11, a11
v_ldexp_f32 v10, v10, v8
v_ldexp_f32 v11, v11, v8
v_accvgpr_write_b32 a10, v10
v_accvgpr_write_b32 a11, v11
v_accvgpr_read_b32 v10, a12
v_accvgpr_read_b32 v11, a13
v_ldexp_f32 v10, v10, v9
v_ldexp_f32 v11, v11, v9
v_accvgpr_write_b32 a12, v10
v_accvgpr_write_b32 a13, v11
v_accvgpr_read_b32 v10, a14
v_accvgpr_read_b32 v11, a15
v_ldexp_f32 v10, v10, v9
v_ldexp_f32 v11, v11, v9
v_accvgpr_write_b32 a14, v10
v_accvgpr_write_b32 a15, v11
v_accvgpr_read_b32 v10, a16
v_accvgpr_read_b32 v11, a17
v_ldexp_f32 v10, v10, v6
v_ldexp_f32 v11, v11, v6
v_accvgpr_write_b32 a16, v10
v_accvgpr_write_b32 a17, v11
v_accvgpr_read_b32 v10, a18
v_accvgpr_read_b32 v11, a19
v_ldexp_f32 v10, v10, v6
v_ldexp_f32 v11, v11, v6
v_accvgpr_write_b32 a18, v10
v_accvgpr_write_b32 a19, v11
v_accvgpr_read_b32 v10, a20
v_accvgpr_read_b32 v11, a21
v_ldexp_f32 v10, v10, v7
v_ldexp_f32 v11, v11, v7
v_accvgpr_write_b32 a20, v10
v_accvgpr_write_b32 a21, v11
v_accvgpr_read_b32 v10, a22
v_accvgpr_read_b32 v11, a23
v_ldexp_f32 v10, v10, v7
v_ldexp_f32 v11, v11, v7
v_accvgpr_write_b32 a22, v10
v_accvgpr_write_b32 a23, v11
v_accvgpr_read_b32 v10, a24
v_accvgpr_read_b32 v11, a25
v_ldexp_f32 v10, v10, v8
v_ldexp_f32 v11, v11, v8
v_accvgpr_write_b32 a24, v10
v_accvgpr_write_b32 a25, v11
v_accvgpr_read_b32 v10, a26
v_accvgpr_read_b32 v11, a27
v_ldexp_f32 v10, v10, v8
v_ldexp_f32 v11, v11, v8
v_accvgpr_write_b32 a26, v10
v_accvgpr_write_b32 a27, v11
v_accvgpr_read_b32 v10, a28
v_accvgpr_read_b32 v11, a29
v_ldexp_f32 v10, v10, v9
v_ldexp_f32 v11, v11, v9
v_accvgpr_write_b32 a28, v10
v_accvgpr_write_b32 a29, v11
v_accvgpr_read_b32 v10, a30
v_accvgpr_read_b32 v11, a31
v_ldexp_f32 v10, v10, v9
v_ldexp_f32 v11, v11, v9
v_accvgpr_write_b32 a30, v10
v_accvgpr_write_b32 a31, v11
v_accvgpr_read_b32 v10, a32
v_accvgpr_read_b32 v11, a33
v_ldexp_f32 v10, v10, v6
v_ldexp_f32 v11, v11, v6
v_accvgpr_write_b32 a32, v10
v_accvgpr_write_b32 a33, v11
v_accvgpr_read_b32 v10, a34
v_accvgpr_read_b32 v11, a35
v_ldexp_f32 v10, v10, v6
v_ldexp_f32 v11, v11, v6
v_accvgpr_write_b32 a34, v10
v_accvgpr_write_b32 a35, v11
v_accvgpr_read_b32 v10, a36
v_accvgpr_read_b32 v11, a37
v_ldexp_f32 v10, v10, v7
v_ldexp_f32 v11, v11, v7
v_accvgpr_write_b32 a36, v10
v_accvgpr_write_b32 a37, v11
v_accvgpr_read_b32 v10, a38
v_accvgpr_read_b32 v11, a39
v_ldexp_f32 v10, v10, v7
v_ldexp_f32 v11, v11, v7
v_accvgpr_write_b32 a38, v10
v_accvgpr_write_b32 a39, v11
v_accvgpr_read_b32 v10, a40
v_accvgpr_read_b32 v11, a41
v_ldexp_f32 v10, v10, v8
v_ldexp_f32 v11, v11, v8
v_accvgpr_write_b32 a40, v10
v_accvgpr_write_b32 a41, v11
v_accvgpr_read_b32 v10, a42
v_accvgpr_read_b32 v11, a43
v_ldexp_f32 v10, v10, v8
v_ldexp_f32 v11, v11, v8
v_accvgpr_write_b32 a42, v10
v_accvgpr_write_b32 a43, v11
v_accvgpr_read_b32 v10, a44
v_accvgpr_read_b32 v11, a45
v_ldexp_f32 v10, v10, v9
v_ldexp_f32 v11, v11, v9
v_accvgpr_write_b32 a44, v10
v_accvgpr_write_b32 a45, v11
v_accvgpr_read_b32 v10, a46
v_accvgpr_read_b32 v11, a47
v_ldexp_f32 v10, v10, v9
v_ldexp_f32 v11, v11, v9
v_accvgpr_write_b32 a46, v10
v_accvgpr_write_b32 a47, v11
v_accvgpr_read_b32 v10, a48
v_accvgpr_read_b32 v11, a49
v_ldexp_f32 v10, v10, v6
v_ldexp_f32 v11, v11, v6
v_accvgpr_write_b32 a48, v10
v_accvgpr_write_b32 a49, v11
v_accvgpr_read_b32 v10, a50
v_accvgpr_read_b32 v11, a51
v_ldexp_f32 v10, v10, v6
v_ldexp_f32 v11, v11, v6
v_accvgpr_write_b32 a50, v10
v_accvgpr_write_b32 a51, v11
v_accvgpr_read_b32 v10, a52
v_accvgpr_read_b32 v11, a53
v_ldexp_f32 v10, v10, v7
v_ldexp_f32 v11, v11, v7
v_accvgpr_write_b32 a52, v10
v_accvgpr_write_b32 a53, v11
v_accvgpr_read_b32 v10, a54
v_accvgpr_read_b32 v11, a55
v_ldexp_f32 v10, v10, v7
v_ldexp_f32 v11, v11, v7
v_accvgpr_write_b32 a54, v10
v_accvgpr_write_b32 a55, v11
v_accvgpr_read_b32 v10, a56
v_accvgpr_read_b32 v11, a57
v_ldexp_f32 v10, v10, v8
v_ldexp_f32 v11, v11, v8
v_accvgpr_write_b32 a56, v10
v_accvgpr_write_b32 a57, v11
v_accvgpr_read_b32 v10, a58
v_accvgpr_read_b32 v11, a59
v_ldexp_f32 v10, v10, v8
v_ldexp_f32 v11, v11, v8
v_accvgpr_write_b32 a58, v10
v_accvgpr_write_b32 a59, v11
v_accvgpr_read_b32 v10, a60
v_accvgpr_read_b32 v11, a61
v_ldexp_f32 v10, v10, v9
v_ldexp_f32 v11, v11, v9
v_accvgpr_write_b32 a60, v10
v_accvgpr_write_b32 a61, v11
v_accvgpr_read_b32 v10, a62
v_accvgpr_read_b32 v11, a63
v_ldexp_f32 v10, v10, v9
v_ldexp_f32 v11, v11, v9
v_accvgpr_write_b32 a62, v10
v_accvgpr_write_b32 a63, v11
v_accvgpr_read_b32 v10, a64
v_accvgpr_read_b32 v11, a65
v_ldexp_f32 v10, v10, v6
v_ldexp_f32 v11, v11, v6
v_accvgpr_write_b32 a64, v10
v_accvgpr_write_b32 a65, v11
v_accvgpr_read_b32 v10, a66
v_accvgpr_read_b32 v11, a67
v_ldexp_f32 v10, v10, v6
v_ldexp_f32 v11, v11, v6
v_accvgpr_write_b32 a66, v10
v_accvgpr_write_b32 a67, v11
v_accvgpr_read_b32 v10, a68
v_accvgpr_read_b32 v11, a69
v_ldexp_f32 v10, v10, v7
v_ldexp_f32 v11, v11, v7
v_accvgpr_write_b32 a68, v10
v_accvgpr_write_b32 a69, v11
v_accvgpr_read_b32 v10, a70
v_accvgpr_read_b32 v11, a71
v_ldexp_f32 v10, v10, v7
v_ldexp_f32 v11, v11, v7
v_accvgpr_write_b32 a70, v10
v_accvgpr_write_b32 a71, v11
v_accvgpr_read_b32 v10, a72
v_accvgpr_read_b32 v11, a73
v_ldexp_f32 v10, v10, v8
v_ldexp_f32 v11, v11, v8
v_accvgpr_write_b32 a72, v10
v_accvgpr_write_b32 a73, v11
v_accvgpr_read_b32 v10, a74
v_accvgpr_read_b32 v11, a75
v_ldexp_f32 v10, v10, v8
v_ldexp_f32 v11, v11, v8
v_accvgpr_write_b32 a74, v10
v_accvgpr_write_b32 a75, v11
v_accvgpr_read_b32 v10, a76
v_accvgpr_read_b32 v11, a77
v_ldexp_f32 v10, v10, v9
v_ldexp_f32 v11, v11, v9
v_accvgpr_write_b32 a76, v10
v_accvgpr_write_b32 a77, v11
v_accvgpr_read_b32 v10, a78
v_accvgpr_read_b32 v11, a79
v_ldexp_f32 v10, v10, v9
v_ldexp_f32 v11, v11, v9
v_accvgpr_write_b32 a78, v10
v_accvgpr_write_b32 a79, v11
v_accvgpr_read_b32 v10, a80
v_accvgpr_read_b32 v11, a81
v_ldexp_f32 v10, v10, v6
v_ldexp_f32 v11, v11, v6
v_accvgpr_write_b32 a80, v10
v_accvgpr_write_b32 a81, v11
v_accvgpr_read_b32 v10, a82
v_accvgpr_read_b32 v11, a83
v_ldexp_f32 v10, v10, v6
v_ldexp_f32 v11, v11, v6
v_accvgpr_write_b32 a82, v10
v_accvgpr_write_b32 a83, v11
v_accvgpr_read_b32 v10, a84
v_accvgpr_read_b32 v11, a85
v_ldexp_f32 v10, v10, v7
v_ldexp_f32 v11, v11, v7
v_accvgpr_write_b32 a84, v10
v_accvgpr_write_b32 a85, v11
v_accvgpr_read_b32 v10, a86
v_accvgpr_read_b32 v11, a87
v_ldexp_f32 v10, v10, v7
v_ldexp_f32 v11, v11, v7
v_accvgpr_write_b32 a86, v10
v_accvgpr_write_b32 a87, v11
v_accvgpr_read_b32 v10, a88
v_accvgpr_read_b32 v11, a89
v_ldexp_f32 v10, v10, v8
v_ldexp_f32 v11, v11, v8
v_accvgpr_write_b32 a88, v10
v_accvgpr_write_b32 a89, v11
v_accvgpr_read_b32 v10, a90
v_accvgpr_read_b32 v11, a91
v_ldexp_f32 v10, v10, v8
v_ldexp_f32 v11, v11, v8
v_accvgpr_write_b32 a90, v10
v_accvgpr_write_b32 a91, v11
v_accvgpr_read_b32 v10, a92
v_accvgpr_read_b32 v11, a93
v_ldexp_f32 v10, v10, v9
v_ldexp_f32 v11, v11, v9
v_accvgpr_write_b32 a92, v10
v_accvgpr_write_b32 a93, v11
v_accvgpr_read_b32 v10, a94
v_accvgpr_read_b32 v11, a95
v_ldexp_f32 v10, v10, v9
v_ldexp_f32 v11, v11, v9
v_accvgpr_write_b32 a94, v10
v_accvgpr_write_b32 a95, v11
v_accvgpr_read_b32 v10, a96
v_accvgpr_read_b32 v11, a97
v_ldexp_f32 v10, v10, v6
v_ldexp_f32 v11, v11, v6
v_accvgpr_write_b32 a96, v10
v_accvgpr_write_b32 a97, v11
v_accvgpr_read_b32 v10, a98
v_accvgpr_read_b32 v11, a99
v_ldexp_f32 v10, v10, v6
v_ldexp_f32 v11, v11, v6
v_accvgpr_write_b32 a98, v10
v_accvgpr_write_b32 a99, v11
v_accvgpr_read_b32 v10, a100
v_accvgpr_read_b32 v11, a101
v_ldexp_f32 v10, v10, v7
v_ldexp_f32 v11, v11, v7
v_accvgpr_write_b32 a100, v10
v_accvgpr_write_b32 a101, v11
v_accvgpr_read_b32 v10, a102
v_accvgpr_read_b32 v11, a103
v_ldexp_f32 v10, v10, v7
v_ldexp_f32 v11, v11, v7
v_accvgpr_write_b32 a102, v10
v_accvgpr_write_b32 a103, v11
v_accvgpr_read_b32 v10, a104
v_accvgpr_read_b32 v11, a105
v_ldexp_f32 v10, v10, v8
v_ldexp_f32 v11, v11, v8
v_accvgpr_write_b32 a104, v10
v_accvgpr_write_b32 a105, v11
v_accvgpr_read_b32 v10, a106
v_accvgpr_read_b32 v11, a107
v_ldexp_f32 v10, v10, v8
v_ldexp_f32 v11, v11, v8
v_accvgpr_write_b32 a106, v10
v_accvgpr_write_b32 a107, v11
v_accvgpr_read_b32 v10, a108
v_accvgpr_read_b32 v11, a109
v_ldexp_f32 v10, v10, v9
v_ldexp_f32 v11, v11, v9
v_accvgpr_write_b32 a108, v10
v_accvgpr_write_b32 a109, v11
v_accvgpr_read_b32 v10, a110
v_accvgpr_read_b32 v11, a111
v_ldexp_f32 v10, v10, v9
v_ldexp_f32 v11, v11, v9
v_accvgpr_write_b32 a110, v10
v_accvgpr_write_b32 a111, v11
v_accvgpr_read_b32 v10, a112
v_accvgpr_read_b32 v11, a113
v_ldexp_f32 v10, v10, v6
v_ldexp_f32 v11, v11, v6
v_accvgpr_write_b32 a112, v10
v_accvgpr_write_b32 a113, v11
v_accvgpr_read_b32 v10, a114
v_accvgpr_read_b32 v11, a115
v_ldexp_f32 v10, v10, v6
v_ldexp_f32 v11, v11, v6
v_accvgpr_write_b32 a114, v10
v_accvgpr_write_b32 a115, v11
v_accvgpr_read_b32 v10, a116
v_accvgpr_read_b32 v11, a117
v_ldexp_f32 v10, v10, v7
v_ldexp_f32 v11, v11, v7
v_accvgpr_write_b32 a116, v10
v_accvgpr_write_b32 a117, v11
v_accvgpr_read_b32 v10, a118
v_accvgpr_read_b32 v11, a119
v_ldexp_f32 v10, v10, v7
v_ldexp_f32 v11, v11, v7
v_accvgpr_write_b32 a118, v10
v_accvgpr_write_b32 a119, v11
v_accvgpr_read_b32 v10, a120
v_accvgpr_read_b32 v11, a121
v_ldexp_f32 v10, v10, v8
v_ldexp_f32 v11, v11, v8
v_accvgpr_write_b32 a120, v10
v_accvgpr_write_b32 a121, v11
v_accvgpr_read_b32 v10, a122
v_accvgpr_read_b32 v11, a123
v_ldexp_f32 v10, v10, v8
v_ldexp_f32 v11, v11, v8
v_accvgpr_write_b32 a122, v10
v_accvgpr_write_b32 a123, v11
v_accvgpr_read_b32 v10, a124
v_accvgpr_read_b32 v11, a125
v_ldexp_f32 v10, v10, v9
v_ldexp_f32 v11, v11, v9
v_accvgpr_write_b32 a124, v10
v_accvgpr_write_b32 a125, v11
v_accvgpr_read_b32 v10, a126
v_accvgpr_read_b32 v11, a127
v_ldexp_f32 v10, v10, v9
v_ldexp_f32 v11, v11, v9
v_accvgpr_write_b32 a126, v10
v_accvgpr_write_b32 a127, v11
v_accvgpr_read_b32 v10, a128
v_accvgpr_read_b32 v11, a129
v_ldexp_f32 v10, v10, v6
v_ldexp_f32 v11, v11, v6
v_accvgpr_write_b32 a128, v10
v_accvgpr_write_b32 a129, v11
v_accvgpr_read_b32 v10, a130
v_accvgpr_read_b32 v11, a131
v_ldexp_f32 v10, v10, v6
v_ldexp_f32 v11, v11, v6
v_accvgpr_write_b32 a130, v10
v_accvgpr_write_b32 a131, v11
v_accvgpr_read_b32 v10, a132
v_accvgpr_read_b32 v11, a133
v_ldexp_f32 v10, v10, v7
v_ldexp_f32 v11, v11, v7
v_accvgpr_write_b32 a132, v10
v_accvgpr_write_b32 a133, v11
v_accvgpr_read_b32 v10, a134
v_accvgpr_read_b32 v11, a135
v_ldexp_f32 v10, v10, v7
v_ldexp_f32 v11, v11, v7
v_accvgpr_write_b32 a134, v10
v_accvgpr_write_b32 a135, v11
v_accvgpr_read_b32 v10, a136
v_accvgpr_read_b32 v11, a137
v_ldexp_f32 v10, v10, v8
v_ldexp_f32 v11, v11, v8
v_accvgpr_write_b32 a136, v10
v_accvgpr_write_b32 a137, v11
v_accvgpr_read_b32 v10, a138
v_accvgpr_read_b32 v11, a139
v_ldexp_f32 v10, v10, v8
v_ldexp_f32 v11, v11, v8
v_accvgpr_write_b32 a138, v10
v_accvgpr_write_b32 a139, v11
v_accvgpr_read_b32 v10, a140
v_accvgpr_read_b32 v11, a141
v_ldexp_f32 v10, v10, v9
v_ldexp_f32 v11, v11, v9
v_accvgpr_write_b32 a140, v10
v_accvgpr_write_b32 a141, v11
v_accvgpr_read_b32 v10, a142
v_accvgpr_read_b32 v11, a143
v_ldexp_f32 v10, v10, v9
v_ldexp_f32 v11, v11, v9
v_accvgpr_write_b32 a142, v10
v_accvgpr_write_b32 a143, v11
v_accvgpr_read_b32 v10, a144
v_accvgpr_read_b32 v11, a145
v_ldexp_f32 v10, v10, v6
v_ldexp_f32 v11, v11, v6
v_accvgpr_write_b32 a144, v10
v_accvgpr_write_b32 a145, v11
v_accvgpr_read_b32 v10, a146
v_accvgpr_read_b32 v11, a147
v_ldexp_f32 v10, v10, v6
v_ldexp_f32 v11, v11, v6
v_accvgpr_write_b32 a146, v10
v_accvgpr_write_b32 a147, v11
v_accvgpr_read_b32 v10, a148
v_accvgpr_read_b32 v11, a149
v_ldexp_f32 v10, v10, v7
v_ldexp_f32 v11, v11, v7
v_accvgpr_write_b32 a148, v10
v_accvgpr_write_b32 a149, v11
v_accvgpr_read_b32 v10, a150
v_accvgpr_read_b32 v11, a151
v_ldexp_f32 v10, v10, v7
v_ldexp_f32 v11, v11, v7
v_accvgpr_write_b32 a150, v10
v_accvgpr_write_b32 a151, v11
v_accvgpr_read_b32 v10, a152
v_accvgpr_read_b32 v11, a153
v_ldexp_f32 v10, v10, v8
v_ldexp_f32 v11, v11, v8
v_accvgpr_write_b32 a152, v10
v_accvgpr_write_b32 a153, v11
v_accvgpr_read_b32 v10, a154
v_accvgpr_read_b32 v11, a155
v_ldexp_f32 v10, v10, v8
v_ldexp_f32 v11, v11, v8
v_accvgpr_write_b32 a154, v10
v_accvgpr_write_b32 a155, v11
v_accvgpr_read_b32 v10, a156
v_accvgpr_read_b32 v11, a157
v_ldexp_f32 v10, v10, v9
v_ldexp_f32 v11, v11, v9
v_accvgpr_write_b32 a156, v10
v_accvgpr_write_b32 a157, v11
v_accvgpr_read_b32 v10, a158
v_accvgpr_read_b32 v11, a159
v_ldexp_f32 v10, v10, v9
v_ldexp_f32 v11, v11, v9
v_accvgpr_write_b32 a158, v10
v_accvgpr_write_b32 a159, v11
v_accvgpr_read_b32 v10, a160
v_accvgpr_read_b32 v11, a161
v_ldexp_f32 v10, v10, v6
v_ldexp_f32 v11, v11, v6
v_accvgpr_write_b32 a160, v10
v_accvgpr_write_b32 a161, v11
v_accvgpr_read_b32 v10, a162
v_accvgpr_read_b32 v11, a163
v_ldexp_f32 v10, v10, v6
v_ldexp_f32 v11, v11, v6
v_accvgpr_write_b32 a162, v10
v_accvgpr_write_b32 a163, v11
v_accvgpr_read_b32 v10, a164
v_accvgpr_read_b32 v11, a165
v_ldexp_f32 v10, v10, v7
v_ldexp_f32 v11, v11, v7
v_accvgpr_write_b32 a164, v10
v_accvgpr_write_b32 a165, v11
v_accvgpr_read_b32 v10, a166
v_accvgpr_read_b32 v11, a167
v_ldexp_f32 v10, v10, v7
v_ldexp_f32 v11, v11, v7
v_accvgpr_write_b32 a166, v10
v_accvgpr_write_b32 a167, v11
v_accvgpr_read_b32 v10, a168
v_accvgpr_read_b32 v11, a169
v_ldexp_f32 v10, v10, v8
v_ldexp_f32 v11, v11, v8
v_accvgpr_write_b32 a168, v10
v_accvgpr_write_b32 a169, v11
v_accvgpr_read_b32 v10, a170
v_accvgpr_read_b32 v11, a171
v_ldexp_f32 v10, v10, v8
v_ldexp_f32 v11, v11, v8
v_accvgpr_write_b32 a170, v10
v_accvgpr_write_b32 a171, v11
v_accvgpr_read_b32 v10, a172
v_accvgpr_read_b32 v11, a173
v_ldexp_f32 v10, v10, v9
v_ldexp_f32 v11, v11, v9
v_accvgpr_write_b32 a172, v10
v_accvgpr_write_b32 a173, v11
v_accvgpr_read_b32 v10, a174
v_accvgpr_read_b32 v11, a175
v_ldexp_f32 v10, v10, v9
v_ldexp_f32 v11, v11, v9
v_accvgpr_write_b32 a174, v10
v_accvgpr_write_b32 a175, v11
v_accvgpr_read_b32 v10, a176
v_accvgpr_read_b32 v11, a177
v_ldexp_f32 v10, v10, v6
v_ldexp_f32 v11, v11, v6
v_accvgpr_write_b32 a176, v10
v_accvgpr_write_b32 a177, v11
v_accvgpr_read_b32 v10, a178
v_accvgpr_read_b32 v11, a179
v_ldexp_f32 v10, v10, v6
v_ldexp_f32 v11, v11, v6
v_accvgpr_write_b32 a178, v10
v_accvgpr_write_b32 a179, v11
v_accvgpr_read_b32 v10, a180
v_accvgpr_read_b32 v11, a181
v_ldexp_f32 v10, v10, v7
v_ldexp_f32 v11, v11, v7
v_accvgpr_write_b32 a180, v10
v_accvgpr_write_b32 a181, v11
v_accvgpr_read_b32 v10, a182
v_accvgpr_read_b32 v11, a183
v_ldexp_f32 v10, v10, v7
v_ldexp_f32 v11, v11, v7
v_accvgpr_write_b32 a182, v10
v_accvgpr_write_b32 a183, v11
v_accvgpr_read_b32 v10, a184
v_accvgpr_read_b32 v11, a185
v_ldexp_f32 v10, v10, v8
v_ldexp_f32 v11, v11, v8
v_accvgpr_write_b32 a184, v10
v_accvgpr_write_b32 a185, v11
v_accvgpr_read_b32 v10, a186
v_accvgpr_read_b32 v11, a187
v_ldexp_f32 v10, v10, v8
v_ldexp_f32 v11, v11, v8
v_accvgpr_write_b32 a186, v10
v_accvgpr_write_b32 a187, v11
v_accvgpr_read_b32 v10, a188
v_accvgpr_read_b32 v11, a189
v_ldexp_f32 v10, v10, v9
v_ldexp_f32 v11, v11, v9
v_accvgpr_write_b32 a188, v10
v_accvgpr_write_b32 a189, v11
v_accvgpr_read_b32 v10, a190
v_accvgpr_read_b32 v11, a191
v_ldexp_f32 v10, v10, v9
v_ldexp_f32 v11, v11, v9
v_accvgpr_write_b32 a190, v10
v_accvgpr_write_b32 a191, v11
v_exp_f32 v224, v64
v_exp_f32 v225, v65
v_exp_f32 v226, v66
v_exp_f32 v227, v67
v_exp_f32 v228, v68
v_exp_f32 v229, v69
v_exp_f32 v230, v70
v_exp_f32 v231, v71
v_add_f32 v232, v224, v225
v_cvt_pk_bf16_f32 v144, v224, v225
v_add_f32 v232, v232, v226
v_add_f32 v232, v232, v227
v_cvt_pk_bf16_f32 v145, v226, v227
v_add_f32 v233, v228, v229
v_cvt_pk_bf16_f32 v148, v228, v229
v_add_f32 v233, v233, v230
v_add_f32 v233, v233, v231
v_cvt_pk_bf16_f32 v149, v230, v231
v_exp_f32 v224, v72
v_exp_f32 v225, v73
v_exp_f32 v226, v74
v_exp_f32 v227, v75
v_exp_f32 v228, v76
v_exp_f32 v229, v77
v_exp_f32 v230, v78
v_exp_f32 v231, v79
v_add_f32 v234, v224, v225
v_cvt_pk_bf16_f32 v152, v224, v225
v_add_f32 v234, v234, v226
v_add_f32 v234, v234, v227
v_cvt_pk_bf16_f32 v153, v226, v227
v_add_f32 v235, v228, v229
v_cvt_pk_bf16_f32 v156, v228, v229
v_add_f32 v235, v235, v230
v_add_f32 v235, v235, v231
v_cvt_pk_bf16_f32 v157, v230, v231
v_exp_f32 v224, v96
v_exp_f32 v225, v97
v_exp_f32 v226, v98
v_exp_f32 v227, v99
v_exp_f32 v228, v100
v_exp_f32 v229, v101
v_exp_f32 v230, v102
v_exp_f32 v231, v103
v_add_f32 v232, v232, v224
v_add_f32 v232, v232, v225
v_cvt_pk_bf16_f32 v146, v224, v225
v_add_f32 v232, v232, v226
v_add_f32 v232, v232, v227
v_cvt_pk_bf16_f32 v147, v226, v227
v_add_f32 v233, v233, v228
v_add_f32 v233, v233, v229
v_cvt_pk_bf16_f32 v150, v228, v229
v_add_f32 v233, v233, v230
v_add_f32 v233, v233, v231
v_cvt_pk_bf16_f32 v151, v230, v231
v_exp_f32 v224, v104
v_exp_f32 v225, v105
v_exp_f32 v226, v106
v_exp_f32 v227, v107
v_exp_f32 v228, v108
v_exp_f32 v229, v109
v_exp_f32 v230, v110
v_exp_f32 v231, v111
v_add_f32 v234, v234, v224
v_add_f32 v234, v234, v225
v_cvt_pk_bf16_f32 v154, v224, v225
v_add_f32 v234, v234, v226
v_add_f32 v234, v234, v227
v_cvt_pk_bf16_f32 v155, v226, v227
v_add_f32 v235, v235, v228
v_add_f32 v235, v235, v229
v_cvt_pk_bf16_f32 v158, v228, v229
v_add_f32 v235, v235, v230
v_add_f32 v235, v235, v231
v_cvt_pk_bf16_f32 v159, v230, v231
s_nop 1
s_setpc_b64 s[64:65]
F_SLOW3:
s_nop 7
s_nop 7
v_max3_f32 v2, v80, v81, v82
v_max3_f32 v2, v2, v83, v96
v_max3_f32 v2, v2, v97, v98
v_max_f32 v2, v2, v99
v_max3_f32 v3, v84, v85, v86
v_max3_f32 v3, v3, v87, v100
v_max3_f32 v3, v3, v101, v102
v_max_f32 v3, v3, v103
v_max3_f32 v4, v88, v89, v90
v_max3_f32 v4, v4, v91, v104
v_max3_f32 v4, v4, v105, v106
v_max_f32 v4, v4, v107
v_max3_f32 v5, v92, v93, v94
v_max3_f32 v5, v5, v95, v108
v_max3_f32 v5, v5, v109, v110
v_max_f32 v5, v5, v111
v_mov_b32 v6, v2
v_mov_b32 v7, v3
v_mov_b32 v8, v4
v_mov_b32 v9, v5
s_nop 1
v_permlane16_swap_b32 v2, v6
v_permlane16_swap_b32 v3, v7
v_permlane16_swap_b32 v4, v8
v_permlane16_swap_b32 v5, v9
v_max_f32 v2, v2, v6
v_max_f32 v3, v3, v7
v_max_f32 v4, v4, v8
v_max_f32 v5, v5, v9
v_mov_b32 v6, v2
v_mov_b32 v7, v3
v_mov_b32 v8, v4
v_mov_b32 v9, v5
s_nop 1
v_permlane32_swap_b32 v2, v6
v_permlane32_swap_b32 v3, v7
v_permlane32_swap_b32 v4, v8
v_permlane32_swap_b32 v5, v9
v_max_f32 v2, v2, v6
v_max_f32 v3, v3, v7
v_max_f32 v4, v4, v8
v_max_f32 v5, v5, v9
v_max_f32 v2, 0, v2
v_ceil_f32 v2, v2
v_sub_f32 v6, 0, v2
v_cvt_i32_f32 v6, v6
v_max_f32 v3, 0, v3
v_ceil_f32 v3, v3
v_sub_f32 v7, 0, v3
v_cvt_i32_f32 v7, v7
v_max_f32 v4, 0, v4
v_ceil_f32 v4, v4
v_sub_f32 v8, 0, v4
v_cvt_i32_f32 v8, v8
v_max_f32 v5, 0, v5
v_ceil_f32 v5, v5
v_sub_f32 v9, 0, v5
v_cvt_i32_f32 v9, v9
v_ldexp_f32 v236, v236, v6
v_sub_f32 v48, v48, v2
v_sub_f32 v49, v49, v2
v_sub_f32 v50, v50, v2
v_sub_f32 v51, v51, v2
v_sub_f32 v80, v80, v2
v_sub_f32 v81, v81, v2
v_sub_f32 v82, v82, v2
v_sub_f32 v83, v83, v2
v_sub_f32 v96, v96, v2
v_sub_f32 v97, v97, v2
v_sub_f32 v98, v98, v2
v_sub_f32 v99, v99, v2
v_sub_f32 v64, v64, v2
v_sub_f32 v65, v65, v2
v_sub_f32 v66, v66, v2
v_sub_f32 v67, v67, v2
v_ldexp_f32 v237, v237, v7
v_sub_f32 v52, v52, v3
v_sub_f32 v53, v53, v3
v_sub_f32 v54, v54, v3
v_sub_f32 v55, v55, v3
v_sub_f32 v84, v84, v3
v_sub_f32 v85, v85, v3
v_sub_f32 v86, v86, v3
v_sub_f32 v87, v87, v3
v_sub_f32 v100, v100, v3
v_sub_f32 v101, v101, v3
v_sub_f32 v102, v102, v3
v_sub_f32 v103, v103, v3
v_sub_f32 v68, v68, v3
v_sub_f32 v69, v69, v3
v_sub_f32 v70, v70, v3
v_sub_f32 v71, v71, v3
v_ldexp_f32 v238, v238, v8
v_sub_f32 v56, v56, v4
v_sub_f32 v57, v57, v4
v_sub_f32 v58, v58, v4
v_sub_f32 v59, v59, v4
v_sub_f32 v88, v88, v4
v_sub_f32 v89, v89, v4
v_sub_f32 v90, v90, v4
v_sub_f32 v91, v91, v4
v_sub_f32 v104, v104, v4
v_sub_f32 v105, v105, v4
v_sub_f32 v106, v106, v4
v_sub_f32 v107, v107, v4
v_sub_f32 v72, v72, v4
v_sub_f32 v73, v73, v4
v_sub_f32 v74, v74, v4
v_sub_f32 v75, v75, v4
v_ldexp_f32 v239, v239, v9
v_sub_f32 v60, v60, v5
v_sub_f32 v61, v61, v5
v_sub_f32 v62, v62, v5
v_sub_f32 v63, v63, v5
v_sub_f32 v92, v92, v5
v_sub_f32 v93, v93, v5
v_sub_f32 v94, v94, v5
v_sub_f32 v95, v95, v5
v_sub_f32 v108, v108, v5
v_sub_f32 v109, v109, v5
v_sub_f32 v110, v110, v5
v_sub_f32 v111, v111, v5
v_sub_f32 v76, v76, v5
v_sub_f32 v77, v77, v5
v_sub_f32 v78, v78, v5
v_sub_f32 v79, v79, v5
v_lshlrev_b32 v10, 16, v144
v_and_b32 v11, 0xffff0000, v144
v_ldexp_f32 v10, v10, v6
v_ldexp_f32 v11, v11, v6
v_cvt_pk_bf16_f32 v144, v10, v11
v_lshlrev_b32 v10, 16, v145
v_and_b32 v11, 0xffff0000, v145
v_ldexp_f32 v10, v10, v6
v_ldexp_f32 v11, v11, v6
v_cvt_pk_bf16_f32 v145, v10, v11
v_lshlrev_b32 v10, 16, v146
v_and_b32 v11, 0xffff0000, v146
v_ldexp_f32 v10, v10, v6
v_ldexp_f32 v11, v11, v6
v_cvt_pk_bf16_f32 v146, v10, v11
v_lshlrev_b32 v10, 16, v147
v_and_b32 v11, 0xffff0000, v147
v_ldexp_f32 v10, v10, v6
v_ldexp_f32 v11, v11, v6
v_cvt_pk_bf16_f32 v147, v10, v11
v_lshlrev_b32 v10, 16, v148
v_and_b32 v11, 0xffff0000, v148
v_ldexp_f32 v10, v10, v7
v_ldexp_f32 v11, v11, v7
v_cvt_pk_bf16_f32 v148, v10, v11
v_lshlrev_b32 v10, 16, v149
v_and_b32 v11, 0xffff0000, v149
v_ldexp_f32 v10, v10, v7
v_ldexp_f32 v11, v11, v7
v_cvt_pk_bf16_f32 v149, v10, v11
v_lshlrev_b32 v10, 16, v150
v_and_b32 v11, 0xffff0000, v150
v_ldexp_f32 v10, v10, v7
v_ldexp_f32 v11, v11, v7
v_cvt_pk_bf16_f32 v150, v10, v11
v_lshlrev_b32 v10, 16, v151
v_and_b32 v11, 0xffff0000, v151
v_ldexp_f32 v10, v10, v7
v_ldexp_f32 v11, v11, v7
v_cvt_pk_bf16_f32 v151, v10, v11
v_lshlrev_b32 v10, 16, v152
v_and_b32 v11, 0xffff0000, v152
v_ldexp_f32 v10, v10, v8
v_ldexp_f32 v11, v11, v8
v_cvt_pk_bf16_f32 v152, v10, v11
v_lshlrev_b32 v10, 16, v153
v_and_b32 v11, 0xffff0000, v153
v_ldexp_f32 v10, v10, v8
v_ldexp_f32 v11, v11, v8
v_cvt_pk_bf16_f32 v153, v10, v11
v_lshlrev_b32 v10, 16, v154
v_and_b32 v11, 0xffff0000, v154
v_ldexp_f32 v10, v10, v8
v_ldexp_f32 v11, v11, v8
v_cvt_pk_bf16_f32 v154, v10, v11
v_lshlrev_b32 v10, 16, v155
v_and_b32 v11, 0xffff0000, v155
v_ldexp_f32 v10, v10, v8
v_ldexp_f32 v11, v11, v8
v_cvt_pk_bf16_f32 v155, v10, v11
v_lshlrev_b32 v10, 16, v156
v_and_b32 v11, 0xffff0000, v156
v_ldexp_f32 v10, v10, v9
v_ldexp_f32 v11, v11, v9
v_cvt_pk_bf16_f32 v156, v10, v11
v_lshlrev_b32 v10, 16, v157
v_and_b32 v11, 0xffff0000, v157
v_ldexp_f32 v10, v10, v9
v_ldexp_f32 v11, v11, v9
v_cvt_pk_bf16_f32 v157, v10, v11
v_lshlrev_b32 v10, 16, v158
v_and_b32 v11, 0xffff0000, v158
v_ldexp_f32 v10, v10, v9
v_ldexp_f32 v11, v11, v9
v_cvt_pk_bf16_f32 v158, v10, v11
v_lshlrev_b32 v10, 16, v159
v_and_b32 v11, 0xffff0000, v159
v_ldexp_f32 v10, v10, v9
v_ldexp_f32 v11, v11, v9
v_cvt_pk_bf16_f32 v159, v10, v11
v_accvgpr_read_b32 v10, a0
v_accvgpr_read_b32 v11, a1
v_ldexp_f32 v10, v10, v6
v_ldexp_f32 v11, v11, v6
v_accvgpr_write_b32 a0, v10
v_accvgpr_write_b32 a1, v11
v_accvgpr_read_b32 v10, a2
v_accvgpr_read_b32 v11, a3
v_ldexp_f32 v10, v10, v6
v_ldexp_f32 v11, v11, v6
v_accvgpr_write_b32 a2, v10
v_accvgpr_write_b32 a3, v11
v_accvgpr_read_b32 v10, a4
v_accvgpr_read_b32 v11, a5
v_ldexp_f32 v10, v10, v7
v_ldexp_f32 v11, v11, v7
v_accvgpr_write_b32 a4, v10
v_accvgpr_write_b32 a5, v11
v_accvgpr_read_b32 v10, a6
v_accvgpr_read_b32 v11, a7
v_ldexp_f32 v10, v10, v7
v_ldexp_f32 v11, v11, v7
v_accvgpr_write_b32 a6, v10
v_accvgpr_write_b32 a7, v11
v_accvgpr_read_b32 v10, a8
v_accvgpr_read_b32 v11, a9
v_ldexp_f32 v10, v10, v8
v_ldexp_f32 v11, v11, v8
v_accvgpr_write_b32 a8, v10
v_accvgpr_write_b32 a9, v11
v_accvgpr_read_b32 v10, a10
v_accvgpr_read_b32 v11, a11
v_ldexp_f32 v10, v10, v8
v_ldexp_f32 v11, v11, v8
v_accvgpr_write_b32 a10, v10
v_accvgpr_write_b32 a11, v11
v_accvgpr_read_b32 v10, a12
v_accvgpr_read_b32 v11, a13
v_ldexp_f32 v10, v10, v9
v_ldexp_f32 v11, v11, v9
v_accvgpr_write_b32 a12, v10
v_accvgpr_write_b32 a13, v11
v_accvgpr_read_b32 v10, a14
v_accvgpr_read_b32 v11, a15
v_ldexp_f32 v10, v10, v9
v_ldexp_f32 v11, v11, v9
v_accvgpr_write_b32 a14, v10
v_accvgpr_write_b32 a15, v11
v_accvgpr_read_b32 v10, a16
v_accvgpr_read_b32 v11, a17
v_ldexp_f32 v10, v10, v6
v_ldexp_f32 v11, v11, v6
v_accvgpr_write_b32 a16, v10
v_accvgpr_write_b32 a17, v11
v_accvgpr_read_b32 v10, a18
v_accvgpr_read_b32 v11, a19
v_ldexp_f32 v10, v10, v6
v_ldexp_f32 v11, v11, v6
v_accvgpr_write_b32 a18, v10
v_accvgpr_write_b32 a19, v11
v_accvgpr_read_b32 v10, a20
v_accvgpr_read_b32 v11, a21
v_ldexp_f32 v10, v10, v7
v_ldexp_f32 v11, v11, v7
v_accvgpr_write_b32 a20, v10
v_accvgpr_write_b32 a21, v11
v_accvgpr_read_b32 v10, a22
v_accvgpr_read_b32 v11, a23
v_ldexp_f32 v10, v10, v7
v_ldexp_f32 v11, v11, v7
v_accvgpr_write_b32 a22, v10
v_accvgpr_write_b32 a23, v11
v_accvgpr_read_b32 v10, a24
v_accvgpr_read_b32 v11, a25
v_ldexp_f32 v10, v10, v8
v_ldexp_f32 v11, v11, v8
v_accvgpr_write_b32 a24, v10
v_accvgpr_write_b32 a25, v11
v_accvgpr_read_b32 v10, a26
v_accvgpr_read_b32 v11, a27
v_ldexp_f32 v10, v10, v8
v_ldexp_f32 v11, v11, v8
v_accvgpr_write_b32 a26, v10
v_accvgpr_write_b32 a27, v11
v_accvgpr_read_b32 v10, a28
v_accvgpr_read_b32 v11, a29
v_ldexp_f32 v10, v10, v9
v_ldexp_f32 v11, v11, v9
v_accvgpr_write_b32 a28, v10
v_accvgpr_write_b32 a29, v11
v_accvgpr_read_b32 v10, a30
v_accvgpr_read_b32 v11, a31
v_ldexp_f32 v10, v10, v9
v_ldexp_f32 v11, v11, v9
v_accvgpr_write_b32 a30, v10
v_accvgpr_write_b32 a31, v11
v_accvgpr_read_b32 v10, a32
v_accvgpr_read_b32 v11, a33
v_ldexp_f32 v10, v10, v6
v_ldexp_f32 v11, v11, v6
v_accvgpr_write_b32 a32, v10
v_accvgpr_write_b32 a33, v11
v_accvgpr_read_b32 v10, a34
v_accvgpr_read_b32 v11, a35
v_ldexp_f32 v10, v10, v6
v_ldexp_f32 v11, v11, v6
v_accvgpr_write_b32 a34, v10
v_accvgpr_write_b32 a35, v11
v_accvgpr_read_b32 v10, a36
v_accvgpr_read_b32 v11, a37
v_ldexp_f32 v10, v10, v7
v_ldexp_f32 v11, v11, v7
v_accvgpr_write_b32 a36, v10
v_accvgpr_write_b32 a37, v11
v_accvgpr_read_b32 v10, a38
v_accvgpr_read_b32 v11, a39
v_ldexp_f32 v10, v10, v7
v_ldexp_f32 v11, v11, v7
v_accvgpr_write_b32 a38, v10
v_accvgpr_write_b32 a39, v11
v_accvgpr_read_b32 v10, a40
v_accvgpr_read_b32 v11, a41
v_ldexp_f32 v10, v10, v8
v_ldexp_f32 v11, v11, v8
v_accvgpr_write_b32 a40, v10
v_accvgpr_write_b32 a41, v11
v_accvgpr_read_b32 v10, a42
v_accvgpr_read_b32 v11, a43
v_ldexp_f32 v10, v10, v8
v_ldexp_f32 v11, v11, v8
v_accvgpr_write_b32 a42, v10
v_accvgpr_write_b32 a43, v11
v_accvgpr_read_b32 v10, a44
v_accvgpr_read_b32 v11, a45
v_ldexp_f32 v10, v10, v9
v_ldexp_f32 v11, v11, v9
v_accvgpr_write_b32 a44, v10
v_accvgpr_write_b32 a45, v11
v_accvgpr_read_b32 v10, a46
v_accvgpr_read_b32 v11, a47
v_ldexp_f32 v10, v10, v9
v_ldexp_f32 v11, v11, v9
v_accvgpr_write_b32 a46, v10
v_accvgpr_write_b32 a47, v11
v_accvgpr_read_b32 v10, a48
v_accvgpr_read_b32 v11, a49
v_ldexp_f32 v10, v10, v6
v_ldexp_f32 v11, v11, v6
v_accvgpr_write_b32 a48, v10
v_accvgpr_write_b32 a49, v11
v_accvgpr_read_b32 v10, a50
v_accvgpr_read_b32 v11, a51
v_ldexp_f32 v10, v10, v6
v_ldexp_f32 v11, v11, v6
v_accvgpr_write_b32 a50, v10
v_accvgpr_write_b32 a51, v11
v_accvgpr_read_b32 v10, a52
v_accvgpr_read_b32 v11, a53
v_ldexp_f32 v10, v10, v7
v_ldexp_f32 v11, v11, v7
v_accvgpr_write_b32 a52, v10
v_accvgpr_write_b32 a53, v11
v_accvgpr_read_b32 v10, a54
v_accvgpr_read_b32 v11, a55
v_ldexp_f32 v10, v10, v7
v_ldexp_f32 v11, v11, v7
v_accvgpr_write_b32 a54, v10
v_accvgpr_write_b32 a55, v11
v_accvgpr_read_b32 v10, a56
v_accvgpr_read_b32 v11, a57
v_ldexp_f32 v10, v10, v8
v_ldexp_f32 v11, v11, v8
v_accvgpr_write_b32 a56, v10
v_accvgpr_write_b32 a57, v11
v_accvgpr_read_b32 v10, a58
v_accvgpr_read_b32 v11, a59
v_ldexp_f32 v10, v10, v8
v_ldexp_f32 v11, v11, v8
v_accvgpr_write_b32 a58, v10
v_accvgpr_write_b32 a59, v11
v_accvgpr_read_b32 v10, a60
v_accvgpr_read_b32 v11, a61
v_ldexp_f32 v10, v10, v9
v_ldexp_f32 v11, v11, v9
v_accvgpr_write_b32 a60, v10
v_accvgpr_write_b32 a61, v11
v_accvgpr_read_b32 v10, a62
v_accvgpr_read_b32 v11, a63
v_ldexp_f32 v10, v10, v9
v_ldexp_f32 v11, v11, v9
v_accvgpr_write_b32 a62, v10
v_accvgpr_write_b32 a63, v11
v_accvgpr_read_b32 v10, a64
v_accvgpr_read_b32 v11, a65
v_ldexp_f32 v10, v10, v6
v_ldexp_f32 v11, v11, v6
v_accvgpr_write_b32 a64, v10
v_accvgpr_write_b32 a65, v11
v_accvgpr_read_b32 v10, a66
v_accvgpr_read_b32 v11, a67
v_ldexp_f32 v10, v10, v6
v_ldexp_f32 v11, v11, v6
v_accvgpr_write_b32 a66, v10
v_accvgpr_write_b32 a67, v11
v_accvgpr_read_b32 v10, a68
v_accvgpr_read_b32 v11, a69
v_ldexp_f32 v10, v10, v7
v_ldexp_f32 v11, v11, v7
v_accvgpr_write_b32 a68, v10
v_accvgpr_write_b32 a69, v11
v_accvgpr_read_b32 v10, a70
v_accvgpr_read_b32 v11, a71
v_ldexp_f32 v10, v10, v7
v_ldexp_f32 v11, v11, v7
v_accvgpr_write_b32 a70, v10
v_accvgpr_write_b32 a71, v11
v_accvgpr_read_b32 v10, a72
v_accvgpr_read_b32 v11, a73
v_ldexp_f32 v10, v10, v8
v_ldexp_f32 v11, v11, v8
v_accvgpr_write_b32 a72, v10
v_accvgpr_write_b32 a73, v11
v_accvgpr_read_b32 v10, a74
v_accvgpr_read_b32 v11, a75
v_ldexp_f32 v10, v10, v8
v_ldexp_f32 v11, v11, v8
v_accvgpr_write_b32 a74, v10
v_accvgpr_write_b32 a75, v11
v_accvgpr_read_b32 v10, a76
v_accvgpr_read_b32 v11, a77
v_ldexp_f32 v10, v10, v9
v_ldexp_f32 v11, v11, v9
v_accvgpr_write_b32 a76, v10
v_accvgpr_write_b32 a77, v11
v_accvgpr_read_b32 v10, a78
v_accvgpr_read_b32 v11, a79
v_ldexp_f32 v10, v10, v9
v_ldexp_f32 v11, v11, v9
v_accvgpr_write_b32 a78, v10
v_accvgpr_write_b32 a79, v11
v_accvgpr_read_b32 v10, a80
v_accvgpr_read_b32 v11, a81
v_ldexp_f32 v10, v10, v6
v_ldexp_f32 v11, v11, v6
v_accvgpr_write_b32 a80, v10
v_accvgpr_write_b32 a81, v11
v_accvgpr_read_b32 v10, a82
v_accvgpr_read_b32 v11, a83
v_ldexp_f32 v10, v10, v6
v_ldexp_f32 v11, v11, v6
v_accvgpr_write_b32 a82, v10
v_accvgpr_write_b32 a83, v11
v_accvgpr_read_b32 v10, a84
v_accvgpr_read_b32 v11, a85
v_ldexp_f32 v10, v10, v7
v_ldexp_f32 v11, v11, v7
v_accvgpr_write_b32 a84, v10
v_accvgpr_write_b32 a85, v11
v_accvgpr_read_b32 v10, a86
v_accvgpr_read_b32 v11, a87
v_ldexp_f32 v10, v10, v7
v_ldexp_f32 v11, v11, v7
v_accvgpr_write_b32 a86, v10
v_accvgpr_write_b32 a87, v11
v_accvgpr_read_b32 v10, a88
v_accvgpr_read_b32 v11, a89
v_ldexp_f32 v10, v10, v8
v_ldexp_f32 v11, v11, v8
v_accvgpr_write_b32 a88, v10
v_accvgpr_write_b32 a89, v11
v_accvgpr_read_b32 v10, a90
v_accvgpr_read_b32 v11, a91
v_ldexp_f32 v10, v10, v8
v_ldexp_f32 v11, v11, v8
v_accvgpr_write_b32 a90, v10
v_accvgpr_write_b32 a91, v11
v_accvgpr_read_b32 v10, a92
v_accvgpr_read_b32 v11, a93
v_ldexp_f32 v10, v10, v9
v_ldexp_f32 v11, v11, v9
v_accvgpr_write_b32 a92, v10
v_accvgpr_write_b32 a93, v11
v_accvgpr_read_b32 v10, a94
v_accvgpr_read_b32 v11, a95
v_ldexp_f32 v10, v10, v9
v_ldexp_f32 v11, v11, v9
v_accvgpr_write_b32 a94, v10
v_accvgpr_write_b32 a95, v11
v_accvgpr_read_b32 v10, a96
v_accvgpr_read_b32 v11, a97
v_ldexp_f32 v10, v10, v6
v_ldexp_f32 v11, v11, v6
v_accvgpr_write_b32 a96, v10
v_accvgpr_write_b32 a97, v11
v_accvgpr_read_b32 v10, a98
v_accvgpr_read_b32 v11, a99
v_ldexp_f32 v10, v10, v6
v_ldexp_f32 v11, v11, v6
v_accvgpr_write_b32 a98, v10
v_accvgpr_write_b32 a99, v11
v_accvgpr_read_b32 v10, a100
v_accvgpr_read_b32 v11, a101
v_ldexp_f32 v10, v10, v7
v_ldexp_f32 v11, v11, v7
v_accvgpr_write_b32 a100, v10
v_accvgpr_write_b32 a101, v11
v_accvgpr_read_b32 v10, a102
v_accvgpr_read_b32 v11, a103
v_ldexp_f32 v10, v10, v7
v_ldexp_f32 v11, v11, v7
v_accvgpr_write_b32 a102, v10
v_accvgpr_write_b32 a103, v11
v_accvgpr_read_b32 v10, a104
v_accvgpr_read_b32 v11, a105
v_ldexp_f32 v10, v10, v8
v_ldexp_f32 v11, v11, v8
v_accvgpr_write_b32 a104, v10
v_accvgpr_write_b32 a105, v11
v_accvgpr_read_b32 v10, a106
v_accvgpr_read_b32 v11, a107
v_ldexp_f32 v10, v10, v8
v_ldexp_f32 v11, v11, v8
v_accvgpr_write_b32 a106, v10
v_accvgpr_write_b32 a107, v11
v_accvgpr_read_b32 v10, a108
v_accvgpr_read_b32 v11, a109
v_ldexp_f32 v10, v10, v9
v_ldexp_f32 v11, v11, v9
v_accvgpr_write_b32 a108, v10
v_accvgpr_write_b32 a109, v11
v_accvgpr_read_b32 v10, a110
v_accvgpr_read_b32 v11, a111
v_ldexp_f32 v10, v10, v9
v_ldexp_f32 v11, v11, v9
v_accvgpr_write_b32 a110, v10
v_accvgpr_write_b32 a111, v11
v_accvgpr_read_b32 v10, a112
v_accvgpr_read_b32 v11, a113
v_ldexp_f32 v10, v10, v6
v_ldexp_f32 v11, v11, v6
v_accvgpr_write_b32 a112, v10
v_accvgpr_write_b32 a113, v11
v_accvgpr_read_b32 v10, a114
v_accvgpr_read_b32 v11, a115
v_ldexp_f32 v10, v10, v6
v_ldexp_f32 v11, v11, v6
v_accvgpr_write_b32 a114, v10
v_accvgpr_write_b32 a115, v11
v_accvgpr_read_b32 v10, a116
v_accvgpr_read_b32 v11, a117
v_ldexp_f32 v10, v10, v7
v_ldexp_f32 v11, v11, v7
v_accvgpr_write_b32 a116, v10
v_accvgpr_write_b32 a117, v11
v_accvgpr_read_b32 v10, a118
v_accvgpr_read_b32 v11, a119
v_ldexp_f32 v10, v10, v7
v_ldexp_f32 v11, v11, v7
v_accvgpr_write_b32 a118, v10
v_accvgpr_write_b32 a119, v11
v_accvgpr_read_b32 v10, a120
v_accvgpr_read_b32 v11, a121
v_ldexp_f32 v10, v10, v8
v_ldexp_f32 v11, v11, v8
v_accvgpr_write_b32 a120, v10
v_accvgpr_write_b32 a121, v11
v_accvgpr_read_b32 v10, a122
v_accvgpr_read_b32 v11, a123
v_ldexp_f32 v10, v10, v8
v_ldexp_f32 v11, v11, v8
v_accvgpr_write_b32 a122, v10
v_accvgpr_write_b32 a123, v11
v_accvgpr_read_b32 v10, a124
v_accvgpr_read_b32 v11, a125
v_ldexp_f32 v10, v10, v9
v_ldexp_f32 v11, v11, v9
v_accvgpr_write_b32 a124, v10
v_accvgpr_write_b32 a125, v11
v_accvgpr_read_b32 v10, a126
v_accvgpr_read_b32 v11, a127
v_ldexp_f32 v10, v10, v9
v_ldexp_f32 v11, v11, v9
v_accvgpr_write_b32 a126, v10
v_accvgpr_write_b32 a127, v11
v_accvgpr_read_b32 v10, a128
v_accvgpr_read_b32 v11, a129
v_ldexp_f32 v10, v10, v6
v_ldexp_f32 v11, v11, v6
v_accvgpr_write_b32 a128, v10
v_accvgpr_write_b32 a129, v11
v_accvgpr_read_b32 v10, a130
v_accvgpr_read_b32 v11, a131
v_ldexp_f32 v10, v10, v6
v_ldexp_f32 v11, v11, v6
v_accvgpr_write_b32 a130, v10
v_accvgpr_write_b32 a131, v11
v_accvgpr_read_b32 v10, a132
v_accvgpr_read_b32 v11, a133
v_ldexp_f32 v10, v10, v7
v_ldexp_f32 v11, v11, v7
v_accvgpr_write_b32 a132, v10
v_accvgpr_write_b32 a133, v11
v_accvgpr_read_b32 v10, a134
v_accvgpr_read_b32 v11, a135
v_ldexp_f32 v10, v10, v7
v_ldexp_f32 v11, v11, v7
v_accvgpr_write_b32 a134, v10
v_accvgpr_write_b32 a135, v11
v_accvgpr_read_b32 v10, a136
v_accvgpr_read_b32 v11, a137
v_ldexp_f32 v10, v10, v8
v_ldexp_f32 v11, v11, v8
v_accvgpr_write_b32 a136, v10
v_accvgpr_write_b32 a137, v11
v_accvgpr_read_b32 v10, a138
v_accvgpr_read_b32 v11, a139
v_ldexp_f32 v10, v10, v8
v_ldexp_f32 v11, v11, v8
v_accvgpr_write_b32 a138, v10
v_accvgpr_write_b32 a139, v11
v_accvgpr_read_b32 v10, a140
v_accvgpr_read_b32 v11, a141
v_ldexp_f32 v10, v10, v9
v_ldexp_f32 v11, v11, v9
v_accvgpr_write_b32 a140, v10
v_accvgpr_write_b32 a141, v11
v_accvgpr_read_b32 v10, a142
v_accvgpr_read_b32 v11, a143
v_ldexp_f32 v10, v10, v9
v_ldexp_f32 v11, v11, v9
v_accvgpr_write_b32 a142, v10
v_accvgpr_write_b32 a143, v11
v_accvgpr_read_b32 v10, a144
v_accvgpr_read_b32 v11, a145
v_ldexp_f32 v10, v10, v6
v_ldexp_f32 v11, v11, v6
v_accvgpr_write_b32 a144, v10
v_accvgpr_write_b32 a145, v11
v_accvgpr_read_b32 v10, a146
v_accvgpr_read_b32 v11, a147
v_ldexp_f32 v10, v10, v6
v_ldexp_f32 v11, v11, v6
v_accvgpr_write_b32 a146, v10
v_accvgpr_write_b32 a147, v11
v_accvgpr_read_b32 v10, a148
v_accvgpr_read_b32 v11, a149
v_ldexp_f32 v10, v10, v7
v_ldexp_f32 v11, v11, v7
v_accvgpr_write_b32 a148, v10
v_accvgpr_write_b32 a149, v11
v_accvgpr_read_b32 v10, a150
v_accvgpr_read_b32 v11, a151
v_ldexp_f32 v10, v10, v7
v_ldexp_f32 v11, v11, v7
v_accvgpr_write_b32 a150, v10
v_accvgpr_write_b32 a151, v11
v_accvgpr_read_b32 v10, a152
v_accvgpr_read_b32 v11, a153
v_ldexp_f32 v10, v10, v8
v_ldexp_f32 v11, v11, v8
v_accvgpr_write_b32 a152, v10
v_accvgpr_write_b32 a153, v11
v_accvgpr_read_b32 v10, a154
v_accvgpr_read_b32 v11, a155
v_ldexp_f32 v10, v10, v8
v_ldexp_f32 v11, v11, v8
v_accvgpr_write_b32 a154, v10
v_accvgpr_write_b32 a155, v11
v_accvgpr_read_b32 v10, a156
v_accvgpr_read_b32 v11, a157
v_ldexp_f32 v10, v10, v9
v_ldexp_f32 v11, v11, v9
v_accvgpr_write_b32 a156, v10
v_accvgpr_write_b32 a157, v11
v_accvgpr_read_b32 v10, a158
v_accvgpr_read_b32 v11, a159
v_ldexp_f32 v10, v10, v9
v_ldexp_f32 v11, v11, v9
v_accvgpr_write_b32 a158, v10
v_accvgpr_write_b32 a159, v11
v_accvgpr_read_b32 v10, a160
v_accvgpr_read_b32 v11, a161
v_ldexp_f32 v10, v10, v6
v_ldexp_f32 v11, v11, v6
v_accvgpr_write_b32 a160, v10
v_accvgpr_write_b32 a161, v11
v_accvgpr_read_b32 v10, a162
v_accvgpr_read_b32 v11, a163
v_ldexp_f32 v10, v10, v6
v_ldexp_f32 v11, v11, v6
v_accvgpr_write_b32 a162, v10
v_accvgpr_write_b32 a163, v11
v_accvgpr_read_b32 v10, a164
v_accvgpr_read_b32 v11, a165
v_ldexp_f32 v10, v10, v7
v_ldexp_f32 v11, v11, v7
v_accvgpr_write_b32 a164, v10
v_accvgpr_write_b32 a165, v11
v_accvgpr_read_b32 v10, a166
v_accvgpr_read_b32 v11, a167
v_ldexp_f32 v10, v10, v7
v_ldexp_f32 v11, v11, v7
v_accvgpr_write_b32 a166, v10
v_accvgpr_write_b32 a167, v11
v_accvgpr_read_b32 v10, a168
v_accvgpr_read_b32 v11, a169
v_ldexp_f32 v10, v10, v8
v_ldexp_f32 v11, v11, v8
v_accvgpr_write_b32 a168, v10
v_accvgpr_write_b32 a169, v11
v_accvgpr_read_b32 v10, a170
v_accvgpr_read_b32 v11, a171
v_ldexp_f32 v10, v10, v8
v_ldexp_f32 v11, v11, v8
v_accvgpr_write_b32 a170, v10
v_accvgpr_write_b32 a171, v11
v_accvgpr_read_b32 v10, a172
v_accvgpr_read_b32 v11, a173
v_ldexp_f32 v10, v10, v9
v_ldexp_f32 v11, v11, v9
v_accvgpr_write_b32 a172, v10
v_accvgpr_write_b32 a173, v11
v_accvgpr_read_b32 v10, a174
v_accvgpr_read_b32 v11, a175
v_ldexp_f32 v10, v10, v9
v_ldexp_f32 v11, v11, v9
v_accvgpr_write_b32 a174, v10
v_accvgpr_write_b32 a175, v11
v_accvgpr_read_b32 v10, a176
v_accvgpr_read_b32 v11, a177
v_ldexp_f32 v10, v10, v6
v_ldexp_f32 v11, v11, v6
v_accvgpr_write_b32 a176, v10
v_accvgpr_write_b32 a177, v11
v_accvgpr_read_b32 v10, a178
v_accvgpr_read_b32 v11, a179
v_ldexp_f32 v10, v10, v6
v_ldexp_f32 v11, v11, v6
v_accvgpr_write_b32 a178, v10
v_accvgpr_write_b32 a179, v11
v_accvgpr_read_b32 v10, a180
v_accvgpr_read_b32 v11, a181
v_ldexp_f32 v10, v10, v7
v_ldexp_f32 v11, v11, v7
v_accvgpr_write_b32 a180, v10
v_accvgpr_write_b32 a181, v11
v_accvgpr_read_b32 v10, a182
v_accvgpr_read_b32 v11, a183
v_ldexp_f32 v10, v10, v7
v_ldexp_f32 v11, v11, v7
v_accvgpr_write_b32 a182, v10
v_accvgpr_write_b32 a183, v11
v_accvgpr_read_b32 v10, a184
v_accvgpr_read_b32 v11, a185
v_ldexp_f32 v10, v10, v8
v_ldexp_f32 v11, v11, v8
v_accvgpr_write_b32 a184, v10
v_accvgpr_write_b32 a185, v11
v_accvgpr_read_b32 v10, a186
v_accvgpr_read_b32 v11, a187
v_ldexp_f32 v10, v10, v8
v_ldexp_f32 v11, v11, v8
v_accvgpr_write_b32 a186, v10
v_accvgpr_write_b32 a187, v11
v_accvgpr_read_b32 v10, a188
v_accvgpr_read_b32 v11, a189
v_ldexp_f32 v10, v10, v9
v_ldexp_f32 v11, v11, v9
v_accvgpr_write_b32 a188, v10
v_accvgpr_write_b32 a189, v11
v_accvgpr_read_b32 v10, a190
v_accvgpr_read_b32 v11, a191
v_ldexp_f32 v10, v10, v9
v_ldexp_f32 v11, v11, v9
v_accvgpr_write_b32 a190, v10
v_accvgpr_write_b32 a191, v11
v_exp_f32 v224, v80
v_exp_f32 v225, v81
v_exp_f32 v226, v82
v_exp_f32 v227, v83
v_exp_f32 v228, v84
v_exp_f32 v229, v85
v_exp_f32 v230, v86
v_exp_f32 v231, v87
v_add_f32 v232, v224, v225
v_cvt_pk_bf16_f32 v160, v224, v225
v_add_f32 v232, v232, v226
v_add_f32 v232, v232, v227
v_cvt_pk_bf16_f32 v161, v226, v227
v_add_f32 v233, v228, v229
v_cvt_pk_bf16_f32 v164, v228, v229
v_add_f32 v233, v233, v230
v_add_f32 v233, v233, v231
v_cvt_pk_bf16_f32 v165, v230, v231
v_exp_f32 v224, v88
v_exp_f32 v225, v89
v_exp_f32 v226, v90
v_exp_f32 v227, v91
v_exp_f32 v228, v92
v_exp_f32 v229, v93
v_exp_f32 v230, v94
v_exp_f32 v231, v95
v_add_f32 v234, v224, v225
v_cvt_pk_bf16_f32 v168, v224, v225
v_add_f32 v234, v234, v226
v_add_f32 v234, v234, v227
v_cvt_pk_bf16_f32 v169, v226, v227
v_add_f32 v235, v228, v229
v_cvt_pk_bf16_f32 v172, v228, v229
v_add_f32 v235, v235, v230
v_add_f32 v235, v235, v231
v_cvt_pk_bf16_f32 v173, v230, v231
v_exp_f32 v224, v96
v_exp_f32 v225, v97
v_exp_f32 v226, v98
v_exp_f32 v227, v99
v_exp_f32 v228, v100
v_exp_f32 v229, v101
v_exp_f32 v230, v102
v_exp_f32 v231, v103
v_add_f32 v232, v232, v224
v_add_f32 v232, v232, v225
v_cvt_pk_bf16_f32 v162, v224, v225
v_add_f32 v232, v232, v226
v_add_f32 v232, v232, v227
v_cvt_pk_bf16_f32 v163, v226, v227
v_add_f32 v233, v233, v228
v_add_f32 v233, v233, v229
v_cvt_pk_bf16_f32 v166, v228, v229
v_add_f32 v233, v233, v230
v_add_f32 v233, v233, v231
v_cvt_pk_bf16_f32 v167, v230, v231
v_exp_f32 v224, v104
v_exp_f32 v225, v105
v_exp_f32 v226, v106
v_exp_f32 v227, v107
v_exp_f32 v228, v108
v_exp_f32 v229, v109
v_exp_f32 v230, v110
v_exp_f32 v231, v111
v_add_f32 v234, v234, v224
v_add_f32 v234, v234, v225
v_cvt_pk_bf16_f32 v170, v224, v225
v_add_f32 v234, v234, v226
v_add_f32 v234, v234, v227
v_cvt_pk_bf16_f32 v171, v226, v227
v_add_f32 v235, v235, v228
v_add_f32 v235, v235, v229
v_cvt_pk_bf16_f32 v174, v228, v229
v_add_f32 v235, v235, v230
v_add_f32 v235, v235, v231
v_cvt_pk_bf16_f32 v175, v230, v231
s_nop 1
s_setpc_b64 s[64:65]
.section .rodata,"a"
.p2align 6
.amdhsa_kernel recurrent_scan__gqa_block_cached__dense_activation_relu__prompt_kernel
  .amdhsa_next_free_vgpr 512
  .amdhsa_next_free_sgpr 102
  .amdhsa_accum_offset 256
  .amdhsa_group_segment_fixed_size 0
  .amdhsa_kernarg_size 88
  .amdhsa_user_sgpr_count 2
  .amdhsa_user_sgpr_kernarg_segment_ptr 1
  .amdhsa_system_sgpr_workgroup_id_x 1
  .amdhsa_float_denorm_mode_32 3
.end_amdhsa_kernel
```
